```python
import torch

def _softmax(x, axis=-1):
    return torch.softmax(x, dim=axis)
def _gelu(x):
    return torch.nn.functional.gelu(x, approximate="tanh")
def _silu(x):
    return torch.nn.functional.silu(x)
def _sigmoid(x):
    return torch.sigmoid(x)
def _layernorm(x, axis=-1, eps=1e-5):
    m = x.mean(dim=axis, keepdim=True)
    v = x.var(dim=axis, keepdim=True, unbiased=False)
    return (x - m) / torch.sqrt(v + eps)
def _scatter_add(tgt, idx, src, axis=0):
    return tgt.clone().index_add_(axis, idx, src)
def _segment_sum(src, seg, n):
    out = torch.zeros((n,) + src.shape[1:], dtype=src.dtype)
    return out.index_add_(0, seg, src)
def _pad(x, pw):
    flat = tuple(v for pair in reversed(pw) for v in pair)
    return torch.nn.functional.pad(x, flat)

kernel_name = 'parallel_sum__sliding_local_dilated__glu_gated_bilinear__prompt'

def setup_inputs():

    _w = (lambda a: (lambda t: t.to(torch.bfloat16) if t.is_floating_point() else t)(torch.as_tensor(a)))
    def _A_setup():
        B, S, D = 1, 2048, 1024
        return {
            "x": _w((lambda *s: torch.randn(*s, dtype=torch.bfloat16) * 0.05)(B, S, D)),
            "wqkv": _w((lambda *s: torch.randn(*s, dtype=torch.bfloat16) * 0.05)(D, 3 * D)),
            "wo": _w((lambda *s: torch.randn(*s, dtype=torch.bfloat16) * 0.05)(D, D)),
        }
    _A_in = _A_setup()

    def _B_setup():
        B, S, D, F = 1, 2048, 1024, 3584
        return {
            "x": _w((lambda *s: torch.randn(*s, dtype=torch.bfloat16) * 0.05)(B, S, D)),
            "w_gate": _w((lambda *s: torch.randn(*s, dtype=torch.bfloat16) * 0.8)(D, F) * (D ** -0.5)),
            "w_up": _w((lambda *s: torch.randn(*s, dtype=torch.bfloat16) * 0.8)(D, F) * (D ** -0.5)),
            "w_down": _w((lambda *s: torch.randn(*s, dtype=torch.bfloat16) * 0.8)(F, D) * (F ** -0.5)),
        }
    _B_in = _B_setup()

    return {
        "A_x": _A_in["x"],
        "A_wqkv": _A_in["wqkv"],
        "A_wo": _A_in["wo"],
        "B_x": _B_in["x"],
        "B_w_gate": _B_in["w_gate"],
        "B_w_up": _B_in["w_up"],
        "B_w_down": _B_in["w_down"],
    }

def reference(A_x, A_wqkv, A_wo, B_x, B_w_gate, B_w_up, B_w_down):
    def _A_ref(x, wqkv, wo):
        B, S, D = x.shape
        H = 32; Dh = D // H
        W, dil = 8, 2
        qkv = (lambda x, *d: x.permute(*d))((x @ wqkv).reshape(B, S, 3, H, Dh), 2, 0, 3, 1, 4)
        q, k, v = qkv[0], qkv[1], qkv[2]
        scale = Dh ** -0.5
        pos = torch.arange(S)
        off = torch.arange(W) * dil
        idx = pos[:, None] - off[None, :]
        mask = idx >= 0
        idx_c = torch.where(mask, idx, 0).reshape(-1)
        kg = k[:, :, idx_c, :].reshape(B, H, S, W, Dh)
        vg = v[:, :, idx_c, :].reshape(B, H, S, W, Dh)
        logits = torch.einsum("bhsd,bhswd->bhsw", q, kg) * scale
        logits = torch.where(mask[None, None, :, :], logits, -1e9)
        attn = _softmax(logits, axis=-1)
        o = torch.einsum("bhsw,bhswd->bhsd", attn, vg)
        return (lambda x, *d: x.permute(*d))(o, 0, 2, 1, 3).reshape(B, S, D) @ wo

    def _B_ref(x, w_gate, w_up, w_down):
        g = torch.einsum("bsd,df->bsf", x, w_gate)
        u = torch.einsum("bsd,df->bsf", x, w_up)
        h = g * u
        return torch.einsum("bsf,fd->bsd", h, w_down)

    x = A_x
    xn = _layernorm(x, axis=-1)
    return x + _A_ref(xn, A_wqkv, A_wo) + _B_ref(xn, B_w_gate, B_w_up, B_w_down)
```

```asm
; @launch grid=(256,1,1) block=(256,1,1) lds=163840
.amdgcn_target "amdgcn-amd-amdhsa--gfx950"
.text
.globl parallel_sum__sliding_local_dilated__glu_gated_bilinear__prompt_kernel
.p2align 8
.type parallel_sum__sliding_local_dilated__glu_gated_bilinear__prompt_kernel,@function
parallel_sum__sliding_local_dilated__glu_gated_bilinear__prompt_kernel:
    s_cmp_ge_u32 s2, 256
    s_cbranch_scc1 L_end
    s_load_dwordx2 s[96:97], s[0:1], 0
    s_load_dwordx2 s[4:5], s[0:1], 8
    s_load_dwordx4 s[56:59], s[0:1], 32
    s_load_dwordx2 s[6:7], s[0:1], 72
    s_load_dwordx2 s[68:69], s[0:1], 48
    s_load_dwordx2 s[92:93], s[0:1], 16
    s_memrealtime s[60:61]
    v_lshrrev_b32 v20, 6, v0
    v_and_b32 v1, 63, v0
    v_readfirstlane_b32 s51, v20
    s_nop 1
    s_cmp_lg_u32 s51, 3
    s_cbranch_scc1 L1_nocpf0
    s_getpc_b64 s[94:95]
Lpc_L1_nocpf0:
    s_add_u32 s94, s94, L1_nocpf0-Lpc_L1_nocpf0
    s_addc_u32 s95, s95, 0
    v_lshlrev_b32 v134, 7, v1
    v_min_u32 v134, L1_wn1-L1_nocpf0-4, v134
    global_load_dword v135, v134, s[94:95]
L1_nocpf0:
    v_lshrrev_b32 v128, 3, v1
    v_and_b32 v129, 7, v1
    s_and_b32 s53, s2, 7
    s_lshl_b32 s53, s53, 5
    s_lshr_b32 s3, s2, 3
    s_or_b32 s53, s53, s3
    s_lshl_b32 s3, s53, 14
    v_lshl_add_u32 v130, v128, 11, s3
    v_lshl_add_u32 v130, v20, 9, v130
    v_lshl_add_u32 v130, v129, 4, v130
    s_mov_b32 s98, 0x400000
    s_mov_b32 s99, 0x20000
    s_waitcnt lgkmcnt(0)
    buffer_load_dwordx4 v[32:35], v130, s[96:99], 0 offen offset:0
    buffer_load_dwordx4 v[36:39], v130, s[96:99], 0 offen offset:128
    buffer_load_dwordx4 v[40:43], v130, s[96:99], 0 offen offset:256
    buffer_load_dwordx4 v[44:47], v130, s[96:99], 0 offen offset:384
    s_sub_u32 s100, s60, 2500
    s_not_b32 s101, s61
    s_and_b32 s55, s2, 7
    s_lshl_b32 s55, s55, 2
    s_lshr_b32 s3, s2, 3
    s_lshr_b32 s54, s3, 2
    s_and_b32 s3, s3, 3
    s_add_u32 s55, s55, s3
    s_lshr_b32 s52, s51, 1
    s_lshl_b32 s62, s55, 6
    s_mul_i32 s63, s55, 224
    s_and_b32 s64, s55, 1
    s_lshl_b32 s64, s64, 1
    s_movk_i32 s65, 6144
    s_movk_i32 s66, 7168
    s_cmp_eq_u32 s51, 1
    s_cbranch_scc1 L1_set1
    s_cmp_eq_u32 s51, 2
    s_cbranch_scc1 L1_set2
    s_cmp_eq_u32 s51, 3
    s_cbranch_scc1 L1_set3
    v_mul_u32_u24 v21, 21846, v1
    v_lshrrev_b32 v21, 16, v21
    v_mul_u32_u24 v22, 3, v21
    v_sub_u32 v22, v1, v22
    s_lshl_b32 s60, s54, 2
    v_add_u32 v21, s60, v21
    v_lshlrev_b32 v22, 11, v22
    v_add_u32 v22, s62, v22
    v_mad_u32_u24 v19, v21, s65, v22
    s_mov_b32 s87, 196608
    s_mov_b32 s86, 0
    s_mov_b32 s88, s4
    s_mov_b32 s89, s5
    s_mov_b32 s90, 6291456
    s_mov_b32 s91, 0x20000
    v_mov_b32 v23, 0x80000000
    v_cmp_gt_u32 vcc, 12, v1
    s_nop 1
    v_cndmask_b32 v19, v23, v19, vcc
    v_add_u32 v21, 0, v1
    v_mul_u32_u24 v22, 5462, v21
    v_lshrrev_b32 v22, 16, v22
    v_mul_u32_u24 v23, 12, v22
    v_sub_u32 v21, v21, v23
    v_lshrrev_b32 v23, 1, v22
    v_and_b32 v23, 2, v23
    v_xor_b32 v21, v21, v23
    v_lshrrev_b32 v23, 2, v21
    v_lshlrev_b32 v23, 11, v23
    v_and_b32 v21, 3, v21
    v_lshl_add_u32 v21, v21, 4, v23
    v_add_u32 v21, s62, v21
    v_and_b32 v23, 3, v22
    v_bfe_u32 v24, v22, 2, 2
    v_lshl_add_u32 v23, v24, 3, v23
    v_lshrrev_b32 v24, 4, v22
    v_lshl_add_u32 v23, v24, 2, v23
    v_mad_u32_u24 v4, v23, s65, v21
    s_mov_b32 s12, s4
    s_mov_b32 s13, s5
    s_mov_b32 s14, 6291456
    s_mov_b32 s15, 0x20000
    s_mov_b32 s42, 196608
    v_add_u32 v21, 64, v1
    v_mul_u32_u24 v22, 5462, v21
    v_lshrrev_b32 v22, 16, v22
    v_mul_u32_u24 v23, 12, v22
    v_sub_u32 v21, v21, v23
    v_lshrrev_b32 v23, 1, v22
    v_and_b32 v23, 2, v23
    v_xor_b32 v21, v21, v23
    v_lshrrev_b32 v23, 2, v21
    v_lshlrev_b32 v23, 11, v23
    v_and_b32 v21, 3, v21
    v_lshl_add_u32 v21, v21, 4, v23
    v_add_u32 v21, s62, v21
    v_and_b32 v23, 3, v22
    v_bfe_u32 v24, v22, 2, 2
    v_lshl_add_u32 v23, v24, 3, v23
    v_lshrrev_b32 v24, 4, v22
    v_lshl_add_u32 v23, v24, 2, v23
    v_mad_u32_u24 v5, v23, s65, v21
    s_mov_b32 s16, s4
    s_mov_b32 s17, s5
    s_mov_b32 s18, 6291456
    s_mov_b32 s19, 0x20000
    s_mov_b32 s43, 196608
    v_add_u32 v21, 128, v1
    v_mul_u32_u24 v22, 5462, v21
    v_lshrrev_b32 v22, 16, v22
    v_mul_u32_u24 v23, 12, v22
    v_sub_u32 v21, v21, v23
    v_lshrrev_b32 v23, 1, v22
    v_and_b32 v23, 2, v23
    v_xor_b32 v21, v21, v23
    v_lshrrev_b32 v23, 2, v21
    v_lshlrev_b32 v23, 11, v23
    v_and_b32 v21, 3, v21
    v_lshl_add_u32 v21, v21, 4, v23
    v_add_u32 v21, s62, v21
    v_and_b32 v23, 3, v22
    v_bfe_u32 v24, v22, 2, 2
    v_lshl_add_u32 v23, v24, 3, v23
    v_lshrrev_b32 v24, 4, v22
    v_lshl_add_u32 v23, v24, 2, v23
    v_mad_u32_u24 v6, v23, s65, v21
    s_mov_b32 s20, s4
    s_mov_b32 s21, s5
    s_mov_b32 s22, 6291456
    s_mov_b32 s23, 0x20000
    s_mov_b32 s44, 196608
    v_add_u32 v21, 192, v1
    v_mul_u32_u24 v22, 5462, v21
    v_lshrrev_b32 v22, 16, v22
    v_mul_u32_u24 v23, 12, v22
    v_sub_u32 v21, v21, v23
    v_lshrrev_b32 v23, 1, v22
    v_and_b32 v23, 2, v23
    v_xor_b32 v21, v21, v23
    v_lshrrev_b32 v23, 2, v21
    v_lshlrev_b32 v23, 11, v23
    v_and_b32 v21, 3, v21
    v_lshl_add_u32 v21, v21, 4, v23
    v_add_u32 v21, s62, v21
    v_and_b32 v23, 3, v22
    v_bfe_u32 v24, v22, 2, 2
    v_lshl_add_u32 v23, v24, 3, v23
    v_lshrrev_b32 v24, 4, v22
    v_lshl_add_u32 v23, v24, 2, v23
    v_mad_u32_u24 v7, v23, s65, v21
    s_mov_b32 s24, s4
    s_mov_b32 s25, s5
    s_mov_b32 s26, 6291456
    s_mov_b32 s27, 0x20000
    s_mov_b32 s45, 196608
    v_add_u32 v21, 256, v1
    v_mul_u32_u24 v22, 5462, v21
    v_lshrrev_b32 v22, 16, v22
    v_mul_u32_u24 v23, 12, v22
    v_sub_u32 v21, v21, v23
    v_lshrrev_b32 v23, 1, v22
    v_and_b32 v23, 2, v23
    v_xor_b32 v21, v21, v23
    v_lshrrev_b32 v23, 2, v21
    v_lshlrev_b32 v23, 11, v23
    v_and_b32 v21, 3, v21
    v_lshl_add_u32 v21, v21, 4, v23
    v_add_u32 v21, s62, v21
    v_and_b32 v23, 3, v22
    v_bfe_u32 v24, v22, 2, 2
    v_lshl_add_u32 v23, v24, 3, v23
    v_lshrrev_b32 v24, 4, v22
    v_lshl_add_u32 v23, v24, 2, v23
    v_mad_u32_u24 v8, v23, s65, v21
    s_mov_b32 s28, s4
    s_mov_b32 s29, s5
    s_mov_b32 s30, 6291456
    s_mov_b32 s31, 0x20000
    s_mov_b32 s46, 196608
    s_branch L1_setdone
L1_set1:
    v_mul_u32_u24 v21, 21846, v1
    v_lshrrev_b32 v21, 16, v21
    v_mul_u32_u24 v22, 3, v21
    v_sub_u32 v22, v1, v22
    s_lshl_b32 s60, s54, 2
    v_add_u32 v21, s60, v21
    v_lshlrev_b32 v22, 7, v22
    v_min_u32 v22, 220, v22
    v_add_u32 v22, s63, v22
    v_mad_u32_u24 v19, v21, s66, v22
    s_mov_b32 s87, 229376
    s_mov_b32 s86, 0
    s_mov_b32 s88, s56
    s_mov_b32 s89, s57
    s_mov_b32 s90, 7340032
    s_mov_b32 s91, 0x20000
    v_mov_b32 v23, 0x80000000
    v_cmp_gt_u32 vcc, 12, v1
    s_nop 1
    v_cndmask_b32 v19, v23, v19, vcc
    v_add_u32 v21, 320, v1
    v_mul_u32_u24 v22, 5462, v21
    v_lshrrev_b32 v22, 16, v22
    v_mul_u32_u24 v23, 12, v22
    v_sub_u32 v21, v21, v23
    v_lshrrev_b32 v23, 1, v22
    v_and_b32 v23, 2, v23
    v_xor_b32 v21, v21, v23
    v_lshrrev_b32 v23, 2, v21
    v_lshlrev_b32 v23, 11, v23
    v_and_b32 v21, 3, v21
    v_lshl_add_u32 v21, v21, 4, v23
    v_add_u32 v21, s62, v21
    v_and_b32 v23, 3, v22
    v_bfe_u32 v24, v22, 2, 2
    v_lshl_add_u32 v23, v24, 3, v23
    v_lshrrev_b32 v24, 4, v22
    v_lshl_add_u32 v23, v24, 2, v23
    v_mad_u32_u24 v4, v23, s65, v21
    s_mov_b32 s12, s4
    s_mov_b32 s13, s5
    s_mov_b32 s14, 6291456
    s_mov_b32 s15, 0x20000
    s_mov_b32 s42, 196608
    v_add_u32 v21, 0, v1
    v_mul_u32_u24 v22, 4682, v21
    v_lshrrev_b32 v22, 16, v22
    v_mul_u32_u24 v23, 14, v22
    v_sub_u32 v21, v21, v23
    v_add_u32 v21, s64, v21
    v_subrev_u32 v23, 14, v21
    v_min_u32 v21, v21, v23
    v_lshl_add_u32 v21, v21, 4, s63
    v_and_b32 v23, 3, v22
    v_bfe_u32 v24, v22, 2, 2
    v_lshl_add_u32 v23, v24, 3, v23
    v_lshrrev_b32 v24, 4, v22
    v_lshl_add_u32 v23, v24, 2, v23
    v_mad_u32_u24 v5, v23, s66, v21
    s_mov_b32 s16, s56
    s_mov_b32 s17, s57
    s_mov_b32 s18, 7340032
    s_mov_b32 s19, 0x20000
    s_mov_b32 s43, 229376
    v_add_u32 v21, 64, v1
    v_mul_u32_u24 v22, 4682, v21
    v_lshrrev_b32 v22, 16, v22
    v_mul_u32_u24 v23, 14, v22
    v_sub_u32 v21, v21, v23
    v_add_u32 v21, s64, v21
    v_subrev_u32 v23, 14, v21
    v_min_u32 v21, v21, v23
    v_lshl_add_u32 v21, v21, 4, s63
    v_and_b32 v23, 3, v22
    v_bfe_u32 v24, v22, 2, 2
    v_lshl_add_u32 v23, v24, 3, v23
    v_lshrrev_b32 v24, 4, v22
    v_lshl_add_u32 v23, v24, 2, v23
    v_mad_u32_u24 v6, v23, s66, v21
    s_mov_b32 s20, s56
    s_mov_b32 s21, s57
    s_mov_b32 s22, 7340032
    s_mov_b32 s23, 0x20000
    s_mov_b32 s44, 229376
    v_add_u32 v21, 128, v1
    v_mul_u32_u24 v22, 4682, v21
    v_lshrrev_b32 v22, 16, v22
    v_mul_u32_u24 v23, 14, v22
    v_sub_u32 v21, v21, v23
    v_add_u32 v21, s64, v21
    v_subrev_u32 v23, 14, v21
    v_min_u32 v21, v21, v23
    v_lshl_add_u32 v21, v21, 4, s63
    v_and_b32 v23, 3, v22
    v_bfe_u32 v24, v22, 2, 2
    v_lshl_add_u32 v23, v24, 3, v23
    v_lshrrev_b32 v24, 4, v22
    v_lshl_add_u32 v23, v24, 2, v23
    v_mad_u32_u24 v7, v23, s66, v21
    s_mov_b32 s24, s56
    s_mov_b32 s25, s57
    s_mov_b32 s26, 7340032
    s_mov_b32 s27, 0x20000
    s_mov_b32 s45, 229376
    v_add_u32 v21, 192, v1
    v_mul_u32_u24 v22, 4682, v21
    v_lshrrev_b32 v22, 16, v22
    v_mul_u32_u24 v23, 14, v22
    v_sub_u32 v21, v21, v23
    v_add_u32 v21, s64, v21
    v_subrev_u32 v23, 14, v21
    v_min_u32 v21, v21, v23
    v_lshl_add_u32 v21, v21, 4, s63
    v_and_b32 v23, 3, v22
    v_bfe_u32 v24, v22, 2, 2
    v_lshl_add_u32 v23, v24, 3, v23
    v_lshrrev_b32 v24, 4, v22
    v_lshl_add_u32 v23, v24, 2, v23
    v_mad_u32_u24 v8, v23, s66, v21
    s_mov_b32 s28, s56
    s_mov_b32 s29, s57
    s_mov_b32 s30, 7340032
    s_mov_b32 s31, 0x20000
    s_mov_b32 s46, 229376
    s_branch L1_setdone
L1_set2:
    v_mul_u32_u24 v21, 21846, v1
    v_lshrrev_b32 v21, 16, v21
    v_mul_u32_u24 v22, 3, v21
    v_sub_u32 v22, v1, v22
    s_lshl_b32 s60, s54, 2
    v_add_u32 v21, s60, v21
    v_lshlrev_b32 v22, 7, v22
    v_min_u32 v22, 220, v22
    v_add_u32 v22, s63, v22
    v_mad_u32_u24 v19, v21, s66, v22
    s_mov_b32 s87, 229376
    s_mov_b32 s86, 0
    s_mov_b32 s88, s58
    s_mov_b32 s89, s59
    s_mov_b32 s90, 7340032
    s_mov_b32 s91, 0x20000
    v_mov_b32 v23, 0x80000000
    v_cmp_gt_u32 vcc, 12, v1
    s_nop 1
    v_cndmask_b32 v19, v23, v19, vcc
    v_add_u32 v21, 256, v1
    v_mul_u32_u24 v22, 4682, v21
    v_lshrrev_b32 v22, 16, v22
    v_mul_u32_u24 v23, 14, v22
    v_sub_u32 v21, v21, v23
    v_add_u32 v21, s64, v21
    v_subrev_u32 v23, 14, v21
    v_min_u32 v21, v21, v23
    v_lshl_add_u32 v21, v21, 4, s63
    v_and_b32 v23, 3, v22
    v_bfe_u32 v24, v22, 2, 2
    v_lshl_add_u32 v23, v24, 3, v23
    v_lshrrev_b32 v24, 4, v22
    v_lshl_add_u32 v23, v24, 2, v23
    v_mad_u32_u24 v4, v23, s66, v21
    s_mov_b32 s12, s56
    s_mov_b32 s13, s57
    s_mov_b32 s14, 7340032
    s_mov_b32 s15, 0x20000
    s_mov_b32 s42, 229376
    v_add_u32 v21, 320, v1
    v_mul_u32_u24 v22, 4682, v21
    v_lshrrev_b32 v22, 16, v22
    v_mul_u32_u24 v23, 14, v22
    v_sub_u32 v21, v21, v23
    v_add_u32 v21, s64, v21
    v_subrev_u32 v23, 14, v21
    v_min_u32 v21, v21, v23
    v_lshl_add_u32 v21, v21, 4, s63
    v_and_b32 v23, 3, v22
    v_bfe_u32 v24, v22, 2, 2
    v_lshl_add_u32 v23, v24, 3, v23
    v_lshrrev_b32 v24, 4, v22
    v_lshl_add_u32 v23, v24, 2, v23
    v_mad_u32_u24 v5, v23, s66, v21
    s_mov_b32 s16, s56
    s_mov_b32 s17, s57
    s_mov_b32 s18, 7340032
    s_mov_b32 s19, 0x20000
    s_mov_b32 s43, 229376
    v_add_u32 v21, 384, v1
    v_mul_u32_u24 v22, 4682, v21
    v_lshrrev_b32 v22, 16, v22
    v_mul_u32_u24 v23, 14, v22
    v_sub_u32 v21, v21, v23
    v_add_u32 v21, s64, v21
    v_subrev_u32 v23, 14, v21
    v_min_u32 v21, v21, v23
    v_lshl_add_u32 v21, v21, 4, s63
    v_and_b32 v23, 3, v22
    v_bfe_u32 v24, v22, 2, 2
    v_lshl_add_u32 v23, v24, 3, v23
    v_lshrrev_b32 v24, 4, v22
    v_lshl_add_u32 v23, v24, 2, v23
    v_mad_u32_u24 v6, v23, s66, v21
    s_mov_b32 s20, s56
    s_mov_b32 s21, s57
    s_mov_b32 s22, 7340032
    s_mov_b32 s23, 0x20000
    s_mov_b32 s44, 229376
    v_add_u32 v21, 0, v1
    v_mul_u32_u24 v22, 4682, v21
    v_lshrrev_b32 v22, 16, v22
    v_mul_u32_u24 v23, 14, v22
    v_sub_u32 v21, v21, v23
    v_add_u32 v21, s64, v21
    v_subrev_u32 v23, 14, v21
    v_min_u32 v21, v21, v23
    v_lshl_add_u32 v21, v21, 4, s63
    v_and_b32 v23, 3, v22
    v_bfe_u32 v24, v22, 2, 2
    v_lshl_add_u32 v23, v24, 3, v23
    v_lshrrev_b32 v24, 4, v22
    v_lshl_add_u32 v23, v24, 2, v23
    v_mad_u32_u24 v7, v23, s66, v21
    s_mov_b32 s24, s58
    s_mov_b32 s25, s59
    s_mov_b32 s26, 7340032
    s_mov_b32 s27, 0x20000
    s_mov_b32 s45, 229376
    v_add_u32 v21, 64, v1
    v_mul_u32_u24 v22, 4682, v21
    v_lshrrev_b32 v22, 16, v22
    v_mul_u32_u24 v23, 14, v22
    v_sub_u32 v21, v21, v23
    v_add_u32 v21, s64, v21
    v_subrev_u32 v23, 14, v21
    v_min_u32 v21, v21, v23
    v_lshl_add_u32 v21, v21, 4, s63
    v_and_b32 v23, 3, v22
    v_bfe_u32 v24, v22, 2, 2
    v_lshl_add_u32 v23, v24, 3, v23
    v_lshrrev_b32 v24, 4, v22
    v_lshl_add_u32 v23, v24, 2, v23
    v_mad_u32_u24 v8, v23, s66, v21
    s_mov_b32 s28, s58
    s_mov_b32 s29, s59
    s_mov_b32 s30, 7340032
    s_mov_b32 s31, 0x20000
    s_mov_b32 s46, 229376
    s_branch L1_setdone
L1_set3:
    v_lshlrev_b32 v19, 7, v1
    s_mov_b32 s87, 7168
    s_mov_b32 s86, 4294737920
    s_mul_i32 s60, s2, 28672
    s_add_u32 s88, s68, s60
    s_addc_u32 s89, s69, 0
    s_mov_b32 s90, 28672
    s_mov_b32 s91, 0x20000
    v_mov_b32 v23, 0x80000000
    v_cmp_gt_u32 vcc, 56, v1
    s_nop 1
    v_cndmask_b32 v19, v23, v19, vcc
    v_add_u32 v21, 128, v1
    v_mul_u32_u24 v22, 4682, v21
    v_lshrrev_b32 v22, 16, v22
    v_mul_u32_u24 v23, 14, v22
    v_sub_u32 v21, v21, v23
    v_add_u32 v21, s64, v21
    v_subrev_u32 v23, 14, v21
    v_min_u32 v21, v21, v23
    v_lshl_add_u32 v21, v21, 4, s63
    v_and_b32 v23, 3, v22
    v_bfe_u32 v24, v22, 2, 2
    v_lshl_add_u32 v23, v24, 3, v23
    v_lshrrev_b32 v24, 4, v22
    v_lshl_add_u32 v23, v24, 2, v23
    v_mad_u32_u24 v4, v23, s66, v21
    s_mov_b32 s12, s58
    s_mov_b32 s13, s59
    s_mov_b32 s14, 7340032
    s_mov_b32 s15, 0x20000
    s_mov_b32 s42, 229376
    v_add_u32 v21, 192, v1
    v_mul_u32_u24 v22, 4682, v21
    v_lshrrev_b32 v22, 16, v22
    v_mul_u32_u24 v23, 14, v22
    v_sub_u32 v21, v21, v23
    v_add_u32 v21, s64, v21
    v_subrev_u32 v23, 14, v21
    v_min_u32 v21, v21, v23
    v_lshl_add_u32 v21, v21, 4, s63
    v_and_b32 v23, 3, v22
    v_bfe_u32 v24, v22, 2, 2
    v_lshl_add_u32 v23, v24, 3, v23
    v_lshrrev_b32 v24, 4, v22
    v_lshl_add_u32 v23, v24, 2, v23
    v_mad_u32_u24 v5, v23, s66, v21
    s_mov_b32 s16, s58
    s_mov_b32 s17, s59
    s_mov_b32 s18, 7340032
    s_mov_b32 s19, 0x20000
    s_mov_b32 s43, 229376
    v_add_u32 v21, 256, v1
    v_mul_u32_u24 v22, 4682, v21
    v_lshrrev_b32 v22, 16, v22
    v_mul_u32_u24 v23, 14, v22
    v_sub_u32 v21, v21, v23
    v_add_u32 v21, s64, v21
    v_subrev_u32 v23, 14, v21
    v_min_u32 v21, v21, v23
    v_lshl_add_u32 v21, v21, 4, s63
    v_and_b32 v23, 3, v22
    v_bfe_u32 v24, v22, 2, 2
    v_lshl_add_u32 v23, v24, 3, v23
    v_lshrrev_b32 v24, 4, v22
    v_lshl_add_u32 v23, v24, 2, v23
    v_mad_u32_u24 v6, v23, s66, v21
    s_mov_b32 s20, s58
    s_mov_b32 s21, s59
    s_mov_b32 s22, 7340032
    s_mov_b32 s23, 0x20000
    s_mov_b32 s44, 229376
    v_add_u32 v21, 320, v1
    v_mul_u32_u24 v22, 4682, v21
    v_lshrrev_b32 v22, 16, v22
    v_mul_u32_u24 v23, 14, v22
    v_sub_u32 v21, v21, v23
    v_add_u32 v21, s64, v21
    v_subrev_u32 v23, 14, v21
    v_min_u32 v21, v21, v23
    v_lshl_add_u32 v21, v21, 4, s63
    v_and_b32 v23, 3, v22
    v_bfe_u32 v24, v22, 2, 2
    v_lshl_add_u32 v23, v24, 3, v23
    v_lshrrev_b32 v24, 4, v22
    v_lshl_add_u32 v23, v24, 2, v23
    v_mad_u32_u24 v7, v23, s66, v21
    s_mov_b32 s24, s58
    s_mov_b32 s25, s59
    s_mov_b32 s26, 7340032
    s_mov_b32 s27, 0x20000
    s_mov_b32 s45, 229376
    v_add_u32 v21, 384, v1
    v_mul_u32_u24 v22, 4682, v21
    v_lshrrev_b32 v22, 16, v22
    v_mul_u32_u24 v23, 14, v22
    v_sub_u32 v21, v21, v23
    v_add_u32 v21, s64, v21
    v_subrev_u32 v23, 14, v21
    v_min_u32 v21, v21, v23
    v_lshl_add_u32 v21, v21, 4, s63
    v_and_b32 v23, 3, v22
    v_bfe_u32 v24, v22, 2, 2
    v_lshl_add_u32 v23, v24, 3, v23
    v_lshrrev_b32 v24, 4, v22
    v_lshl_add_u32 v23, v24, 2, v23
    v_mad_u32_u24 v8, v23, s66, v21
    s_mov_b32 s28, s58
    s_mov_b32 s29, s59
    s_mov_b32 s30, 7340032
    s_mov_b32 s31, 0x20000
    s_mov_b32 s46, 229376
L1_setdone:
    s_mov_b32 s8, s6
    s_mov_b32 s9, s7
    s_mov_b32 s10, 4194304
    s_mov_b32 s11, 0x20000
    s_add_u32 s96, s6, 33554432
    s_addc_u32 s97, s7, 0
    s_mov_b32 s98, 1048576
    s_mov_b32 s99, 0x20000
    v_lshrrev_b32 v131, 2, v129
    v_lshl_add_u32 v131, v20, 3, v131
    v_lshlrev_b32 v131, 17, v131
    v_and_b32 v132, 3, v129
    v_lshl_add_u32 v131, v132, 8, v131
    v_lshl_add_u32 v131, v128, 4, v131
    s_lshr_b32 s60, s53, 1
    s_lshl_b32 s60, s60, 10
    s_and_b32 s61, s53, 1
    s_lshl_b32 s61, s61, 7
    s_add_u32 s60, s60, s61
    v_add_u32 v131, s60, v131
    v_lshlrev_b32 v132, 5, v128
    v_add_u32 v132, 151552, v132
    v_lshl_add_u32 v133, v20, 3, v132
    s_mov_b32 s60, 0xffff0000
    s_mov_b32 s61, 262144
    s_mov_b32 s62, 524288
    s_mov_b32 s63, 786432
    v_mov_b32 v120, 0x43800000
    v_mov_b32 v121, 0x3727c5ac
    v_mov_b32 v122, 0x3a800000
    s_waitcnt vmcnt(0)
    buffer_load_dword v31, v19, s[88:91], s86 offen
    s_add_u32 s86, s86, s87
    buffer_load_dword v31, v19, s[88:91], s86 offen
    s_add_u32 s86, s86, s87
    buffer_load_dword v31, v19, s[88:91], s86 offen
    s_add_u32 s86, s86, s87
    buffer_load_dword v31, v19, s[88:91], s86 offen
    s_add_u32 s86, s86, s87
    v_lshlrev_b32 v48, 16, v32
    v_and_b32 v49, s60, v32
    v_lshlrev_b32 v50, 16, v33
    v_and_b32 v51, s60, v33
    v_lshlrev_b32 v52, 16, v34
    v_and_b32 v53, s60, v34
    v_lshlrev_b32 v54, 16, v35
    v_and_b32 v55, s60, v35
    v_lshlrev_b32 v56, 16, v36
    v_and_b32 v57, s60, v36
    v_lshlrev_b32 v58, 16, v37
    v_and_b32 v59, s60, v37
    v_lshlrev_b32 v60, 16, v38
    v_and_b32 v61, s60, v38
    v_lshlrev_b32 v62, 16, v39
    v_and_b32 v63, s60, v39
    v_lshlrev_b32 v64, 16, v40
    v_and_b32 v65, s60, v40
    v_lshlrev_b32 v66, 16, v41
    v_and_b32 v67, s60, v41
    v_lshlrev_b32 v68, 16, v42
    v_and_b32 v69, s60, v42
    v_lshlrev_b32 v70, 16, v43
    v_and_b32 v71, s60, v43
    v_lshlrev_b32 v72, 16, v44
    v_and_b32 v73, s60, v44
    v_lshlrev_b32 v74, 16, v45
    v_and_b32 v75, s60, v45
    v_lshlrev_b32 v76, 16, v46
    v_and_b32 v77, s60, v46
    v_lshlrev_b32 v78, 16, v47
    v_and_b32 v79, s60, v47
    v_pk_add_f32 v[80:81], v[48:49], v[50:51]
    v_pk_add_f32 v[82:83], v[52:53], v[54:55]
    v_pk_add_f32 v[84:85], v[56:57], v[58:59]
    v_pk_add_f32 v[86:87], v[60:61], v[62:63]
    v_pk_add_f32 v[88:89], v[64:65], v[66:67]
    v_pk_add_f32 v[90:91], v[68:69], v[70:71]
    v_pk_add_f32 v[92:93], v[72:73], v[74:75]
    v_pk_add_f32 v[94:95], v[76:77], v[78:79]
    v_pk_add_f32 v[80:81], v[80:81], v[88:89]
    v_pk_add_f32 v[82:83], v[82:83], v[90:91]
    v_pk_add_f32 v[84:85], v[84:85], v[92:93]
    v_pk_add_f32 v[86:87], v[86:87], v[94:95]
    v_pk_add_f32 v[80:81], v[80:81], v[84:85]
    v_pk_add_f32 v[82:83], v[82:83], v[86:87]
    v_pk_add_f32 v[80:81], v[80:81], v[82:83]
    v_add_f32 v80, v80, v81
    s_nop 1
    v_add_f32_dpp v80, v80, v80 quad_perm:[1,0,3,2] row_mask:0xf bank_mask:0xf
    s_nop 1
    v_add_f32_dpp v80, v80, v80 quad_perm:[2,3,0,1] row_mask:0xf bank_mask:0xf
    s_nop 1
    v_add_f32_dpp v80, v80, v80 row_half_mirror row_mask:0xf bank_mask:0xf
    v_mul_f32 v96, 0xbb800000, v80
    v_mov_b32 v97, v96
    v_pk_add_f32 v[48:49], v[48:49], v[96:97]
    v_pk_add_f32 v[50:51], v[50:51], v[96:97]
    v_pk_add_f32 v[52:53], v[52:53], v[96:97]
    v_pk_add_f32 v[54:55], v[54:55], v[96:97]
    v_pk_add_f32 v[56:57], v[56:57], v[96:97]
    v_pk_add_f32 v[58:59], v[58:59], v[96:97]
    v_pk_add_f32 v[60:61], v[60:61], v[96:97]
    v_pk_add_f32 v[62:63], v[62:63], v[96:97]
    v_pk_add_f32 v[64:65], v[64:65], v[96:97]
    v_pk_add_f32 v[66:67], v[66:67], v[96:97]
    v_pk_add_f32 v[68:69], v[68:69], v[96:97]
    v_pk_add_f32 v[70:71], v[70:71], v[96:97]
    v_pk_add_f32 v[72:73], v[72:73], v[96:97]
    v_pk_add_f32 v[74:75], v[74:75], v[96:97]
    v_pk_add_f32 v[76:77], v[76:77], v[96:97]
    v_pk_add_f32 v[78:79], v[78:79], v[96:97]
    v_pk_mul_f32 v[80:81], v[48:49], v[48:49]
    v_pk_mul_f32 v[82:83], v[52:53], v[52:53]
    v_pk_mul_f32 v[84:85], v[56:57], v[56:57]
    v_pk_mul_f32 v[86:87], v[60:61], v[60:61]
    v_pk_mul_f32 v[88:89], v[64:65], v[64:65]
    v_pk_mul_f32 v[90:91], v[68:69], v[68:69]
    v_pk_mul_f32 v[92:93], v[72:73], v[72:73]
    v_pk_mul_f32 v[94:95], v[76:77], v[76:77]
    v_pk_fma_f32 v[80:81], v[50:51], v[50:51], v[80:81]
    v_pk_fma_f32 v[82:83], v[54:55], v[54:55], v[82:83]
    v_pk_fma_f32 v[84:85], v[58:59], v[58:59], v[84:85]
    v_pk_fma_f32 v[86:87], v[62:63], v[62:63], v[86:87]
    v_pk_fma_f32 v[88:89], v[66:67], v[66:67], v[88:89]
    v_pk_fma_f32 v[90:91], v[70:71], v[70:71], v[90:91]
    v_pk_fma_f32 v[92:93], v[74:75], v[74:75], v[92:93]
    v_pk_fma_f32 v[94:95], v[78:79], v[78:79], v[94:95]
    v_pk_add_f32 v[80:81], v[80:81], v[88:89]
    v_pk_add_f32 v[82:83], v[82:83], v[90:91]
    v_pk_add_f32 v[84:85], v[84:85], v[92:93]
    v_pk_add_f32 v[86:87], v[86:87], v[94:95]
    v_pk_add_f32 v[80:81], v[80:81], v[84:85]
    v_pk_add_f32 v[82:83], v[82:83], v[86:87]
    v_pk_add_f32 v[80:81], v[80:81], v[82:83]
    v_add_f32 v97, v80, v81
    s_nop 1
    v_add_f32_dpp v97, v97, v97 quad_perm:[1,0,3,2] row_mask:0xf bank_mask:0xf
    s_nop 1
    v_add_f32_dpp v97, v97, v97 quad_perm:[2,3,0,1] row_mask:0xf bank_mask:0xf
    s_nop 1
    v_add_f32_dpp v97, v97, v97 row_half_mirror row_mask:0xf bank_mask:0xf
    ds_write_b64 v133, v[96:97]
    s_waitcnt lgkmcnt(0)
    s_barrier
    ds_read_b128 v[100:103], v132
    ds_read_b128 v[104:107], v132 offset:16
    s_waitcnt lgkmcnt(0)
    v_pk_add_f32 v[108:109], v[100:101], v[102:103]
    v_pk_add_f32 v[110:111], v[104:105], v[106:107]
    v_pk_add_f32 v[108:109], v[108:109], v[110:111]
    v_mul_f32 v108, 0x3e800000, v108
    v_sub_f32 v100, v100, v108
    v_sub_f32 v102, v102, v108
    v_sub_f32 v104, v104, v108
    v_sub_f32 v106, v106, v108
    v_mul_f32 v110, v100, v100
    v_mul_f32 v111, v102, v102
    v_fmac_f32 v110, v104, v104
    v_fmac_f32 v111, v106, v106
    v_add_f32 v110, v110, v111
    v_fmac_f32 v109, v110, v120
    v_fmac_f32 v121, v109, v122
    v_rsq_f32 v120, v121
    v_sub_f32 v122, v108, v96
    v_mov_b32 v121, v120
    v_mul_f32 v122, v122, v120
    v_mov_b32 v123, v122
    v_pk_fma_f32 v[48:49], v[48:49], v[120:121], v[122:123]
    v_pk_fma_f32 v[50:51], v[50:51], v[120:121], v[122:123]
    v_pk_fma_f32 v[52:53], v[52:53], v[120:121], v[122:123]
    v_pk_fma_f32 v[54:55], v[54:55], v[120:121], v[122:123]
    v_cvt_pk_bf16_f32 v32, v48, v49
    v_cvt_pk_bf16_f32 v33, v50, v51
    v_cvt_pk_bf16_f32 v34, v52, v53
    v_cvt_pk_bf16_f32 v35, v54, v55
    buffer_store_dwordx4 v[32:35], v131, s[8:11], 0 offen sc1
    v_pk_fma_f32 v[56:57], v[56:57], v[120:121], v[122:123]
    v_pk_fma_f32 v[58:59], v[58:59], v[120:121], v[122:123]
    v_pk_fma_f32 v[60:61], v[60:61], v[120:121], v[122:123]
    v_pk_fma_f32 v[62:63], v[62:63], v[120:121], v[122:123]
    v_cvt_pk_bf16_f32 v36, v56, v57
    v_cvt_pk_bf16_f32 v37, v58, v59
    v_cvt_pk_bf16_f32 v38, v60, v61
    v_cvt_pk_bf16_f32 v39, v62, v63
    buffer_store_dwordx4 v[36:39], v131, s[8:11], s61 offen sc1
    v_pk_fma_f32 v[64:65], v[64:65], v[120:121], v[122:123]
    v_pk_fma_f32 v[66:67], v[66:67], v[120:121], v[122:123]
    v_pk_fma_f32 v[68:69], v[68:69], v[120:121], v[122:123]
    v_pk_fma_f32 v[70:71], v[70:71], v[120:121], v[122:123]
    v_cvt_pk_bf16_f32 v40, v64, v65
    v_cvt_pk_bf16_f32 v41, v66, v67
    v_cvt_pk_bf16_f32 v42, v68, v69
    v_cvt_pk_bf16_f32 v43, v70, v71
    buffer_store_dwordx4 v[40:43], v131, s[8:11], s62 offen sc1
    v_pk_fma_f32 v[72:73], v[72:73], v[120:121], v[122:123]
    v_pk_fma_f32 v[74:75], v[74:75], v[120:121], v[122:123]
    v_pk_fma_f32 v[76:77], v[76:77], v[120:121], v[122:123]
    v_pk_fma_f32 v[78:79], v[78:79], v[120:121], v[122:123]
    v_cvt_pk_bf16_f32 v44, v72, v73
    v_cvt_pk_bf16_f32 v45, v74, v75
    v_cvt_pk_bf16_f32 v46, v76, v77
    v_cvt_pk_bf16_f32 v47, v78, v79
    buffer_store_dwordx4 v[44:47], v131, s[8:11], s63 offen sc1
    s_lshl_b32 s47, s51, 12
    s_mul_i32 s48, s51, 5120
    s_add_u32 s48, s48, 65536
    s_lshl_b32 s49, s51, 8
    s_add_u32 s49, s49, 147456
    s_mov_b32 s36, 0
    s_mov_b32 s37, 0
    s_mov_b32 s38, 0
    s_mov_b32 s39, 0
    s_mov_b32 s40, 0
    s_mov_b32 s41, 0
    s_add_u32 m0, s48, 0
    s_nop 0
    buffer_load_dwordx4 v4, s[12:15], s37 offen sc1 lds
    s_add_u32 s37, s37, s42
    s_add_u32 m0, s48, 1024
    s_nop 0
    buffer_load_dwordx4 v5, s[16:19], s38 offen sc1 lds
    s_add_u32 s38, s38, s43
    s_add_u32 m0, s48, 2048
    s_nop 0
    buffer_load_dwordx4 v6, s[20:23], s39 offen sc1 lds
    s_add_u32 s39, s39, s44
    s_add_u32 m0, s48, 3072
    s_nop 0
    buffer_load_dwordx4 v7, s[24:27], s40 offen sc1 lds
    s_add_u32 s40, s40, s45
    s_add_u32 m0, s48, 4096
    s_nop 0
    buffer_load_dwordx4 v8, s[28:31], s41 offen sc1 lds
    s_add_u32 s41, s41, s46
    s_add_u32 m0, s48, 20480
    s_nop 0
    buffer_load_dwordx4 v4, s[12:15], s37 offen sc1 lds
    s_add_u32 s37, s37, s42
    s_add_u32 m0, s48, 21504
    s_nop 0
    buffer_load_dwordx4 v5, s[16:19], s38 offen sc1 lds
    s_add_u32 s38, s38, s43
    s_add_u32 m0, s48, 22528
    s_nop 0
    buffer_load_dwordx4 v6, s[20:23], s39 offen sc1 lds
    s_add_u32 s39, s39, s44
    s_add_u32 m0, s48, 23552
    s_nop 0
    buffer_load_dwordx4 v7, s[24:27], s40 offen sc1 lds
    s_add_u32 s40, s40, s45
    s_add_u32 m0, s48, 24576
    s_nop 0
    buffer_load_dwordx4 v8, s[28:31], s41 offen sc1 lds
    s_add_u32 s41, s41, s46
    s_add_u32 s32, s6, 4194304
    s_addc_u32 s33, s7, 0
    s_mov_b32 s34, 18874368
    s_mov_b32 s35, 0x20000
    s_lshl_b32 s60, s54, 14
    s_lshl_b32 s61, s51, 12
    s_add_u32 s61, s61, s60
    v_lshl_add_u32 v2, v1, 4, s61
    s_max_u32 s60, s60, 1024
    s_sub_u32 s60, s60, 1024
    s_lshl_b32 s61, s51, 8
    s_add_u32 s61, s61, s60
    v_lshl_add_u32 v3, v1, 2, s61
    s_lshl_b32 s60, s54, 5
    s_sub_u32 s60, s60, 2
    v_min_u32 v134, 33, v1
    v_add_u32 v134, s60, v134
    v_max_i32 v134, 0, v134
    v_lshlrev_b32 v134, 7, v134
    v_add_u32 v134, 262144, v134
    s_lshl_b32 s60, s53, 7
    s_add_u32 s60, s60, 262144
    v_mov_b32 v135, s60
    s_add_u32 s60, s100, 2500
    v_mov_b32 v136, s60
    v_xor_b32 v137, s101, v136
    s_lshl_b32 s60, s52, 13
    v_lshl_add_u32 v9, v1, 4, s60
    v_lshlrev_b32 v10, 4, v1
    v_add_u32 v10, 147456, v10
    v_lshrrev_b32 v20, 2, v1
    v_and_b32 v21, 3, v1
    v_lshlrev_b32 v21, 3, v21
    v_add_u32 v21, 65536, v21
    v_mul_u32_u24 v22, 224, v20
    v_add_u32 v11, v22, v21
    v_add_u32 v12, 40960, v11
    v_mul_u32_u24 v22, 192, v20
    v_add_u32 v22, v22, v21
    v_lshlrev_b32 v20, 1, v1
    v_and_b32 v20, 32, v20
    v_add_u32 v13, v22, v20
    v_sub_u32 v15, v22, v20
    v_add_u32 v14, 40960, v13
    v_add_u32 v16, 40960, v15
    s_lshl_b32 s60, s51, 5
    s_add_u32 s60, s60, 64
    v_xor_b32 v20, s60, v20
    v_add_u32 v17, v22, v20
    v_add_u32 v18, 40960, v17
    s_mov_b32 s50, 0
    s_waitcnt vmcnt(10)
    s_barrier
    s_cmp_eq_u32 s51, 0
    s_cbranch_scc1 L1_pub
    s_cmp_eq_u32 s51, 2
    s_cbranch_scc1 L1_consts
    s_cmp_eq_u32 s51, 1
    s_cbranch_scc1 L1_wopf
    s_getpc_b64 s[94:95]
Lpc_L1_polled:
    s_add_u32 s94, s94, L1_polled-Lpc_L1_polled
    s_addc_u32 s95, s95, 0
    v_lshlrev_b32 v134, 7, v1
    v_min_u32 v134, L_end-L1_polled-4, v134
    global_load_dword v135, v134, s[94:95]
    v_lshlrev_b32 v134, 7, v1
    v_add_u32 v134, 8192, v134
    v_min_u32 v134, L_end-L1_polled-4, v134
    global_load_dword v135, v134, s[94:95]
    v_lshlrev_b32 v134, 7, v1
    v_add_u32 v134, 16384, v134
    v_min_u32 v134, L_end-L1_polled-4, v134
    global_load_dword v135, v134, s[94:95]
    v_lshlrev_b32 v134, 7, v1
    v_add_u32 v134, 24576, v134
    v_min_u32 v134, L_end-L1_polled-4, v134
    global_load_dword v135, v134, s[94:95]
    v_lshlrev_b32 v134, 7, v1
    v_add_u32 v134, 32768, v134
    v_min_u32 v134, L_end-L1_polled-4, v134
    global_load_dword v135, v134, s[94:95]
    v_lshlrev_b32 v134, 7, v1
    v_add_u32 v134, 40960, v134
    v_min_u32 v134, L_end-L1_polled-4, v134
    global_load_dword v135, v134, s[94:95]
    s_branch L1_consts
L1_wopf:
    s_mov_b32 s94, 0x200000
    s_mov_b32 s95, 0x20000
    s_lshl_b32 s60, s2, 13
    v_lshlrev_b32 v134, 7, v1
    buffer_load_dword v135, v134, s[92:95], s60 offen
    s_branch L1_consts
L1_pub:
    s_mov_b64 exec, 1
    buffer_store_dwordx2 v[136:137], v135, s[96:99], 0 offen sc1
    s_mov_b64 exec, -1
L1_consts:
    v_and_b32 v20, 15, v1
    v_lshrrev_b32 v21, 4, v1
    v_lshlrev_b32 v21, 2, v21
    v_sub_u32 v20, v20, v21
    v_mov_b32 v23, 0xf149f2ca
    s_or_b32 s60, s54, s52
    s_cmp_eq_u32 s60, 0
    s_cselect_b64 s[60:61], -1, 0
    v_add_u32 v21, 0, v20
    v_and_b32 v22, 0xfffffff1, v21
    v_cmp_eq_u32 vcc, 0, v22
    s_nop 1
    v_cndmask_b32_e64 v24, v23, 0, vcc
    v_accvgpr_write_b32 a200, v24
    v_add_u32 v21, -1, v20
    v_and_b32 v22, 0xfffffff1, v21
    v_cmp_eq_u32 vcc, 0, v22
    s_nop 1
    v_cndmask_b32_e64 v24, v23, 0, vcc
    v_accvgpr_write_b32 a201, v24
    v_add_u32 v21, -2, v20
    v_and_b32 v22, 0xfffffff1, v21
    v_cmp_eq_u32 vcc, 0, v22
    s_nop 1
    v_cndmask_b32_e64 v24, v23, 0, vcc
    v_accvgpr_write_b32 a202, v24
    v_add_u32 v21, -3, v20
    v_and_b32 v22, 0xfffffff1, v21
    v_cmp_eq_u32 vcc, 0, v22
    s_nop 1
    v_cndmask_b32_e64 v24, v23, 0, vcc
    v_accvgpr_write_b32 a203, v24
    v_add_u32 v21, 16, v20
    v_and_b32 v22, 0xfffffff1, v21
    v_cmp_eq_u32 vcc, 0, v22
    s_nop 1
    v_cndmask_b32_e64 v24, v23, 0, vcc
    v_accvgpr_write_b32 a204, v24
    v_cndmask_b32_e64 v24, v24, v23, s[60:61]
    v_accvgpr_write_b32 a208, v24
    v_add_u32 v21, 15, v20
    v_and_b32 v22, 0xfffffff1, v21
    v_cmp_eq_u32 vcc, 0, v22
    s_nop 1
    v_cndmask_b32_e64 v24, v23, 0, vcc
    v_accvgpr_write_b32 a205, v24
    v_cndmask_b32_e64 v24, v24, v23, s[60:61]
    v_accvgpr_write_b32 a209, v24
    v_add_u32 v21, 14, v20
    v_and_b32 v22, 0xfffffff1, v21
    v_cmp_eq_u32 vcc, 0, v22
    s_nop 1
    v_cndmask_b32_e64 v24, v23, 0, vcc
    v_accvgpr_write_b32 a206, v24
    v_cndmask_b32_e64 v24, v24, v23, s[60:61]
    v_accvgpr_write_b32 a210, v24
    v_add_u32 v21, 13, v20
    v_and_b32 v22, 0xfffffff1, v21
    v_cmp_eq_u32 vcc, 0, v22
    s_nop 1
    v_cndmask_b32_e64 v24, v23, 0, vcc
    v_accvgpr_write_b32 a207, v24
    v_cndmask_b32_e64 v24, v24, v23, s[60:61]
    v_accvgpr_write_b32 a211, v24
    v_mov_b32 v24, 0x3f803f80
    v_accvgpr_write_b32 a212, v24
    v_accvgpr_write_b32 a213, v24
    v_accvgpr_write_b32 a214, v24
    v_accvgpr_write_b32 a215, v24
    s_cmp_lg_u32 s51, 0
    s_cbranch_scc1 L1_polled
    s_mov_b32 s62, 0
L1_poll:
    buffer_load_dwordx2 v[138:139], v134, s[96:99], 0 offen sc1
    s_add_u32 s62, s62, 1
    s_waitcnt vmcnt(0)
    v_xor_b32 v139, v138, v139
    v_subrev_u32 v138, s100, v138
    v_lshrrev_b32 v138, 17, v138
    v_cmp_ne_u32 vcc, s101, v139
    v_cmp_ne_u32 s[60:61], 0, v138
    s_nop 1
    s_or_b64 exec, vcc, s[60:61]
    s_cbranch_execz L1_poll_done
    s_cmp_lt_u32 s62, 0x8000
    s_cbranch_scc1 L1_poll
L1_poll_done:
    s_mov_b64 exec, -1
L1_polled:
    s_barrier
    s_add_u32 m0, s47, 0
    s_nop 0
    buffer_load_dwordx4 v2, s[8:11], s36 offen offset:0 sc1 lds
    buffer_load_dwordx4 v2, s[8:11], s36 offen offset:1024 sc1 lds
    buffer_load_dwordx4 v2, s[8:11], s36 offen offset:2048 sc1 lds
    buffer_load_dwordx4 v2, s[8:11], s36 offen offset:3072 sc1 lds
    s_add_u32 m0, s49, 0
    s_nop 0
    buffer_load_dword v3, s[8:11], s36 offen sc1 lds
    s_add_u32 s36, s36, 131072
    s_add_u32 m0, s47, 16384
    s_nop 0
    buffer_load_dwordx4 v2, s[8:11], s36 offen offset:0 sc1 lds
    buffer_load_dwordx4 v2, s[8:11], s36 offen offset:1024 sc1 lds
    buffer_load_dwordx4 v2, s[8:11], s36 offen offset:2048 sc1 lds
    buffer_load_dwordx4 v2, s[8:11], s36 offen offset:3072 sc1 lds
    s_add_u32 m0, s49, 1024
    s_nop 0
    buffer_load_dword v3, s[8:11], s36 offen sc1 lds
    s_add_u32 s36, s36, 131072
    buffer_load_dword v31, v19, s[88:91], s86 offen
    s_add_u32 s86, s86, s87
    buffer_load_dword v31, v19, s[88:91], s86 offen
    s_add_u32 s86, s86, s87
    buffer_load_dword v31, v19, s[88:91], s86 offen
    s_add_u32 s86, s86, s87
    s_and_b32 s60, s51, 1
    s_cmp_eq_u32 s60, 1
    s_cbranch_scc1 L1_wn1
    s_waitcnt vmcnt(8)
    s_barrier
    ds_read_b64_tr_b16 a[220:221], v15 offset:160
    ds_read_b64_tr_b16 a[222:223], v15 offset:3232
    ds_read_b128 a[0:3], v9 offset:0
    ds_read_b128 a[4:7], v9 offset:1024
    ds_read_b128 a[8:11], v9 offset:2048
    ds_read_b128 a[12:15], v9 offset:3072
    ds_read_b128 a[16:19], v9 offset:4096
    ds_read_b128 a[20:23], v9 offset:5120
    ds_read_b128 a[24:27], v9 offset:6144
    ds_read_b128 a[28:31], v9 offset:7168
    ds_read_b128 a[64:67], v10 offset:0
    ds_read_b64_tr_b16 a[88:89], v17 offset:0
    ds_read_b64_tr_b16 a[90:91], v17 offset:3072
    s_waitcnt lgkmcnt(10)
    v_mfma_f32_16x16x32_bf16 v[224:227], a[0:3], a[220:223], 0
    ds_read_b64_tr_b16 a[228:229], v11 offset:6144
    s_waitcnt lgkmcnt(10)
    v_mfma_f32_16x16x32_bf16 v[228:231], a[4:7], a[220:223], 0
    ds_read_b64_tr_b16 a[230:231], v11 offset:9728
    s_add_u32 m0, s47, 32768
    s_waitcnt lgkmcnt(10)
    v_mfma_f32_16x16x32_bf16 v[232:235], a[8:11], a[220:223], 0
    buffer_load_dwordx4 v2, s[8:11], s36 offen offset:0 sc1 lds
    buffer_load_dwordx4 v2, s[8:11], s36 offen offset:1024 sc1 lds
    s_waitcnt lgkmcnt(9)
    v_mfma_f32_16x16x32_bf16 v[236:239], a[12:15], a[220:223], 0
    buffer_load_dwordx4 v2, s[8:11], s36 offen offset:2048 sc1 lds
    buffer_load_dwordx4 v2, s[8:11], s36 offen offset:3072 sc1 lds
    s_waitcnt lgkmcnt(8)
    v_mfma_f32_16x16x32_bf16 v[240:243], a[16:19], a[220:223], 0
    s_add_u32 m0, s49, 2048
    s_waitcnt lgkmcnt(7)
    v_mfma_f32_16x16x32_bf16 v[244:247], a[20:23], a[220:223], 0
    buffer_load_dword v3, s[8:11], s36 offen sc1 lds
    s_add_u32 s36, s36, 131072
    s_waitcnt lgkmcnt(6)
    v_mfma_f32_16x16x32_bf16 v[248:251], a[24:27], a[220:223], 0
    s_add_u32 m0, s48, 40960
    s_waitcnt lgkmcnt(5)
    v_mfma_f32_16x16x32_bf16 v[252:255], a[28:31], a[220:223], 0
    buffer_load_dwordx4 v4, s[12:15], s37 offen sc1 lds
    s_add_u32 s37, s37, s42
    s_waitcnt lgkmcnt(0)
    v_mfma_f32_16x16x32_bf16 v[32:35], a[228:231], a[0:3], 0
    ds_read_b64_tr_b16 a[236:237], v11 offset:6176
    s_add_u32 m0, s48, 41984
    v_mfma_f32_16x16x32_bf16 v[36:39], a[228:231], a[4:7], 0
    ds_read_b64_tr_b16 a[238:239], v11 offset:9760
    buffer_load_dwordx4 v5, s[16:19], s38 offen sc1 lds
    v_mfma_f32_16x16x32_bf16 v[40:43], a[228:231], a[8:11], 0
    s_add_u32 s38, s38, s43
    s_add_u32 m0, s48, 43008
    v_mfma_f32_16x16x32_bf16 v[44:47], a[228:231], a[12:15], 0
    buffer_load_dwordx4 v6, s[20:23], s39 offen sc1 lds
    s_add_u32 s39, s39, s44
    v_mfma_f32_16x16x32_bf16 v[48:51], a[228:231], a[16:19], 0
    s_add_u32 m0, s48, 44032
    v_mfma_f32_16x16x32_bf16 v[52:55], a[228:231], a[20:23], 0
    buffer_load_dwordx4 v7, s[24:27], s40 offen sc1 lds
    s_add_u32 s40, s40, s45
    v_mfma_f32_16x16x32_bf16 a[192:195], a[88:91], a[64:67], 0
    v_mfma_f32_16x16x32_bf16 v[56:59], a[228:231], a[24:27], 0
    s_add_u32 m0, s48, 45056
    v_mfma_f32_16x16x32_bf16 v[60:63], a[228:231], a[28:31], 0
    buffer_load_dwordx4 v8, s[28:31], s41 offen sc1 lds
    s_add_u32 s41, s41, s46
    s_waitcnt lgkmcnt(0)
    v_mfma_f32_16x16x32_bf16 v[64:67], a[236:239], a[0:3], 0
    ds_read_b64_tr_b16 a[244:245], v11 offset:13312
    buffer_load_dword v31, v19, s[88:91], s86 offen
    v_mfma_f32_16x16x32_bf16 v[68:71], a[236:239], a[4:7], 0
    ds_read_b64_tr_b16 a[246:247], v11 offset:16896
    s_add_u32 s86, s86, s87
    v_mfma_f32_16x16x32_bf16 v[72:75], a[236:239], a[8:11], 0
    ds_read_b64_tr_b16 a[220:221], v11 offset:13344
    v_mfma_f32_16x16x32_bf16 v[76:79], a[236:239], a[12:15], 0
    ds_read_b64_tr_b16 a[222:223], v11 offset:16928
    v_mfma_f32_16x16x32_bf16 v[80:83], a[236:239], a[16:19], 0
    v_mfma_f32_16x16x32_bf16 v[84:87], a[236:239], a[20:23], 0
    v_mfma_f32_16x16x32_bf16 v[88:91], a[236:239], a[24:27], 0
    v_mfma_f32_16x16x32_bf16 v[92:95], a[236:239], a[28:31], 0
    s_waitcnt vmcnt(14) lgkmcnt(0)
    s_barrier
    v_mfma_f32_16x16x32_bf16 v[96:99], a[244:247], a[0:3], 0
    ds_read_b128 a[32:35], v9 offset:16384
    v_mfma_f32_16x16x32_bf16 a[160:163], a[220:223], a[0:3], 0
    ds_read_b64_tr_b16 a[224:225], v13 offset:0
    v_mfma_f32_16x16x32_bf16 v[100:103], a[244:247], a[4:7], 0
    ds_read_b128 a[36:39], v9 offset:17408
    v_mfma_f32_16x16x32_bf16 a[164:167], a[220:223], a[4:7], 0
    ds_read_b64_tr_b16 a[226:227], v13 offset:3072
    v_mfma_f32_16x16x32_bf16 v[104:107], a[244:247], a[8:11], 0
    ds_read_b128 a[40:43], v9 offset:18432
    v_mfma_f32_16x16x32_bf16 a[168:171], a[220:223], a[8:11], 0
    ds_read_b64_tr_b16 a[228:229], v13 offset:20480
    v_mfma_f32_16x16x32_bf16 v[108:111], a[244:247], a[12:15], 0
    ds_read_b128 a[44:47], v9 offset:19456
    v_mfma_f32_16x16x32_bf16 a[172:175], a[220:223], a[12:15], 0
    ds_read_b64_tr_b16 a[230:231], v13 offset:23552
    v_mfma_f32_16x16x32_bf16 v[112:115], a[244:247], a[16:19], 0
    ds_read_b128 a[48:51], v9 offset:20480
    v_mfma_f32_16x16x32_bf16 a[176:179], a[220:223], a[16:19], 0
    ds_read_b128 a[64:67], v10 offset:1024
    v_mfma_f32_16x16x32_bf16 v[116:119], a[244:247], a[20:23], 0
    ds_read_b128 a[52:55], v9 offset:21504
    v_mfma_f32_16x16x32_bf16 a[180:183], a[220:223], a[20:23], 0
    ds_read_b64_tr_b16 a[88:89], v17 offset:20480
    v_mfma_f32_16x16x32_bf16 v[120:123], a[244:247], a[24:27], 0
    ds_read_b128 a[56:59], v9 offset:22528
    v_mfma_f32_16x16x32_bf16 a[184:187], a[220:223], a[24:27], 0
    ds_read_b64_tr_b16 a[90:91], v17 offset:23552
    v_mfma_f32_16x16x32_bf16 v[124:127], a[244:247], a[28:31], 0
    ds_read_b128 a[60:63], v9 offset:23552
    v_mfma_f32_16x16x32_bf16 a[188:191], a[220:223], a[28:31], 0
    s_add_u32 m0, s47, 49152
    s_waitcnt lgkmcnt(11)
    v_mfma_f32_16x16x32_bf16 v[128:131], a[224:227], a[0:3], 0
    ds_read_b64_tr_b16 a[232:233], v15 offset:32
    s_waitcnt lgkmcnt(8)
    v_mfma_f32_16x16x32_bf16 v[128:131], a[228:231], a[32:35], v[128:131]
    ds_read_b64_tr_b16 a[234:235], v15 offset:3104
    v_mfma_f32_16x16x32_bf16 v[132:135], a[224:227], a[4:7], 0
    ds_read_b64_tr_b16 a[236:237], v15 offset:20512
    v_mfma_f32_16x16x32_bf16 v[132:135], a[228:231], a[36:39], v[132:135]
    ds_read_b64_tr_b16 a[238:239], v15 offset:23584
    v_mfma_f32_16x16x32_bf16 v[136:139], a[224:227], a[8:11], 0
    buffer_load_dwordx4 v2, s[8:11], s36 offen offset:0 sc1 lds
    v_mfma_f32_16x16x32_bf16 v[136:139], a[228:231], a[40:43], v[136:139]
    v_mfma_f32_16x16x32_bf16 v[140:143], a[224:227], a[12:15], 0
    buffer_load_dwordx4 v2, s[8:11], s36 offen offset:1024 sc1 lds
    v_mfma_f32_16x16x32_bf16 v[140:143], a[228:231], a[44:47], v[140:143]
    v_mfma_f32_16x16x32_bf16 v[144:147], a[224:227], a[16:19], 0
    buffer_load_dwordx4 v2, s[8:11], s36 offen offset:2048 sc1 lds
    s_waitcnt lgkmcnt(10)
    v_mfma_f32_16x16x32_bf16 v[144:147], a[228:231], a[48:51], v[144:147]
    v_mfma_f32_16x16x32_bf16 v[148:151], a[224:227], a[20:23], 0
    buffer_load_dwordx4 v2, s[8:11], s36 offen offset:3072 sc1 lds
    s_waitcnt lgkmcnt(8)
    v_mfma_f32_16x16x32_bf16 v[148:151], a[228:231], a[52:55], v[148:151]
    s_add_u32 m0, s49, 3072
    v_mfma_f32_16x16x32_bf16 v[152:155], a[224:227], a[24:27], 0
    buffer_load_dword v3, s[8:11], s36 offen sc1 lds
    s_waitcnt lgkmcnt(6)
    v_mfma_f32_16x16x32_bf16 v[152:155], a[228:231], a[56:59], v[152:155]
    s_add_u32 s36, s36, 131072
    v_mfma_f32_16x16x32_bf16 v[156:159], a[224:227], a[28:31], 0
    s_add_u32 m0, s48, 61440
    s_waitcnt lgkmcnt(4)
    v_mfma_f32_16x16x32_bf16 v[156:159], a[228:231], a[60:63], v[156:159]
    buffer_load_dwordx4 v4, s[12:15], s37 offen sc1 lds
    s_waitcnt lgkmcnt(0)
    v_mfma_f32_16x16x32_bf16 a[96:99], a[232:235], a[0:3], 0
    ds_read_b64_tr_b16 a[240:241], v13 offset:64
    v_mfma_f32_16x16x32_bf16 a[96:99], a[236:239], a[32:35], a[96:99]
    ds_read_b64_tr_b16 a[242:243], v13 offset:3136
    v_mfma_f32_16x16x32_bf16 a[100:103], a[232:235], a[4:7], 0
    ds_read_b64_tr_b16 a[244:245], v13 offset:20544
    v_mfma_f32_16x16x32_bf16 a[100:103], a[236:239], a[36:39], a[100:103]
    ds_read_b64_tr_b16 a[246:247], v13 offset:23616
    v_mfma_f32_16x16x32_bf16 a[104:107], a[232:235], a[8:11], 0
    s_add_u32 s37, s37, s42
    v_mfma_f32_16x16x32_bf16 a[104:107], a[236:239], a[40:43], a[104:107]
    s_add_u32 m0, s48, 62464
    v_mfma_f32_16x16x32_bf16 a[192:195], a[88:91], a[64:67], a[192:195]
    v_mfma_f32_16x16x32_bf16 a[108:111], a[232:235], a[12:15], 0
    buffer_load_dwordx4 v5, s[16:19], s38 offen sc1 lds
    v_mfma_f32_16x16x32_bf16 a[108:111], a[236:239], a[44:47], a[108:111]
    s_add_u32 s38, s38, s43
    v_mfma_f32_16x16x32_bf16 a[112:115], a[232:235], a[16:19], 0
    s_add_u32 m0, s48, 63488
    v_mfma_f32_16x16x32_bf16 a[112:115], a[236:239], a[48:51], a[112:115]
    buffer_load_dwordx4 v6, s[20:23], s39 offen sc1 lds
    v_mfma_f32_16x16x32_bf16 a[116:119], a[232:235], a[20:23], 0
    s_add_u32 s39, s39, s44
    v_mfma_f32_16x16x32_bf16 a[116:119], a[236:239], a[52:55], a[116:119]
    s_add_u32 m0, s48, 64512
    v_mfma_f32_16x16x32_bf16 a[120:123], a[232:235], a[24:27], 0
    buffer_load_dwordx4 v7, s[24:27], s40 offen sc1 lds
    v_mfma_f32_16x16x32_bf16 a[120:123], a[236:239], a[56:59], a[120:123]
    s_add_u32 s40, s40, s45
    v_mfma_f32_16x16x32_bf16 a[124:127], a[232:235], a[28:31], 0
    s_add_u32 m0, s48, 65536
    v_mfma_f32_16x16x32_bf16 a[124:127], a[236:239], a[60:63], a[124:127]
    buffer_load_dwordx4 v8, s[28:31], s41 offen sc1 lds
    s_waitcnt lgkmcnt(0)
    v_mfma_f32_16x16x32_bf16 v[160:163], a[240:243], a[0:3], 0
    ds_read_b64_tr_b16 a[216:217], v15 offset:96
    v_mfma_f32_16x16x32_bf16 v[160:163], a[244:247], a[32:35], v[160:163]
    ds_read_b64_tr_b16 a[218:219], v15 offset:3168
    v_mfma_f32_16x16x32_bf16 v[164:167], a[240:243], a[4:7], 0
    ds_read_b64_tr_b16 a[220:221], v15 offset:20576
    v_mfma_f32_16x16x32_bf16 v[164:167], a[244:247], a[36:39], v[164:167]
    ds_read_b64_tr_b16 a[222:223], v15 offset:23648
    v_mfma_f32_16x16x32_bf16 v[168:171], a[240:243], a[8:11], 0
    ds_read_b64_tr_b16 a[224:225], v13 offset:128
    v_mfma_f32_16x16x32_bf16 v[168:171], a[244:247], a[40:43], v[168:171]
    ds_read_b64_tr_b16 a[226:227], v13 offset:3200
    v_mfma_f32_16x16x32_bf16 v[172:175], a[240:243], a[12:15], 0
    ds_read_b64_tr_b16 a[228:229], v13 offset:20608
    v_mfma_f32_16x16x32_bf16 v[172:175], a[244:247], a[44:47], v[172:175]
    ds_read_b64_tr_b16 a[230:231], v13 offset:23680
    v_mfma_f32_16x16x32_bf16 v[176:179], a[240:243], a[16:19], 0
    s_add_u32 s41, s41, s46
    v_mfma_f32_16x16x32_bf16 v[176:179], a[244:247], a[48:51], v[176:179]
    buffer_load_dword v31, v19, s[88:91], s86 offen
    v_mfma_f32_16x16x32_bf16 v[180:183], a[240:243], a[20:23], 0
    s_add_u32 s86, s86, s87
    v_mfma_f32_16x16x32_bf16 v[180:183], a[244:247], a[52:55], v[180:183]
    v_mfma_f32_16x16x32_bf16 v[184:187], a[240:243], a[24:27], 0
    v_mfma_f32_16x16x32_bf16 v[184:187], a[244:247], a[56:59], v[184:187]
    v_mfma_f32_16x16x32_bf16 v[188:191], a[240:243], a[28:31], 0
    v_mfma_f32_16x16x32_bf16 v[188:191], a[244:247], a[60:63], v[188:191]
    s_waitcnt vmcnt(12) lgkmcnt(0)
    s_barrier
    v_mfma_f32_16x16x32_bf16 a[128:131], a[216:219], a[0:3], 0
    ds_read_b64_tr_b16 a[232:233], v15 offset:20640
    v_mfma_f32_16x16x32_bf16 a[128:131], a[220:223], a[32:35], a[128:131]
    s_add_u32 m0, s47, 0
    v_mfma_f32_16x16x32_bf16 v[192:195], a[0:3], a[224:227], 0
    ds_read_b128 a[0:3], v9 offset:32768
    v_mfma_f32_16x16x32_bf16 v[192:195], a[32:35], a[228:231], v[192:195]
    buffer_load_dwordx4 v2, s[8:11], s36 offen offset:0 sc1 lds
    v_mfma_f32_16x16x32_bf16 a[132:135], a[216:219], a[4:7], 0
    ds_read_b64_tr_b16 a[234:235], v15 offset:23712
    v_mfma_f32_16x16x32_bf16 a[132:135], a[220:223], a[36:39], a[132:135]
    v_mfma_f32_16x16x32_bf16 v[196:199], a[4:7], a[224:227], 0
    ds_read_b128 a[4:7], v9 offset:33792
    v_mfma_f32_16x16x32_bf16 v[196:199], a[36:39], a[228:231], v[196:199]
    buffer_load_dwordx4 v2, s[8:11], s36 offen offset:1024 sc1 lds
    v_mfma_f32_16x16x32_bf16 a[136:139], a[216:219], a[8:11], 0
    ds_read_b64_tr_b16 a[236:237], v16 offset:160
    v_mfma_f32_16x16x32_bf16 a[136:139], a[220:223], a[40:43], a[136:139]
    v_mfma_f32_16x16x32_bf16 v[200:203], a[8:11], a[224:227], 0
    ds_read_b128 a[8:11], v9 offset:34816
    v_mfma_f32_16x16x32_bf16 v[200:203], a[40:43], a[228:231], v[200:203]
    buffer_load_dwordx4 v2, s[8:11], s36 offen offset:2048 sc1 lds
    v_mfma_f32_16x16x32_bf16 a[140:143], a[216:219], a[12:15], 0
    ds_read_b64_tr_b16 a[238:239], v16 offset:3232
    v_mfma_f32_16x16x32_bf16 a[140:143], a[220:223], a[44:47], a[140:143]
    v_mfma_f32_16x16x32_bf16 v[204:207], a[12:15], a[224:227], 0
    ds_read_b128 a[12:15], v9 offset:35840
    v_mfma_f32_16x16x32_bf16 v[204:207], a[44:47], a[228:231], v[204:207]
    buffer_load_dwordx4 v2, s[8:11], s36 offen offset:3072 sc1 lds
    v_mfma_f32_16x16x32_bf16 a[144:147], a[216:219], a[16:19], 0
    ds_read_b128 a[64:67], v10 offset:2048
    v_mfma_f32_16x16x32_bf16 a[144:147], a[220:223], a[48:51], a[144:147]
    s_add_u32 m0, s49, 0
    v_mfma_f32_16x16x32_bf16 v[208:211], a[16:19], a[224:227], 0
    ds_read_b128 a[16:19], v9 offset:36864
    v_mfma_f32_16x16x32_bf16 v[208:211], a[48:51], a[228:231], v[208:211]
    buffer_load_dword v3, s[8:11], s36 offen sc1 lds
    v_mfma_f32_16x16x32_bf16 a[148:151], a[216:219], a[20:23], 0
    ds_read_b64_tr_b16 a[88:89], v18 offset:0
    v_mfma_f32_16x16x32_bf16 a[148:151], a[220:223], a[52:55], a[148:151]
    s_add_u32 s36, s36, 131072
    v_mfma_f32_16x16x32_bf16 v[212:215], a[20:23], a[224:227], 0
    ds_read_b128 a[20:23], v9 offset:37888
    v_mfma_f32_16x16x32_bf16 v[212:215], a[52:55], a[228:231], v[212:215]
    s_add_u32 m0, s48, 0
    v_mfma_f32_16x16x32_bf16 a[152:155], a[216:219], a[24:27], 0
    ds_read_b64_tr_b16 a[90:91], v18 offset:3072
    v_mfma_f32_16x16x32_bf16 a[152:155], a[220:223], a[56:59], a[152:155]
    buffer_load_dwordx4 v4, s[12:15], s37 offen sc1 lds
    v_mfma_f32_16x16x32_bf16 v[216:219], a[24:27], a[224:227], 0
    ds_read_b128 a[24:27], v9 offset:38912
    v_mfma_f32_16x16x32_bf16 v[216:219], a[56:59], a[228:231], v[216:219]
    s_add_u32 s37, s37, s42
    v_mfma_f32_16x16x32_bf16 a[156:159], a[216:219], a[28:31], 0
    s_add_u32 m0, s48, 1024
    v_mfma_f32_16x16x32_bf16 a[156:159], a[220:223], a[60:63], a[156:159]
    buffer_load_dwordx4 v5, s[16:19], s38 offen sc1 lds
    v_mfma_f32_16x16x32_bf16 v[220:223], a[28:31], a[224:227], 0
    ds_read_b128 a[28:31], v9 offset:39936
    v_mfma_f32_16x16x32_bf16 v[220:223], a[60:63], a[228:231], v[220:223]
    s_add_u32 s38, s38, s43
L1_loop0:
    s_waitcnt lgkmcnt(12)
    v_mfma_f32_16x16x32_bf16 v[224:227], a[32:35], a[232:235], v[224:227]
    ds_read_b64_tr_b16 a[240:241], v11 offset:26624
    s_waitcnt lgkmcnt(9)
    v_mfma_f32_16x16x32_bf16 v[224:227], a[0:3], a[236:239], v[224:227]
    ds_read_b64_tr_b16 a[242:243], v11 offset:30208
    v_mfma_f32_16x16x32_bf16 v[228:231], a[36:39], a[232:235], v[228:231]
    ds_read_b64_tr_b16 a[244:245], v12 offset:6144
    v_mfma_f32_16x16x32_bf16 v[228:231], a[4:7], a[236:239], v[228:231]
    ds_read_b64_tr_b16 a[246:247], v12 offset:9728
    v_mfma_f32_16x16x32_bf16 v[232:235], a[40:43], a[232:235], v[232:235]
    s_add_u32 m0, s48, 2048
    v_mfma_f32_16x16x32_bf16 v[232:235], a[8:11], a[236:239], v[232:235]
    buffer_load_dwordx4 v6, s[20:23], s39 offen sc1 lds
    v_mfma_f32_16x16x32_bf16 v[236:239], a[44:47], a[232:235], v[236:239]
    s_add_u32 s39, s39, s44
    s_waitcnt lgkmcnt(11)
    v_mfma_f32_16x16x32_bf16 v[236:239], a[12:15], a[236:239], v[236:239]
    s_add_u32 m0, s48, 3072
    v_mfma_f32_16x16x32_bf16 v[240:243], a[48:51], a[232:235], v[240:243]
    s_waitcnt lgkmcnt(9)
    v_mfma_f32_16x16x32_bf16 v[240:243], a[16:19], a[236:239], v[240:243]
    buffer_load_dwordx4 v7, s[24:27], s40 offen sc1 lds
    v_mfma_f32_16x16x32_bf16 v[244:247], a[52:55], a[232:235], v[244:247]
    s_add_u32 s40, s40, s45
    s_waitcnt lgkmcnt(7)
    v_mfma_f32_16x16x32_bf16 v[244:247], a[20:23], a[236:239], v[244:247]
    s_add_u32 m0, s48, 4096
    v_mfma_f32_16x16x32_bf16 v[248:251], a[56:59], a[232:235], v[248:251]
    s_waitcnt lgkmcnt(5)
    v_mfma_f32_16x16x32_bf16 v[248:251], a[24:27], a[236:239], v[248:251]
    buffer_load_dwordx4 v8, s[28:31], s41 offen sc1 lds
    v_mfma_f32_16x16x32_bf16 v[252:255], a[60:63], a[232:235], v[252:255]
    s_add_u32 s41, s41, s46
    s_waitcnt lgkmcnt(4)
    v_mfma_f32_16x16x32_bf16 v[252:255], a[28:31], a[236:239], v[252:255]
    s_waitcnt lgkmcnt(0)
    v_mfma_f32_16x16x32_bf16 v[32:35], a[240:243], a[32:35], v[32:35]
    ds_read_b64_tr_b16 a[216:217], v11 offset:26656
    v_mfma_f32_16x16x32_bf16 v[32:35], a[244:247], a[0:3], v[32:35]
    ds_read_b64_tr_b16 a[218:219], v11 offset:30240
    v_mfma_f32_16x16x32_bf16 v[36:39], a[240:243], a[36:39], v[36:39]
    ds_read_b64_tr_b16 a[220:221], v12 offset:6176
    v_mfma_f32_16x16x32_bf16 v[36:39], a[244:247], a[4:7], v[36:39]
    ds_read_b64_tr_b16 a[222:223], v12 offset:9760
    v_mfma_f32_16x16x32_bf16 v[40:43], a[240:243], a[40:43], v[40:43]
    buffer_load_dword v31, v19, s[88:91], s86 offen
    v_mfma_f32_16x16x32_bf16 v[40:43], a[244:247], a[8:11], v[40:43]
    s_add_u32 s86, s86, s87
    v_mfma_f32_16x16x32_bf16 a[192:195], a[88:91], a[64:67], a[192:195]
    v_mfma_f32_16x16x32_bf16 v[44:47], a[240:243], a[44:47], v[44:47]
    v_mfma_f32_16x16x32_bf16 v[44:47], a[244:247], a[12:15], v[44:47]
    v_mfma_f32_16x16x32_bf16 v[48:51], a[240:243], a[48:51], v[48:51]
    v_mfma_f32_16x16x32_bf16 v[48:51], a[244:247], a[16:19], v[48:51]
    v_mfma_f32_16x16x32_bf16 v[52:55], a[240:243], a[52:55], v[52:55]
    v_mfma_f32_16x16x32_bf16 v[52:55], a[244:247], a[20:23], v[52:55]
    v_mfma_f32_16x16x32_bf16 v[56:59], a[240:243], a[56:59], v[56:59]
    v_mfma_f32_16x16x32_bf16 v[56:59], a[244:247], a[24:27], v[56:59]
    v_mfma_f32_16x16x32_bf16 v[60:63], a[240:243], a[60:63], v[60:63]
    v_mfma_f32_16x16x32_bf16 v[60:63], a[244:247], a[28:31], v[60:63]
    s_waitcnt lgkmcnt(0)
    v_mfma_f32_16x16x32_bf16 v[64:67], a[216:219], a[32:35], v[64:67]
    ds_read_b64_tr_b16 a[224:225], v11 offset:33792
    v_mfma_f32_16x16x32_bf16 v[64:67], a[220:223], a[0:3], v[64:67]
    ds_read_b64_tr_b16 a[226:227], v11 offset:37376
    v_mfma_f32_16x16x32_bf16 v[68:71], a[216:219], a[36:39], v[68:71]
    ds_read_b64_tr_b16 a[228:229], v12 offset:13312
    v_mfma_f32_16x16x32_bf16 v[68:71], a[220:223], a[4:7], v[68:71]
    ds_read_b64_tr_b16 a[230:231], v12 offset:16896
    v_mfma_f32_16x16x32_bf16 v[72:75], a[216:219], a[40:43], v[72:75]
    ds_read_b64_tr_b16 a[232:233], v11 offset:33824
    v_mfma_f32_16x16x32_bf16 v[72:75], a[220:223], a[8:11], v[72:75]
    ds_read_b64_tr_b16 a[234:235], v11 offset:37408
    v_mfma_f32_16x16x32_bf16 v[76:79], a[216:219], a[44:47], v[76:79]
    ds_read_b64_tr_b16 a[236:237], v12 offset:13344
    v_mfma_f32_16x16x32_bf16 v[76:79], a[220:223], a[12:15], v[76:79]
    ds_read_b64_tr_b16 a[238:239], v12 offset:16928
    v_mfma_f32_16x16x32_bf16 v[80:83], a[216:219], a[48:51], v[80:83]
    v_mfma_f32_16x16x32_bf16 v[80:83], a[220:223], a[16:19], v[80:83]
    v_mfma_f32_16x16x32_bf16 v[84:87], a[216:219], a[52:55], v[84:87]
    v_mfma_f32_16x16x32_bf16 v[84:87], a[220:223], a[20:23], v[84:87]
    v_mfma_f32_16x16x32_bf16 v[88:91], a[216:219], a[56:59], v[88:91]
    v_mfma_f32_16x16x32_bf16 v[88:91], a[220:223], a[24:27], v[88:91]
    v_mfma_f32_16x16x32_bf16 v[92:95], a[216:219], a[60:63], v[92:95]
    v_mfma_f32_16x16x32_bf16 v[92:95], a[220:223], a[28:31], v[92:95]
    s_waitcnt vmcnt(12) lgkmcnt(0)
    s_barrier
    v_mfma_f32_16x16x32_bf16 v[96:99], a[224:227], a[32:35], v[96:99]
    ds_read_b64_tr_b16 a[240:241], v14 offset:0
    v_mfma_f32_16x16x32_bf16 v[96:99], a[228:231], a[0:3], v[96:99]
    s_add_u32 m0, s47, 16384
    v_mfma_f32_16x16x32_bf16 a[160:163], a[232:235], a[32:35], a[160:163]
    ds_read_b128 a[32:35], v9 offset:49152
    v_mfma_f32_16x16x32_bf16 a[160:163], a[236:239], a[0:3], a[160:163]
    buffer_load_dwordx4 v2, s[8:11], s36 offen offset:0 sc1 lds
    v_mfma_f32_16x16x32_bf16 v[100:103], a[224:227], a[36:39], v[100:103]
    ds_read_b64_tr_b16 a[242:243], v14 offset:3072
    v_mfma_f32_16x16x32_bf16 v[100:103], a[228:231], a[4:7], v[100:103]
    v_mfma_f32_16x16x32_bf16 a[164:167], a[232:235], a[36:39], a[164:167]
    ds_read_b128 a[36:39], v9 offset:50176
    v_mfma_f32_16x16x32_bf16 a[164:167], a[236:239], a[4:7], a[164:167]
    buffer_load_dwordx4 v2, s[8:11], s36 offen offset:1024 sc1 lds
    v_mfma_f32_16x16x32_bf16 v[104:107], a[224:227], a[40:43], v[104:107]
    ds_read_b64_tr_b16 a[244:245], v14 offset:20480
    v_mfma_f32_16x16x32_bf16 v[104:107], a[228:231], a[8:11], v[104:107]
    v_mfma_f32_16x16x32_bf16 a[168:171], a[232:235], a[40:43], a[168:171]
    ds_read_b128 a[40:43], v9 offset:51200
    v_mfma_f32_16x16x32_bf16 a[168:171], a[236:239], a[8:11], a[168:171]
    buffer_load_dwordx4 v2, s[8:11], s36 offen offset:2048 sc1 lds
    v_mfma_f32_16x16x32_bf16 v[108:111], a[224:227], a[44:47], v[108:111]
    ds_read_b64_tr_b16 a[246:247], v14 offset:23552
    v_mfma_f32_16x16x32_bf16 v[108:111], a[228:231], a[12:15], v[108:111]
    v_mfma_f32_16x16x32_bf16 a[172:175], a[232:235], a[44:47], a[172:175]
    ds_read_b128 a[44:47], v9 offset:52224
    v_mfma_f32_16x16x32_bf16 a[172:175], a[236:239], a[12:15], a[172:175]
    buffer_load_dwordx4 v2, s[8:11], s36 offen offset:3072 sc1 lds
    v_mfma_f32_16x16x32_bf16 v[112:115], a[224:227], a[48:51], v[112:115]
    ds_read_b128 a[64:67], v10 offset:3072
    v_mfma_f32_16x16x32_bf16 v[112:115], a[228:231], a[16:19], v[112:115]
    s_add_u32 m0, s49, 1024
    v_mfma_f32_16x16x32_bf16 a[176:179], a[232:235], a[48:51], a[176:179]
    ds_read_b128 a[48:51], v9 offset:53248
    v_mfma_f32_16x16x32_bf16 a[176:179], a[236:239], a[16:19], a[176:179]
    buffer_load_dword v3, s[8:11], s36 offen sc1 lds
    v_mfma_f32_16x16x32_bf16 v[116:119], a[224:227], a[52:55], v[116:119]
    ds_read_b64_tr_b16 a[88:89], v18 offset:20480
    v_mfma_f32_16x16x32_bf16 v[116:119], a[228:231], a[20:23], v[116:119]
    s_add_u32 s36, s36, 131072
    v_mfma_f32_16x16x32_bf16 a[180:183], a[232:235], a[52:55], a[180:183]
    ds_read_b128 a[52:55], v9 offset:54272
    v_mfma_f32_16x16x32_bf16 a[180:183], a[236:239], a[20:23], a[180:183]
    s_add_u32 m0, s48, 20480
    v_mfma_f32_16x16x32_bf16 v[120:123], a[224:227], a[56:59], v[120:123]
    ds_read_b64_tr_b16 a[90:91], v18 offset:23552
    v_mfma_f32_16x16x32_bf16 v[120:123], a[228:231], a[24:27], v[120:123]
    buffer_load_dwordx4 v4, s[12:15], s37 offen sc1 lds
    v_mfma_f32_16x16x32_bf16 a[184:187], a[232:235], a[56:59], a[184:187]
    ds_read_b128 a[56:59], v9 offset:55296
    v_mfma_f32_16x16x32_bf16 a[184:187], a[236:239], a[24:27], a[184:187]
    s_add_u32 s37, s37, s42
    v_mfma_f32_16x16x32_bf16 v[124:127], a[224:227], a[60:63], v[124:127]
    s_add_u32 m0, s48, 21504
    v_mfma_f32_16x16x32_bf16 v[124:127], a[228:231], a[28:31], v[124:127]
    buffer_load_dwordx4 v5, s[16:19], s38 offen sc1 lds
    v_mfma_f32_16x16x32_bf16 a[188:191], a[232:235], a[60:63], a[188:191]
    ds_read_b128 a[60:63], v9 offset:56320
    v_mfma_f32_16x16x32_bf16 a[188:191], a[236:239], a[28:31], a[188:191]
    s_add_u32 s38, s38, s43
    s_waitcnt lgkmcnt(12)
    v_mfma_f32_16x16x32_bf16 v[128:131], a[240:243], a[0:3], v[128:131]
    ds_read_b64_tr_b16 a[216:217], v16 offset:32
    s_waitcnt lgkmcnt(9)
    v_mfma_f32_16x16x32_bf16 v[128:131], a[244:247], a[32:35], v[128:131]
    ds_read_b64_tr_b16 a[218:219], v16 offset:3104
    v_mfma_f32_16x16x32_bf16 v[132:135], a[240:243], a[4:7], v[132:135]
    ds_read_b64_tr_b16 a[220:221], v16 offset:20512
    v_mfma_f32_16x16x32_bf16 v[132:135], a[244:247], a[36:39], v[132:135]
    ds_read_b64_tr_b16 a[222:223], v16 offset:23584
    v_mfma_f32_16x16x32_bf16 v[136:139], a[240:243], a[8:11], v[136:139]
    s_add_u32 m0, s48, 22528
    v_mfma_f32_16x16x32_bf16 v[136:139], a[244:247], a[40:43], v[136:139]
    buffer_load_dwordx4 v6, s[20:23], s39 offen sc1 lds
    v_mfma_f32_16x16x32_bf16 v[140:143], a[240:243], a[12:15], v[140:143]
    s_add_u32 s39, s39, s44
    s_waitcnt lgkmcnt(11)
    v_mfma_f32_16x16x32_bf16 v[140:143], a[244:247], a[44:47], v[140:143]
    s_add_u32 m0, s48, 23552
    v_mfma_f32_16x16x32_bf16 v[144:147], a[240:243], a[16:19], v[144:147]
    s_waitcnt lgkmcnt(9)
    v_mfma_f32_16x16x32_bf16 v[144:147], a[244:247], a[48:51], v[144:147]
    buffer_load_dwordx4 v7, s[24:27], s40 offen sc1 lds
    v_mfma_f32_16x16x32_bf16 v[148:151], a[240:243], a[20:23], v[148:151]
    s_add_u32 s40, s40, s45
    s_waitcnt lgkmcnt(7)
    v_mfma_f32_16x16x32_bf16 v[148:151], a[244:247], a[52:55], v[148:151]
    s_add_u32 m0, s48, 24576
    v_mfma_f32_16x16x32_bf16 v[152:155], a[240:243], a[24:27], v[152:155]
    s_waitcnt lgkmcnt(5)
    v_mfma_f32_16x16x32_bf16 v[152:155], a[244:247], a[56:59], v[152:155]
    buffer_load_dwordx4 v8, s[28:31], s41 offen sc1 lds
    v_mfma_f32_16x16x32_bf16 v[156:159], a[240:243], a[28:31], v[156:159]
    s_add_u32 s41, s41, s46
    s_waitcnt lgkmcnt(4)
    v_mfma_f32_16x16x32_bf16 v[156:159], a[244:247], a[60:63], v[156:159]
    s_waitcnt lgkmcnt(0)
    v_mfma_f32_16x16x32_bf16 a[96:99], a[216:219], a[0:3], a[96:99]
    ds_read_b64_tr_b16 a[224:225], v14 offset:64
    v_mfma_f32_16x16x32_bf16 a[96:99], a[220:223], a[32:35], a[96:99]
    ds_read_b64_tr_b16 a[226:227], v14 offset:3136
    v_mfma_f32_16x16x32_bf16 a[100:103], a[216:219], a[4:7], a[100:103]
    ds_read_b64_tr_b16 a[228:229], v14 offset:20544
    v_mfma_f32_16x16x32_bf16 a[100:103], a[220:223], a[36:39], a[100:103]
    ds_read_b64_tr_b16 a[230:231], v14 offset:23616
    v_mfma_f32_16x16x32_bf16 a[104:107], a[216:219], a[8:11], a[104:107]
    buffer_load_dword v31, v19, s[88:91], s86 offen
    v_mfma_f32_16x16x32_bf16 a[104:107], a[220:223], a[40:43], a[104:107]
    s_add_u32 s86, s86, s87
    v_mfma_f32_16x16x32_bf16 a[192:195], a[88:91], a[64:67], a[192:195]
    v_mfma_f32_16x16x32_bf16 a[108:111], a[216:219], a[12:15], a[108:111]
    v_mfma_f32_16x16x32_bf16 a[108:111], a[220:223], a[44:47], a[108:111]
    v_mfma_f32_16x16x32_bf16 a[112:115], a[216:219], a[16:19], a[112:115]
    v_mfma_f32_16x16x32_bf16 a[112:115], a[220:223], a[48:51], a[112:115]
    v_mfma_f32_16x16x32_bf16 a[116:119], a[216:219], a[20:23], a[116:119]
    v_mfma_f32_16x16x32_bf16 a[116:119], a[220:223], a[52:55], a[116:119]
    v_mfma_f32_16x16x32_bf16 a[120:123], a[216:219], a[24:27], a[120:123]
    v_mfma_f32_16x16x32_bf16 a[120:123], a[220:223], a[56:59], a[120:123]
    v_mfma_f32_16x16x32_bf16 a[124:127], a[216:219], a[28:31], a[124:127]
    v_mfma_f32_16x16x32_bf16 a[124:127], a[220:223], a[60:63], a[124:127]
    s_waitcnt lgkmcnt(0)
    v_mfma_f32_16x16x32_bf16 v[160:163], a[224:227], a[0:3], v[160:163]
    ds_read_b64_tr_b16 a[232:233], v16 offset:96
    v_mfma_f32_16x16x32_bf16 v[160:163], a[228:231], a[32:35], v[160:163]
    ds_read_b64_tr_b16 a[234:235], v16 offset:3168
    v_mfma_f32_16x16x32_bf16 v[164:167], a[224:227], a[4:7], v[164:167]
    ds_read_b64_tr_b16 a[236:237], v16 offset:20576
    v_mfma_f32_16x16x32_bf16 v[164:167], a[228:231], a[36:39], v[164:167]
    ds_read_b64_tr_b16 a[238:239], v16 offset:23648
    v_mfma_f32_16x16x32_bf16 v[168:171], a[224:227], a[8:11], v[168:171]
    ds_read_b64_tr_b16 a[240:241], v14 offset:128
    v_mfma_f32_16x16x32_bf16 v[168:171], a[228:231], a[40:43], v[168:171]
    ds_read_b64_tr_b16 a[242:243], v14 offset:3200
    v_mfma_f32_16x16x32_bf16 v[172:175], a[224:227], a[12:15], v[172:175]
    ds_read_b64_tr_b16 a[244:245], v14 offset:20608
    v_mfma_f32_16x16x32_bf16 v[172:175], a[228:231], a[44:47], v[172:175]
    ds_read_b64_tr_b16 a[246:247], v14 offset:23680
    v_mfma_f32_16x16x32_bf16 v[176:179], a[224:227], a[16:19], v[176:179]
    v_mfma_f32_16x16x32_bf16 v[176:179], a[228:231], a[48:51], v[176:179]
    v_mfma_f32_16x16x32_bf16 v[180:183], a[224:227], a[20:23], v[180:183]
    v_mfma_f32_16x16x32_bf16 v[180:183], a[228:231], a[52:55], v[180:183]
    v_mfma_f32_16x16x32_bf16 v[184:187], a[224:227], a[24:27], v[184:187]
    v_mfma_f32_16x16x32_bf16 v[184:187], a[228:231], a[56:59], v[184:187]
    v_mfma_f32_16x16x32_bf16 v[188:191], a[224:227], a[28:31], v[188:191]
    v_mfma_f32_16x16x32_bf16 v[188:191], a[228:231], a[60:63], v[188:191]
    s_waitcnt vmcnt(12) lgkmcnt(0)
    s_barrier
    v_mfma_f32_16x16x32_bf16 a[128:131], a[232:235], a[0:3], a[128:131]
    ds_read_b64_tr_b16 a[216:217], v16 offset:20640
    v_mfma_f32_16x16x32_bf16 a[128:131], a[236:239], a[32:35], a[128:131]
    s_add_u32 m0, s47, 32768
    v_mfma_f32_16x16x32_bf16 v[192:195], a[0:3], a[240:243], v[192:195]
    ds_read_b128 a[0:3], v9 offset:0
    v_mfma_f32_16x16x32_bf16 v[192:195], a[32:35], a[244:247], v[192:195]
    buffer_load_dwordx4 v2, s[8:11], s36 offen offset:0 sc1 lds
    v_mfma_f32_16x16x32_bf16 a[132:135], a[232:235], a[4:7], a[132:135]
    ds_read_b64_tr_b16 a[218:219], v16 offset:23712
    v_mfma_f32_16x16x32_bf16 a[132:135], a[236:239], a[36:39], a[132:135]
    v_mfma_f32_16x16x32_bf16 v[196:199], a[4:7], a[240:243], v[196:199]
    ds_read_b128 a[4:7], v9 offset:1024
    v_mfma_f32_16x16x32_bf16 v[196:199], a[36:39], a[244:247], v[196:199]
    buffer_load_dwordx4 v2, s[8:11], s36 offen offset:1024 sc1 lds
    v_mfma_f32_16x16x32_bf16 a[136:139], a[232:235], a[8:11], a[136:139]
    ds_read_b64_tr_b16 a[220:221], v15 offset:160
    v_mfma_f32_16x16x32_bf16 a[136:139], a[236:239], a[40:43], a[136:139]
    v_mfma_f32_16x16x32_bf16 v[200:203], a[8:11], a[240:243], v[200:203]
    ds_read_b128 a[8:11], v9 offset:2048
    v_mfma_f32_16x16x32_bf16 v[200:203], a[40:43], a[244:247], v[200:203]
    buffer_load_dwordx4 v2, s[8:11], s36 offen offset:2048 sc1 lds
    v_mfma_f32_16x16x32_bf16 a[140:143], a[232:235], a[12:15], a[140:143]
    ds_read_b64_tr_b16 a[222:223], v15 offset:3232
    v_mfma_f32_16x16x32_bf16 a[140:143], a[236:239], a[44:47], a[140:143]
    v_mfma_f32_16x16x32_bf16 v[204:207], a[12:15], a[240:243], v[204:207]
    ds_read_b128 a[12:15], v9 offset:3072
    v_mfma_f32_16x16x32_bf16 v[204:207], a[44:47], a[244:247], v[204:207]
    buffer_load_dwordx4 v2, s[8:11], s36 offen offset:3072 sc1 lds
    v_mfma_f32_16x16x32_bf16 a[144:147], a[232:235], a[16:19], a[144:147]
    ds_read_b128 a[64:67], v10 offset:0
    v_mfma_f32_16x16x32_bf16 a[144:147], a[236:239], a[48:51], a[144:147]
    s_add_u32 m0, s49, 2048
    v_mfma_f32_16x16x32_bf16 v[208:211], a[16:19], a[240:243], v[208:211]
    ds_read_b128 a[16:19], v9 offset:4096
    v_mfma_f32_16x16x32_bf16 v[208:211], a[48:51], a[244:247], v[208:211]
    buffer_load_dword v3, s[8:11], s36 offen sc1 lds
    v_mfma_f32_16x16x32_bf16 a[148:151], a[232:235], a[20:23], a[148:151]
    ds_read_b64_tr_b16 a[88:89], v17 offset:0
    v_mfma_f32_16x16x32_bf16 a[148:151], a[236:239], a[52:55], a[148:151]
    s_add_u32 s36, s36, 131072
    v_mfma_f32_16x16x32_bf16 v[212:215], a[20:23], a[240:243], v[212:215]
    ds_read_b128 a[20:23], v9 offset:5120
    v_mfma_f32_16x16x32_bf16 v[212:215], a[52:55], a[244:247], v[212:215]
    s_add_u32 m0, s48, 40960
    v_mfma_f32_16x16x32_bf16 a[152:155], a[232:235], a[24:27], a[152:155]
    ds_read_b64_tr_b16 a[90:91], v17 offset:3072
    v_mfma_f32_16x16x32_bf16 a[152:155], a[236:239], a[56:59], a[152:155]
    buffer_load_dwordx4 v4, s[12:15], s37 offen sc1 lds
    v_mfma_f32_16x16x32_bf16 v[216:219], a[24:27], a[240:243], v[216:219]
    ds_read_b128 a[24:27], v9 offset:6144
    v_mfma_f32_16x16x32_bf16 v[216:219], a[56:59], a[244:247], v[216:219]
    s_add_u32 s37, s37, s42
    v_mfma_f32_16x16x32_bf16 a[156:159], a[232:235], a[28:31], a[156:159]
    s_add_u32 m0, s48, 41984
    v_mfma_f32_16x16x32_bf16 a[156:159], a[236:239], a[60:63], a[156:159]
    s_add_u32 s50, s50, 1
    v_mfma_f32_16x16x32_bf16 v[220:223], a[28:31], a[240:243], v[220:223]
    ds_read_b128 a[28:31], v9 offset:7168
    s_cmp_eq_u32 s50, 8
    v_mfma_f32_16x16x32_bf16 v[220:223], a[60:63], a[244:247], v[220:223]
    s_cbranch_scc1 L1_tail0
    s_waitcnt lgkmcnt(12)
    v_mfma_f32_16x16x32_bf16 v[224:227], a[32:35], a[216:219], v[224:227]
    ds_read_b64_tr_b16 a[224:225], v12 offset:26624
    s_waitcnt lgkmcnt(9)
    v_mfma_f32_16x16x32_bf16 v[224:227], a[0:3], a[220:223], v[224:227]
    ds_read_b64_tr_b16 a[226:227], v12 offset:30208
    v_mfma_f32_16x16x32_bf16 v[228:231], a[36:39], a[216:219], v[228:231]
    ds_read_b64_tr_b16 a[228:229], v11 offset:6144
    v_mfma_f32_16x16x32_bf16 v[228:231], a[4:7], a[220:223], v[228:231]
    ds_read_b64_tr_b16 a[230:231], v11 offset:9728
    v_mfma_f32_16x16x32_bf16 v[232:235], a[40:43], a[216:219], v[232:235]
    buffer_load_dwordx4 v5, s[16:19], s38 offen sc1 lds
    v_mfma_f32_16x16x32_bf16 v[232:235], a[8:11], a[220:223], v[232:235]
    s_add_u32 s38, s38, s43
    v_mfma_f32_16x16x32_bf16 v[236:239], a[44:47], a[216:219], v[236:239]
    s_add_u32 m0, s48, 43008
    s_waitcnt lgkmcnt(11)
    v_mfma_f32_16x16x32_bf16 v[236:239], a[12:15], a[220:223], v[236:239]
    v_mfma_f32_16x16x32_bf16 v[240:243], a[48:51], a[216:219], v[240:243]
    buffer_load_dwordx4 v6, s[20:23], s39 offen sc1 lds
    s_waitcnt lgkmcnt(9)
    v_mfma_f32_16x16x32_bf16 v[240:243], a[16:19], a[220:223], v[240:243]
    s_add_u32 s39, s39, s44
    v_mfma_f32_16x16x32_bf16 v[244:247], a[52:55], a[216:219], v[244:247]
    s_add_u32 m0, s48, 44032
    s_waitcnt lgkmcnt(7)
    v_mfma_f32_16x16x32_bf16 v[244:247], a[20:23], a[220:223], v[244:247]
    v_mfma_f32_16x16x32_bf16 v[248:251], a[56:59], a[216:219], v[248:251]
    buffer_load_dwordx4 v7, s[24:27], s40 offen sc1 lds
    s_waitcnt lgkmcnt(5)
    v_mfma_f32_16x16x32_bf16 v[248:251], a[24:27], a[220:223], v[248:251]
    s_add_u32 s40, s40, s45
    v_mfma_f32_16x16x32_bf16 v[252:255], a[60:63], a[216:219], v[252:255]
    s_add_u32 m0, s48, 45056
    s_waitcnt lgkmcnt(4)
    v_mfma_f32_16x16x32_bf16 v[252:255], a[28:31], a[220:223], v[252:255]
    s_waitcnt lgkmcnt(0)
    v_mfma_f32_16x16x32_bf16 v[32:35], a[224:227], a[32:35], v[32:35]
    ds_read_b64_tr_b16 a[232:233], v12 offset:26656
    v_mfma_f32_16x16x32_bf16 v[32:35], a[228:231], a[0:3], v[32:35]
    ds_read_b64_tr_b16 a[234:235], v12 offset:30240
    v_mfma_f32_16x16x32_bf16 v[36:39], a[224:227], a[36:39], v[36:39]
    ds_read_b64_tr_b16 a[236:237], v11 offset:6176
    v_mfma_f32_16x16x32_bf16 v[36:39], a[228:231], a[4:7], v[36:39]
    ds_read_b64_tr_b16 a[238:239], v11 offset:9760
    v_mfma_f32_16x16x32_bf16 v[40:43], a[224:227], a[40:43], v[40:43]
    buffer_load_dwordx4 v8, s[28:31], s41 offen sc1 lds
    v_mfma_f32_16x16x32_bf16 v[40:43], a[228:231], a[8:11], v[40:43]
    s_add_u32 s41, s41, s46
    v_mfma_f32_16x16x32_bf16 a[192:195], a[88:91], a[64:67], a[192:195]
    v_mfma_f32_16x16x32_bf16 v[44:47], a[224:227], a[44:47], v[44:47]
    v_mfma_f32_16x16x32_bf16 v[44:47], a[228:231], a[12:15], v[44:47]
    v_mfma_f32_16x16x32_bf16 v[48:51], a[224:227], a[48:51], v[48:51]
    buffer_load_dword v31, v19, s[88:91], s86 offen
    v_mfma_f32_16x16x32_bf16 v[48:51], a[228:231], a[16:19], v[48:51]
    s_add_u32 s86, s86, s87
    v_mfma_f32_16x16x32_bf16 v[52:55], a[224:227], a[52:55], v[52:55]
    v_mfma_f32_16x16x32_bf16 v[52:55], a[228:231], a[20:23], v[52:55]
    v_mfma_f32_16x16x32_bf16 v[56:59], a[224:227], a[56:59], v[56:59]
    v_mfma_f32_16x16x32_bf16 v[56:59], a[228:231], a[24:27], v[56:59]
    v_mfma_f32_16x16x32_bf16 v[60:63], a[224:227], a[60:63], v[60:63]
    v_mfma_f32_16x16x32_bf16 v[60:63], a[228:231], a[28:31], v[60:63]
    s_waitcnt lgkmcnt(0)
    v_mfma_f32_16x16x32_bf16 v[64:67], a[232:235], a[32:35], v[64:67]
    ds_read_b64_tr_b16 a[240:241], v12 offset:33792
    v_mfma_f32_16x16x32_bf16 v[64:67], a[236:239], a[0:3], v[64:67]
    ds_read_b64_tr_b16 a[242:243], v12 offset:37376
    v_mfma_f32_16x16x32_bf16 v[68:71], a[232:235], a[36:39], v[68:71]
    ds_read_b64_tr_b16 a[244:245], v11 offset:13312
    v_mfma_f32_16x16x32_bf16 v[68:71], a[236:239], a[4:7], v[68:71]
    ds_read_b64_tr_b16 a[246:247], v11 offset:16896
    v_mfma_f32_16x16x32_bf16 v[72:75], a[232:235], a[40:43], v[72:75]
    ds_read_b64_tr_b16 a[216:217], v12 offset:33824
    v_mfma_f32_16x16x32_bf16 v[72:75], a[236:239], a[8:11], v[72:75]
    ds_read_b64_tr_b16 a[218:219], v12 offset:37408
    v_mfma_f32_16x16x32_bf16 v[76:79], a[232:235], a[44:47], v[76:79]
    ds_read_b64_tr_b16 a[220:221], v11 offset:13344
    v_mfma_f32_16x16x32_bf16 v[76:79], a[236:239], a[12:15], v[76:79]
    ds_read_b64_tr_b16 a[222:223], v11 offset:16928
    v_mfma_f32_16x16x32_bf16 v[80:83], a[232:235], a[48:51], v[80:83]
    v_mfma_f32_16x16x32_bf16 v[80:83], a[236:239], a[16:19], v[80:83]
    v_mfma_f32_16x16x32_bf16 v[84:87], a[232:235], a[52:55], v[84:87]
    v_mfma_f32_16x16x32_bf16 v[84:87], a[236:239], a[20:23], v[84:87]
    v_mfma_f32_16x16x32_bf16 v[88:91], a[232:235], a[56:59], v[88:91]
    v_mfma_f32_16x16x32_bf16 v[88:91], a[236:239], a[24:27], v[88:91]
    v_mfma_f32_16x16x32_bf16 v[92:95], a[232:235], a[60:63], v[92:95]
    v_mfma_f32_16x16x32_bf16 v[92:95], a[236:239], a[28:31], v[92:95]
    s_waitcnt vmcnt(12) lgkmcnt(0)
    s_barrier
    v_mfma_f32_16x16x32_bf16 v[96:99], a[240:243], a[32:35], v[96:99]
    ds_read_b64_tr_b16 a[224:225], v13 offset:0
    v_mfma_f32_16x16x32_bf16 v[96:99], a[244:247], a[0:3], v[96:99]
    s_add_u32 m0, s47, 49152
    v_mfma_f32_16x16x32_bf16 a[160:163], a[216:219], a[32:35], a[160:163]
    ds_read_b128 a[32:35], v9 offset:16384
    v_mfma_f32_16x16x32_bf16 a[160:163], a[220:223], a[0:3], a[160:163]
    buffer_load_dwordx4 v2, s[8:11], s36 offen offset:0 sc1 lds
    v_mfma_f32_16x16x32_bf16 v[100:103], a[240:243], a[36:39], v[100:103]
    ds_read_b64_tr_b16 a[226:227], v13 offset:3072
    v_mfma_f32_16x16x32_bf16 v[100:103], a[244:247], a[4:7], v[100:103]
    v_mfma_f32_16x16x32_bf16 a[164:167], a[216:219], a[36:39], a[164:167]
    ds_read_b128 a[36:39], v9 offset:17408
    v_mfma_f32_16x16x32_bf16 a[164:167], a[220:223], a[4:7], a[164:167]
    buffer_load_dwordx4 v2, s[8:11], s36 offen offset:1024 sc1 lds
    v_mfma_f32_16x16x32_bf16 v[104:107], a[240:243], a[40:43], v[104:107]
    ds_read_b64_tr_b16 a[228:229], v13 offset:20480
    v_mfma_f32_16x16x32_bf16 v[104:107], a[244:247], a[8:11], v[104:107]
    v_mfma_f32_16x16x32_bf16 a[168:171], a[216:219], a[40:43], a[168:171]
    ds_read_b128 a[40:43], v9 offset:18432
    v_mfma_f32_16x16x32_bf16 a[168:171], a[220:223], a[8:11], a[168:171]
    buffer_load_dwordx4 v2, s[8:11], s36 offen offset:2048 sc1 lds
    v_mfma_f32_16x16x32_bf16 v[108:111], a[240:243], a[44:47], v[108:111]
    ds_read_b64_tr_b16 a[230:231], v13 offset:23552
    v_mfma_f32_16x16x32_bf16 v[108:111], a[244:247], a[12:15], v[108:111]
    v_mfma_f32_16x16x32_bf16 a[172:175], a[216:219], a[44:47], a[172:175]
    ds_read_b128 a[44:47], v9 offset:19456
    v_mfma_f32_16x16x32_bf16 a[172:175], a[220:223], a[12:15], a[172:175]
    buffer_load_dwordx4 v2, s[8:11], s36 offen offset:3072 sc1 lds
    v_mfma_f32_16x16x32_bf16 v[112:115], a[240:243], a[48:51], v[112:115]
    ds_read_b128 a[64:67], v10 offset:1024
    v_mfma_f32_16x16x32_bf16 v[112:115], a[244:247], a[16:19], v[112:115]
    s_add_u32 m0, s49, 3072
    v_mfma_f32_16x16x32_bf16 a[176:179], a[216:219], a[48:51], a[176:179]
    ds_read_b128 a[48:51], v9 offset:20480
    v_mfma_f32_16x16x32_bf16 a[176:179], a[220:223], a[16:19], a[176:179]
    buffer_load_dword v3, s[8:11], s36 offen sc1 lds
    v_mfma_f32_16x16x32_bf16 v[116:119], a[240:243], a[52:55], v[116:119]
    ds_read_b64_tr_b16 a[88:89], v17 offset:20480
    v_mfma_f32_16x16x32_bf16 v[116:119], a[244:247], a[20:23], v[116:119]
    s_add_u32 s36, s36, 131072
    v_mfma_f32_16x16x32_bf16 a[180:183], a[216:219], a[52:55], a[180:183]
    ds_read_b128 a[52:55], v9 offset:21504
    v_mfma_f32_16x16x32_bf16 a[180:183], a[220:223], a[20:23], a[180:183]
    s_add_u32 m0, s48, 61440
    v_mfma_f32_16x16x32_bf16 v[120:123], a[240:243], a[56:59], v[120:123]
    ds_read_b64_tr_b16 a[90:91], v17 offset:23552
    v_mfma_f32_16x16x32_bf16 v[120:123], a[244:247], a[24:27], v[120:123]
    buffer_load_dwordx4 v4, s[12:15], s37 offen sc1 lds
    v_mfma_f32_16x16x32_bf16 a[184:187], a[216:219], a[56:59], a[184:187]
    ds_read_b128 a[56:59], v9 offset:22528
    v_mfma_f32_16x16x32_bf16 a[184:187], a[220:223], a[24:27], a[184:187]
    s_add_u32 s37, s37, s42
    v_mfma_f32_16x16x32_bf16 v[124:127], a[240:243], a[60:63], v[124:127]
    s_add_u32 m0, s48, 62464
    v_mfma_f32_16x16x32_bf16 v[124:127], a[244:247], a[28:31], v[124:127]
    buffer_load_dwordx4 v5, s[16:19], s38 offen sc1 lds
    v_mfma_f32_16x16x32_bf16 a[188:191], a[216:219], a[60:63], a[188:191]
    ds_read_b128 a[60:63], v9 offset:23552
    v_mfma_f32_16x16x32_bf16 a[188:191], a[220:223], a[28:31], a[188:191]
    s_add_u32 s38, s38, s43
    s_waitcnt lgkmcnt(12)
    v_mfma_f32_16x16x32_bf16 v[128:131], a[224:227], a[0:3], v[128:131]
    ds_read_b64_tr_b16 a[232:233], v15 offset:32
    s_waitcnt lgkmcnt(9)
    v_mfma_f32_16x16x32_bf16 v[128:131], a[228:231], a[32:35], v[128:131]
    ds_read_b64_tr_b16 a[234:235], v15 offset:3104
    v_mfma_f32_16x16x32_bf16 v[132:135], a[224:227], a[4:7], v[132:135]
    ds_read_b64_tr_b16 a[236:237], v15 offset:20512
    v_mfma_f32_16x16x32_bf16 v[132:135], a[228:231], a[36:39], v[132:135]
    ds_read_b64_tr_b16 a[238:239], v15 offset:23584
    v_mfma_f32_16x16x32_bf16 v[136:139], a[224:227], a[8:11], v[136:139]
    s_add_u32 m0, s48, 63488
    v_mfma_f32_16x16x32_bf16 v[136:139], a[228:231], a[40:43], v[136:139]
    buffer_load_dwordx4 v6, s[20:23], s39 offen sc1 lds
    v_mfma_f32_16x16x32_bf16 v[140:143], a[224:227], a[12:15], v[140:143]
    s_add_u32 s39, s39, s44
    s_waitcnt lgkmcnt(11)
    v_mfma_f32_16x16x32_bf16 v[140:143], a[228:231], a[44:47], v[140:143]
    s_add_u32 m0, s48, 64512
    v_mfma_f32_16x16x32_bf16 v[144:147], a[224:227], a[16:19], v[144:147]
    s_waitcnt lgkmcnt(9)
    v_mfma_f32_16x16x32_bf16 v[144:147], a[228:231], a[48:51], v[144:147]
    buffer_load_dwordx4 v7, s[24:27], s40 offen sc1 lds
    v_mfma_f32_16x16x32_bf16 v[148:151], a[224:227], a[20:23], v[148:151]
    s_add_u32 s40, s40, s45
    s_waitcnt lgkmcnt(7)
    v_mfma_f32_16x16x32_bf16 v[148:151], a[228:231], a[52:55], v[148:151]
    s_add_u32 m0, s48, 65536
    v_mfma_f32_16x16x32_bf16 v[152:155], a[224:227], a[24:27], v[152:155]
    s_waitcnt lgkmcnt(5)
    v_mfma_f32_16x16x32_bf16 v[152:155], a[228:231], a[56:59], v[152:155]
    buffer_load_dwordx4 v8, s[28:31], s41 offen sc1 lds
    v_mfma_f32_16x16x32_bf16 v[156:159], a[224:227], a[28:31], v[156:159]
    s_add_u32 s41, s41, s46
    s_waitcnt lgkmcnt(4)
    v_mfma_f32_16x16x32_bf16 v[156:159], a[228:231], a[60:63], v[156:159]
    s_waitcnt lgkmcnt(0)
    v_mfma_f32_16x16x32_bf16 a[96:99], a[232:235], a[0:3], a[96:99]
    ds_read_b64_tr_b16 a[240:241], v13 offset:64
    v_mfma_f32_16x16x32_bf16 a[96:99], a[236:239], a[32:35], a[96:99]
    ds_read_b64_tr_b16 a[242:243], v13 offset:3136
    v_mfma_f32_16x16x32_bf16 a[100:103], a[232:235], a[4:7], a[100:103]
    ds_read_b64_tr_b16 a[244:245], v13 offset:20544
    v_mfma_f32_16x16x32_bf16 a[100:103], a[236:239], a[36:39], a[100:103]
    ds_read_b64_tr_b16 a[246:247], v13 offset:23616
    v_mfma_f32_16x16x32_bf16 a[104:107], a[232:235], a[8:11], a[104:107]
    buffer_load_dword v31, v19, s[88:91], s86 offen
    v_mfma_f32_16x16x32_bf16 a[104:107], a[236:239], a[40:43], a[104:107]
    s_add_u32 s86, s86, s87
    v_mfma_f32_16x16x32_bf16 a[192:195], a[88:91], a[64:67], a[192:195]
    v_mfma_f32_16x16x32_bf16 a[108:111], a[232:235], a[12:15], a[108:111]
    v_mfma_f32_16x16x32_bf16 a[108:111], a[236:239], a[44:47], a[108:111]
    v_mfma_f32_16x16x32_bf16 a[112:115], a[232:235], a[16:19], a[112:115]
    v_mfma_f32_16x16x32_bf16 a[112:115], a[236:239], a[48:51], a[112:115]
    v_mfma_f32_16x16x32_bf16 a[116:119], a[232:235], a[20:23], a[116:119]
    v_mfma_f32_16x16x32_bf16 a[116:119], a[236:239], a[52:55], a[116:119]
    v_mfma_f32_16x16x32_bf16 a[120:123], a[232:235], a[24:27], a[120:123]
    v_mfma_f32_16x16x32_bf16 a[120:123], a[236:239], a[56:59], a[120:123]
    v_mfma_f32_16x16x32_bf16 a[124:127], a[232:235], a[28:31], a[124:127]
    v_mfma_f32_16x16x32_bf16 a[124:127], a[236:239], a[60:63], a[124:127]
    s_waitcnt lgkmcnt(0)
    v_mfma_f32_16x16x32_bf16 v[160:163], a[240:243], a[0:3], v[160:163]
    ds_read_b64_tr_b16 a[216:217], v15 offset:96
    v_mfma_f32_16x16x32_bf16 v[160:163], a[244:247], a[32:35], v[160:163]
    ds_read_b64_tr_b16 a[218:219], v15 offset:3168
    v_mfma_f32_16x16x32_bf16 v[164:167], a[240:243], a[4:7], v[164:167]
    ds_read_b64_tr_b16 a[220:221], v15 offset:20576
    v_mfma_f32_16x16x32_bf16 v[164:167], a[244:247], a[36:39], v[164:167]
    ds_read_b64_tr_b16 a[222:223], v15 offset:23648
    v_mfma_f32_16x16x32_bf16 v[168:171], a[240:243], a[8:11], v[168:171]
    ds_read_b64_tr_b16 a[224:225], v13 offset:128
    v_mfma_f32_16x16x32_bf16 v[168:171], a[244:247], a[40:43], v[168:171]
    ds_read_b64_tr_b16 a[226:227], v13 offset:3200
    v_mfma_f32_16x16x32_bf16 v[172:175], a[240:243], a[12:15], v[172:175]
    ds_read_b64_tr_b16 a[228:229], v13 offset:20608
    v_mfma_f32_16x16x32_bf16 v[172:175], a[244:247], a[44:47], v[172:175]
    ds_read_b64_tr_b16 a[230:231], v13 offset:23680
    v_mfma_f32_16x16x32_bf16 v[176:179], a[240:243], a[16:19], v[176:179]
    v_mfma_f32_16x16x32_bf16 v[176:179], a[244:247], a[48:51], v[176:179]
    v_mfma_f32_16x16x32_bf16 v[180:183], a[240:243], a[20:23], v[180:183]
    v_mfma_f32_16x16x32_bf16 v[180:183], a[244:247], a[52:55], v[180:183]
    v_mfma_f32_16x16x32_bf16 v[184:187], a[240:243], a[24:27], v[184:187]
    s_cmp_eq_u32 s50, 7
    v_mfma_f32_16x16x32_bf16 v[184:187], a[244:247], a[56:59], v[184:187]
    s_cselect_b32 s48, 170000, s48
    v_mfma_f32_16x16x32_bf16 v[188:191], a[240:243], a[28:31], v[188:191]
    s_cselect_b32 s47, 170000, s47
    v_mfma_f32_16x16x32_bf16 v[188:191], a[244:247], a[60:63], v[188:191]
    s_cselect_b32 s49, 170000, s49
    s_waitcnt vmcnt(12) lgkmcnt(0)
    s_barrier
    v_mfma_f32_16x16x32_bf16 a[128:131], a[216:219], a[0:3], a[128:131]
    ds_read_b64_tr_b16 a[232:233], v15 offset:20640
    v_mfma_f32_16x16x32_bf16 a[128:131], a[220:223], a[32:35], a[128:131]
    s_add_u32 m0, s47, 0
    v_mfma_f32_16x16x32_bf16 v[192:195], a[0:3], a[224:227], v[192:195]
    ds_read_b128 a[0:3], v9 offset:32768
    v_mfma_f32_16x16x32_bf16 v[192:195], a[32:35], a[228:231], v[192:195]
    buffer_load_dwordx4 v2, s[8:11], s36 offen offset:0 sc1 lds
    v_mfma_f32_16x16x32_bf16 a[132:135], a[216:219], a[4:7], a[132:135]
    ds_read_b64_tr_b16 a[234:235], v15 offset:23712
    v_mfma_f32_16x16x32_bf16 a[132:135], a[220:223], a[36:39], a[132:135]
    v_mfma_f32_16x16x32_bf16 v[196:199], a[4:7], a[224:227], v[196:199]
    ds_read_b128 a[4:7], v9 offset:33792
    v_mfma_f32_16x16x32_bf16 v[196:199], a[36:39], a[228:231], v[196:199]
    buffer_load_dwordx4 v2, s[8:11], s36 offen offset:1024 sc1 lds
    v_mfma_f32_16x16x32_bf16 a[136:139], a[216:219], a[8:11], a[136:139]
    ds_read_b64_tr_b16 a[236:237], v16 offset:160
    v_mfma_f32_16x16x32_bf16 a[136:139], a[220:223], a[40:43], a[136:139]
    v_mfma_f32_16x16x32_bf16 v[200:203], a[8:11], a[224:227], v[200:203]
    ds_read_b128 a[8:11], v9 offset:34816
    v_mfma_f32_16x16x32_bf16 v[200:203], a[40:43], a[228:231], v[200:203]
    buffer_load_dwordx4 v2, s[8:11], s36 offen offset:2048 sc1 lds
    v_mfma_f32_16x16x32_bf16 a[140:143], a[216:219], a[12:15], a[140:143]
    ds_read_b64_tr_b16 a[238:239], v16 offset:3232
    v_mfma_f32_16x16x32_bf16 a[140:143], a[220:223], a[44:47], a[140:143]
    v_mfma_f32_16x16x32_bf16 v[204:207], a[12:15], a[224:227], v[204:207]
    ds_read_b128 a[12:15], v9 offset:35840
    v_mfma_f32_16x16x32_bf16 v[204:207], a[44:47], a[228:231], v[204:207]
    buffer_load_dwordx4 v2, s[8:11], s36 offen offset:3072 sc1 lds
    v_mfma_f32_16x16x32_bf16 a[144:147], a[216:219], a[16:19], a[144:147]
    ds_read_b128 a[64:67], v10 offset:2048
    v_mfma_f32_16x16x32_bf16 a[144:147], a[220:223], a[48:51], a[144:147]
    s_add_u32 m0, s49, 0
    v_mfma_f32_16x16x32_bf16 v[208:211], a[16:19], a[224:227], v[208:211]
    ds_read_b128 a[16:19], v9 offset:36864
    v_mfma_f32_16x16x32_bf16 v[208:211], a[48:51], a[228:231], v[208:211]
    buffer_load_dword v3, s[8:11], s36 offen sc1 lds
    v_mfma_f32_16x16x32_bf16 a[148:151], a[216:219], a[20:23], a[148:151]
    ds_read_b64_tr_b16 a[88:89], v18 offset:0
    v_mfma_f32_16x16x32_bf16 a[148:151], a[220:223], a[52:55], a[148:151]
    s_add_u32 s36, s36, 131072
    v_mfma_f32_16x16x32_bf16 v[212:215], a[20:23], a[224:227], v[212:215]
    ds_read_b128 a[20:23], v9 offset:37888
    v_mfma_f32_16x16x32_bf16 v[212:215], a[52:55], a[228:231], v[212:215]
    s_add_u32 m0, s48, 0
    v_mfma_f32_16x16x32_bf16 a[152:155], a[216:219], a[24:27], a[152:155]
    ds_read_b64_tr_b16 a[90:91], v18 offset:3072
    v_mfma_f32_16x16x32_bf16 a[152:155], a[220:223], a[56:59], a[152:155]
    buffer_load_dwordx4 v4, s[12:15], s37 offen sc1 lds
    v_mfma_f32_16x16x32_bf16 v[216:219], a[24:27], a[224:227], v[216:219]
    ds_read_b128 a[24:27], v9 offset:38912
    v_mfma_f32_16x16x32_bf16 v[216:219], a[56:59], a[228:231], v[216:219]
    s_add_u32 s37, s37, s42
    v_mfma_f32_16x16x32_bf16 a[156:159], a[216:219], a[28:31], a[156:159]
    s_add_u32 m0, s48, 1024
    v_mfma_f32_16x16x32_bf16 a[156:159], a[220:223], a[60:63], a[156:159]
    buffer_load_dwordx4 v5, s[16:19], s38 offen sc1 lds
    v_mfma_f32_16x16x32_bf16 v[220:223], a[28:31], a[224:227], v[220:223]
    ds_read_b128 a[28:31], v9 offset:39936
    v_mfma_f32_16x16x32_bf16 v[220:223], a[60:63], a[228:231], v[220:223]
    s_add_u32 s38, s38, s43
    s_branch L1_loop0
L1_tail0:
    s_waitcnt lgkmcnt(12)
    v_mfma_f32_16x16x32_bf16 v[224:227], a[32:35], a[216:219], v[224:227]
    ds_read_b64_tr_b16 a[224:225], v12 offset:26624
    v_mfma_f32_16x16x32_bf16 v[228:231], a[36:39], a[216:219], v[228:231]
    ds_read_b64_tr_b16 a[226:227], v12 offset:30208
    v_mfma_f32_16x16x32_bf16 v[232:235], a[40:43], a[216:219], v[232:235]
    v_mfma_f32_16x16x32_bf16 v[236:239], a[44:47], a[216:219], v[236:239]
    s_lshl_b32 s60, s54, 14
    s_lshl_b32 s61, s52, 13
    s_add_u32 s60, s60, s61
    v_lshl_add_u32 v2, v1, 4, s60
    v_add_u32 v3, 4096, v2
    v_mfma_f32_16x16x32_bf16 v[240:243], a[48:51], a[216:219], v[240:243]
    s_mul_i32 s62, s55, 7
    s_and_b32 s63, s55, 1
    s_add_u32 s62, s62, s63
    s_lshr_b32 s62, s62, 1
    v_mfma_f32_16x16x32_bf16 v[244:247], a[52:55], a[216:219], v[244:247]
    s_add_u32 s62, s62, 32
    s_lshl_b32 s62, s62, 17
    s_add_u32 s64, s62, 131072
    s_add_u32 s65, s62, 262144
    s_lshl_b32 s60, s52, 14
    v_mfma_f32_16x16x32_bf16 v[248:251], a[56:59], a[216:219], v[248:251]
    s_add_u32 s60, s60, 4096
    v_lshl_add_u32 v4, v1, 4, s60
    v_and_b32 v20, 15, v1
    v_lshrrev_b32 v21, 4, v1
    v_mfma_f32_16x16x32_bf16 v[252:255], a[60:63], a[216:219], v[252:255]
    v_lshl_add_u32 v5, v20, 5, s60
    v_lshl_add_u32 v5, v21, 3, v5
    s_mul_i32 s60, s52, 40960
    s_sub_u32 s61, 40960, s60
    s_waitcnt lgkmcnt(0)
    v_mfma_f32_16x16x32_bf16 v[32:35], a[224:227], a[32:35], v[32:35]
    ds_read_b64_tr_b16 a[232:233], v12 offset:26656
    v_lshl_add_u32 v6, v1, 4, s60
    v_lshl_add_u32 v7, v21, 7, s61
    v_lshl_add_u32 v7, v20, 1, v7
    v_accvgpr_read_b32 v20, a192
    v_accvgpr_read_b32 v21, a193
    v_mfma_f32_16x16x32_bf16 v[36:39], a[224:227], a[36:39], v[36:39]
    ds_read_b64_tr_b16 a[234:235], v12 offset:30240
    v_accvgpr_read_b32 v22, a194
    v_accvgpr_read_b32 v23, a195
    v_cvt_pk_bf16_f32 v24, v20, v21
    v_cvt_pk_bf16_f32 v25, v22, v23
    v_mfma_f32_16x16x32_bf16 v[40:43], a[224:227], a[40:43], v[40:43]
    ds_write_b64 v6, v[24:25] offset:0
    ds_write_b16 v7, v24 offset:1024
    ds_write_b16_d16_hi v7, v24 offset:1056
    ds_write_b16 v7, v25 offset:1088
    ds_write_b16_d16_hi v7, v25 offset:1120
    v_mfma_f32_16x16x32_bf16 v[44:47], a[224:227], a[44:47], v[44:47]
    s_mov_b32 s94, 0x3e8293ee
    s_mov_b32 s95, 0x3e8293ee
    s_lshl_b32 s67, s55, 17
    v_accvgpr_read_b32 v24, a140
    v_mfma_f32_16x16x32_bf16 v[48:51], a[224:227], a[48:51], v[48:51]
    v_accvgpr_read_b32 v25, a141
    v_accvgpr_read_b32 v26, a142
    v_accvgpr_read_b32 v27, a143
    v_cvt_pk_bf16_f32 v172, v172, v173
    v_mfma_f32_16x16x32_bf16 v[52:55], a[224:227], a[52:55], v[52:55]
    v_cvt_pk_bf16_f32 v173, v174, v175
    v_cvt_pk_bf16_f32 v174, v24, v25
    v_cvt_pk_bf16_f32 v175, v26, v27
    ds_write_b128 v4, v[172:175] offset:0
    v_accvgpr_read_b32 v20, a144
    v_mfma_f32_16x16x32_bf16 v[56:59], a[224:227], a[56:59], v[56:59]
    v_accvgpr_read_b32 v21, a145
    v_accvgpr_read_b32 v22, a146
    v_accvgpr_read_b32 v23, a147
    v_cvt_pk_bf16_f32 v176, v176, v177
    v_mfma_f32_16x16x32_bf16 v[60:63], a[224:227], a[60:63], v[60:63]
    v_cvt_pk_bf16_f32 v177, v178, v179
    v_cvt_pk_bf16_f32 v178, v20, v21
    v_cvt_pk_bf16_f32 v179, v22, v23
    ds_write_b128 v4, v[176:179] offset:2048
    s_waitcnt lgkmcnt(7)
    v_mfma_f32_16x16x32_bf16 v[64:67], a[232:235], a[32:35], v[64:67]
    ds_read_b64_tr_b16 a[240:241], v12 offset:33792
    v_accvgpr_read_b32 v24, a148
    v_accvgpr_read_b32 v25, a149
    v_accvgpr_read_b32 v26, a150
    v_accvgpr_read_b32 v27, a151
    v_cvt_pk_bf16_f32 v180, v180, v181
    v_mfma_f32_16x16x32_bf16 v[68:71], a[232:235], a[36:39], v[68:71]
    ds_read_b64_tr_b16 a[242:243], v12 offset:37376
    v_cvt_pk_bf16_f32 v181, v182, v183
    v_cvt_pk_bf16_f32 v182, v24, v25
    v_cvt_pk_bf16_f32 v183, v26, v27
    ds_write_b128 v4, v[180:183] offset:4096
    v_mfma_f32_16x16x32_bf16 v[72:75], a[232:235], a[40:43], v[72:75]
    ds_read_b64_tr_b16 a[216:217], v12 offset:33824
    v_accvgpr_read_b32 v20, a152
    v_accvgpr_read_b32 v21, a153
    v_accvgpr_read_b32 v22, a154
    v_accvgpr_read_b32 v23, a155
    v_cvt_pk_bf16_f32 v184, v184, v185
    v_mfma_f32_16x16x32_bf16 v[76:79], a[232:235], a[44:47], v[76:79]
    ds_read_b64_tr_b16 a[218:219], v12 offset:37408
    v_cvt_pk_bf16_f32 v185, v186, v187
    v_cvt_pk_bf16_f32 v186, v20, v21
    v_cvt_pk_bf16_f32 v187, v22, v23
    ds_write_b128 v4, v[184:187] offset:6144
    v_mfma_f32_16x16x32_bf16 v[80:83], a[232:235], a[48:51], v[80:83]
    v_accvgpr_read_b32 v24, a156
    v_accvgpr_read_b32 v25, a157
    v_accvgpr_read_b32 v26, a158
    v_accvgpr_read_b32 v27, a159
    v_mfma_f32_16x16x32_bf16 v[84:87], a[232:235], a[52:55], v[84:87]
    v_cvt_pk_bf16_f32 v188, v188, v189
    v_cvt_pk_bf16_f32 v189, v190, v191
    v_cvt_pk_bf16_f32 v190, v24, v25
    v_cvt_pk_bf16_f32 v191, v26, v27
    ds_write_b128 v4, v[188:191] offset:8192
    v_mfma_f32_16x16x32_bf16 v[88:91], a[232:235], a[56:59], v[88:91]
    v_accvgpr_read_b32 v20, a112
    v_accvgpr_read_b32 v21, a113
    v_accvgpr_read_b32 v22, a114
    v_accvgpr_read_b32 v23, a115
    v_mfma_f32_16x16x32_bf16 v[92:95], a[232:235], a[60:63], v[92:95]
    v_cvt_pk_bf16_f32 v144, v144, v145
    v_cvt_pk_bf16_f32 v145, v146, v147
    v_cvt_pk_bf16_f32 v146, v20, v21
    v_cvt_pk_bf16_f32 v147, v22, v23
    s_waitcnt lgkmcnt(5)
    v_mfma_f32_16x16x32_bf16 v[96:99], a[240:243], a[32:35], v[96:99]
    ds_write_b128 v4, v[144:147] offset:10240
    v_accvgpr_read_b32 v24, a116
    v_accvgpr_read_b32 v25, a117
    v_accvgpr_read_b32 v26, a118
    v_accvgpr_read_b32 v27, a119
    v_mfma_f32_16x16x32_bf16 v[100:103], a[240:243], a[36:39], v[100:103]
    v_cvt_pk_bf16_f32 v148, v148, v149
    v_cvt_pk_bf16_f32 v149, v150, v151
    v_cvt_pk_bf16_f32 v150, v24, v25
    v_cvt_pk_bf16_f32 v151, v26, v27
    v_mfma_f32_16x16x32_bf16 v[104:107], a[240:243], a[40:43], v[104:107]
    ds_write_b128 v4, v[148:151] offset:11264
    v_accvgpr_read_b32 v20, a120
    v_accvgpr_read_b32 v21, a121
    v_accvgpr_read_b32 v22, a122
    v_accvgpr_read_b32 v23, a123
    v_mfma_f32_16x16x32_bf16 v[108:111], a[240:243], a[44:47], v[108:111]
    v_cvt_pk_bf16_f32 v152, v152, v153
    v_cvt_pk_bf16_f32 v153, v154, v155
    v_cvt_pk_bf16_f32 v154, v20, v21
    v_cvt_pk_bf16_f32 v155, v22, v23
    v_mfma_f32_16x16x32_bf16 v[112:115], a[240:243], a[48:51], v[112:115]
    ds_write_b128 v4, v[152:155] offset:12288
    v_accvgpr_read_b32 v24, a124
    v_accvgpr_read_b32 v25, a125
    v_accvgpr_read_b32 v26, a126
    v_mfma_f32_16x16x32_bf16 v[116:119], a[240:243], a[52:55], v[116:119]
    v_accvgpr_read_b32 v27, a127
    v_cvt_pk_bf16_f32 v156, v156, v157
    v_cvt_pk_bf16_f32 v157, v158, v159
    v_cvt_pk_bf16_f32 v158, v24, v25
    v_cvt_pk_bf16_f32 v159, v26, v27
    v_mfma_f32_16x16x32_bf16 v[120:123], a[240:243], a[56:59], v[120:123]
    ds_write_b128 v4, v[156:159] offset:13312
    v_cvt_pk_bf16_f32 v195, v194, v195
    v_cvt_pk_bf16_f32 v194, v192, v193
    v_cvt_pk_bf16_f32 v196, v196, v197
    v_mfma_f32_16x16x32_bf16 v[124:127], a[240:243], a[60:63], v[124:127]
    v_cvt_pk_bf16_f32 v197, v198, v199
    v_cvt_pk_bf16_f32 v198, v200, v201
    v_cvt_pk_bf16_f32 v199, v202, v203
    v_cvt_pk_bf16_f32 v200, v204, v205
    s_waitcnt lgkmcnt(6)
    v_mfma_f32_16x16x32_bf16 a[160:163], a[216:219], a[32:35], a[160:163]
    v_cvt_pk_bf16_f32 v201, v206, v207
    ds_write_b64 v5, v[200:201] offset:1024
    v_cvt_pk_bf16_f32 v202, v208, v209
    v_cvt_pk_bf16_f32 v203, v210, v211
    ds_write_b64 v5, v[202:203] offset:3072
    v_mfma_f32_16x16x32_bf16 a[164:167], a[216:219], a[36:39], a[164:167]
    v_cvt_pk_bf16_f32 v204, v212, v213
    v_cvt_pk_bf16_f32 v205, v214, v215
    ds_write_b64 v5, v[204:205] offset:5120
    v_cvt_pk_bf16_f32 v206, v216, v217
    v_mfma_f32_16x16x32_bf16 a[168:171], a[216:219], a[40:43], a[168:171]
    v_cvt_pk_bf16_f32 v207, v218, v219
    ds_write_b64 v5, v[206:207] offset:7168
    v_cvt_pk_bf16_f32 v208, v220, v221
    v_cvt_pk_bf16_f32 v209, v222, v223
    ds_write_b64 v5, v[208:209] offset:9216
    v_mfma_f32_16x16x32_bf16 a[172:175], a[216:219], a[44:47], a[172:175]
    v_cvt_pk_bf16_f32 v227, v226, v227
    v_cvt_pk_bf16_f32 v226, v224, v225
    v_cvt_pk_bf16_f32 v228, v228, v229
    v_cvt_pk_bf16_f32 v229, v230, v231
    v_mfma_f32_16x16x32_bf16 a[176:179], a[216:219], a[48:51], a[176:179]
    v_cvt_pk_bf16_f32 v230, v232, v233
    v_cvt_pk_bf16_f32 v231, v234, v235
    v_cvt_pk_bf16_f32 v232, v236, v237
    v_cvt_pk_bf16_f32 v233, v238, v239
    v_mfma_f32_16x16x32_bf16 a[180:183], a[216:219], a[52:55], a[180:183]
    ds_write_b64 v5, v[232:233] offset:1536
    v_cvt_pk_bf16_f32 v234, v240, v241
    v_cvt_pk_bf16_f32 v235, v242, v243
    ds_write_b64 v5, v[234:235] offset:3584
    v_cvt_pk_bf16_f32 v236, v244, v245
    v_mfma_f32_16x16x32_bf16 a[184:187], a[216:219], a[56:59], a[184:187]
    v_cvt_pk_bf16_f32 v237, v246, v247
    ds_write_b64 v5, v[236:237] offset:5632
    v_cvt_pk_bf16_f32 v238, v248, v249
    v_cvt_pk_bf16_f32 v239, v250, v251
    v_mfma_f32_16x16x32_bf16 a[188:191], a[216:219], a[60:63], a[188:191]
    ds_write_b64 v5, v[238:239] offset:7680
    v_cvt_pk_bf16_f32 v240, v252, v253
    v_cvt_pk_bf16_f32 v241, v254, v255
    ds_write_b64 v5, v[240:241] offset:9728
    s_waitcnt lgkmcnt(0)
    s_barrier
    s_lshl_b32 s60, s52, 12
    s_add_u32 s60, s60, 4096
    v_subrev_u32 v4, s60, v4
    v_subrev_u32 v5, s60, v5
    ds_read_b128 v[210:213], v4
    ds_read_b64 v[192:193], v5 offset:1024
    ds_read_b64 v[224:225], v5 offset:1536
    v_pk_mul_f32 v[32:33], v[32:33], v[96:97]
    v_pk_mul_f32 v[34:35], v[34:35], v[98:99]
    v_cvt_pk_bf16_f32 v32, v32, v33
    v_cvt_pk_bf16_f32 v33, v34, v35
    v_accvgpr_read_b32 v24, a160
    v_accvgpr_read_b32 v25, a161
    v_accvgpr_read_b32 v26, a162
    v_accvgpr_read_b32 v27, a163
    v_pk_mul_f32 v[64:65], v[64:65], v[24:25]
    v_pk_mul_f32 v[66:67], v[66:67], v[26:27]
    v_cvt_pk_bf16_f32 v34, v64, v65
    v_cvt_pk_bf16_f32 v35, v66, v67
    buffer_store_dwordx4 v[32:35], v2, s[32:35], s62 offen offset:0 sc1
    v_pk_mul_f32 v[36:37], v[36:37], v[100:101]
    v_pk_mul_f32 v[38:39], v[38:39], v[102:103]
    v_cvt_pk_bf16_f32 v36, v36, v37
    v_cvt_pk_bf16_f32 v37, v38, v39
    v_accvgpr_read_b32 v24, a164
    v_accvgpr_read_b32 v25, a165
    v_accvgpr_read_b32 v26, a166
    v_accvgpr_read_b32 v27, a167
    v_pk_mul_f32 v[68:69], v[68:69], v[24:25]
    v_pk_mul_f32 v[70:71], v[70:71], v[26:27]
    v_cvt_pk_bf16_f32 v38, v68, v69
    v_cvt_pk_bf16_f32 v39, v70, v71
    buffer_store_dwordx4 v[36:39], v2, s[32:35], s62 offen offset:1024 sc1
    v_pk_mul_f32 v[40:41], v[40:41], v[104:105]
    v_pk_mul_f32 v[42:43], v[42:43], v[106:107]
    v_cvt_pk_bf16_f32 v40, v40, v41
    v_cvt_pk_bf16_f32 v41, v42, v43
    v_accvgpr_read_b32 v24, a168
    v_accvgpr_read_b32 v25, a169
    v_accvgpr_read_b32 v26, a170
    v_accvgpr_read_b32 v27, a171
    v_pk_mul_f32 v[72:73], v[72:73], v[24:25]
    v_pk_mul_f32 v[74:75], v[74:75], v[26:27]
    v_cvt_pk_bf16_f32 v42, v72, v73
    v_cvt_pk_bf16_f32 v43, v74, v75
    buffer_store_dwordx4 v[40:43], v2, s[32:35], s62 offen offset:2048 sc1
    v_pk_mul_f32 v[44:45], v[44:45], v[108:109]
    v_pk_mul_f32 v[46:47], v[46:47], v[110:111]
    v_cvt_pk_bf16_f32 v44, v44, v45
    v_cvt_pk_bf16_f32 v45, v46, v47
    v_accvgpr_read_b32 v24, a172
    v_accvgpr_read_b32 v25, a173
    v_accvgpr_read_b32 v26, a174
    v_accvgpr_read_b32 v27, a175
    v_pk_mul_f32 v[76:77], v[76:77], v[24:25]
    v_pk_mul_f32 v[78:79], v[78:79], v[26:27]
    v_cvt_pk_bf16_f32 v46, v76, v77
    v_cvt_pk_bf16_f32 v47, v78, v79
    buffer_store_dwordx4 v[44:47], v2, s[32:35], s62 offen offset:3072 sc1
    v_pk_mul_f32 v[48:49], v[48:49], v[112:113]
    v_pk_mul_f32 v[50:51], v[50:51], v[114:115]
    v_cvt_pk_bf16_f32 v48, v48, v49
    v_cvt_pk_bf16_f32 v49, v50, v51
    v_accvgpr_read_b32 v24, a176
    v_accvgpr_read_b32 v25, a177
    v_accvgpr_read_b32 v26, a178
    v_accvgpr_read_b32 v27, a179
    v_pk_mul_f32 v[80:81], v[80:81], v[24:25]
    v_pk_mul_f32 v[82:83], v[82:83], v[26:27]
    v_cvt_pk_bf16_f32 v50, v80, v81
    v_cvt_pk_bf16_f32 v51, v82, v83
    buffer_store_dwordx4 v[48:51], v3, s[32:35], s62 offen offset:0 sc1
    v_pk_mul_f32 v[52:53], v[52:53], v[116:117]
    v_pk_mul_f32 v[54:55], v[54:55], v[118:119]
    v_cvt_pk_bf16_f32 v52, v52, v53
    v_cvt_pk_bf16_f32 v53, v54, v55
    v_accvgpr_read_b32 v24, a180
    v_accvgpr_read_b32 v25, a181
    v_accvgpr_read_b32 v26, a182
    v_accvgpr_read_b32 v27, a183
    v_pk_mul_f32 v[84:85], v[84:85], v[24:25]
    v_pk_mul_f32 v[86:87], v[86:87], v[26:27]
    v_cvt_pk_bf16_f32 v54, v84, v85
    v_cvt_pk_bf16_f32 v55, v86, v87
    buffer_store_dwordx4 v[52:55], v3, s[32:35], s62 offen offset:1024 sc1
    v_pk_mul_f32 v[56:57], v[56:57], v[120:121]
    v_pk_mul_f32 v[58:59], v[58:59], v[122:123]
    v_cvt_pk_bf16_f32 v56, v56, v57
    v_cvt_pk_bf16_f32 v57, v58, v59
    v_accvgpr_read_b32 v24, a184
    v_accvgpr_read_b32 v25, a185
    v_accvgpr_read_b32 v26, a186
    v_accvgpr_read_b32 v27, a187
    v_pk_mul_f32 v[88:89], v[88:89], v[24:25]
    v_pk_mul_f32 v[90:91], v[90:91], v[26:27]
    v_cvt_pk_bf16_f32 v58, v88, v89
    v_cvt_pk_bf16_f32 v59, v90, v91
    buffer_store_dwordx4 v[56:59], v3, s[32:35], s62 offen offset:2048 sc1
    v_pk_mul_f32 v[60:61], v[60:61], v[124:125]
    v_pk_mul_f32 v[62:63], v[62:63], v[126:127]
    v_cvt_pk_bf16_f32 v60, v60, v61
    v_cvt_pk_bf16_f32 v61, v62, v63
    v_accvgpr_read_b32 v24, a188
    v_accvgpr_read_b32 v25, a189
    v_accvgpr_read_b32 v26, a190
    v_accvgpr_read_b32 v27, a191
    v_pk_mul_f32 v[92:93], v[92:93], v[24:25]
    v_pk_mul_f32 v[94:95], v[94:95], v[26:27]
    v_cvt_pk_bf16_f32 v62, v92, v93
    v_cvt_pk_bf16_f32 v63, v94, v95
    buffer_store_dwordx4 v[60:63], v3, s[32:35], s62 offen offset:3072 sc1
    v_accvgpr_read_b32 v20, a128
    v_accvgpr_read_b32 v21, a129
    v_accvgpr_read_b32 v22, a130
    v_accvgpr_read_b32 v23, a131
    v_cvt_pk_bf16_f32 v160, v160, v161
    v_cvt_pk_bf16_f32 v161, v162, v163
    v_cvt_pk_bf16_f32 v162, v20, v21
    v_cvt_pk_bf16_f32 v163, v22, v23
    v_accvgpr_read_b32 v24, a132
    v_accvgpr_read_b32 v25, a133
    v_accvgpr_read_b32 v26, a134
    v_accvgpr_read_b32 v27, a135
    v_cvt_pk_bf16_f32 v164, v164, v165
    v_cvt_pk_bf16_f32 v165, v166, v167
    v_cvt_pk_bf16_f32 v166, v24, v25
    v_cvt_pk_bf16_f32 v167, v26, v27
    v_accvgpr_read_b32 v20, a136
    v_accvgpr_read_b32 v21, a137
    v_accvgpr_read_b32 v22, a138
    v_accvgpr_read_b32 v23, a139
    v_cvt_pk_bf16_f32 v168, v168, v169
    v_cvt_pk_bf16_f32 v169, v170, v171
    v_cvt_pk_bf16_f32 v170, v20, v21
    v_cvt_pk_bf16_f32 v171, v22, v23
    v_accvgpr_read_b32 v20, a96
    v_accvgpr_read_b32 v21, a97
    v_accvgpr_read_b32 v22, a98
    v_accvgpr_read_b32 v23, a99
    v_cvt_pk_bf16_f32 v128, v128, v129
    v_cvt_pk_bf16_f32 v129, v130, v131
    v_cvt_pk_bf16_f32 v130, v20, v21
    v_cvt_pk_bf16_f32 v131, v22, v23
    v_accvgpr_read_b32 v24, a100
    v_accvgpr_read_b32 v25, a101
    v_accvgpr_read_b32 v26, a102
    v_accvgpr_read_b32 v27, a103
    v_cvt_pk_bf16_f32 v132, v132, v133
    v_cvt_pk_bf16_f32 v133, v134, v135
    v_cvt_pk_bf16_f32 v134, v24, v25
    v_cvt_pk_bf16_f32 v135, v26, v27
    v_accvgpr_read_b32 v20, a104
    v_accvgpr_read_b32 v21, a105
    v_accvgpr_read_b32 v22, a106
    v_accvgpr_read_b32 v23, a107
    v_cvt_pk_bf16_f32 v136, v136, v137
    v_cvt_pk_bf16_f32 v137, v138, v139
    v_cvt_pk_bf16_f32 v138, v20, v21
    v_cvt_pk_bf16_f32 v139, v22, v23
    v_accvgpr_read_b32 v24, a108
    v_accvgpr_read_b32 v25, a109
    v_accvgpr_read_b32 v26, a110
    v_accvgpr_read_b32 v27, a111
    v_cvt_pk_bf16_f32 v140, v140, v141
    v_cvt_pk_bf16_f32 v141, v142, v143
    v_cvt_pk_bf16_f32 v142, v24, v25
    v_cvt_pk_bf16_f32 v143, v26, v27
    v_accvgpr_read_b32 v242, a200
    v_accvgpr_read_b32 v243, a201
    v_accvgpr_read_b32 v244, a202
    v_accvgpr_read_b32 v245, a203
    v_accvgpr_read_b32 v246, a204
    v_accvgpr_read_b32 v247, a205
    v_accvgpr_read_b32 v248, a206
    v_accvgpr_read_b32 v249, a207
    v_accvgpr_read_b32 v250, a208
    v_accvgpr_read_b32 v251, a209
    v_accvgpr_read_b32 v252, a210
    v_accvgpr_read_b32 v253, a211
    s_waitcnt lgkmcnt(0)
    v_mfma_f32_16x16x32_bf16 v[64:67], v[210:213], v[128:131], 0
    v_mfma_f32_16x16x32_bf16 v[96:99], v[160:163], v[132:135], 0
    v_mfma_f32_16x16x32_bf16 v[68:71], v[160:163], v[128:131], 0
    v_mfma_f32_16x16x32_bf16 v[100:103], v[164:167], v[132:135], 0
    s_nop 4
    v_pk_fma_f32 v[64:65], v[64:65], s[94:95], v[250:251]
    v_pk_fma_f32 v[96:97], v[96:97], s[94:95], v[246:247]
    v_pk_fma_f32 v[66:67], v[66:67], s[94:95], v[252:253]
    v_pk_fma_f32 v[98:99], v[98:99], s[94:95], v[248:249]
    v_pk_fma_f32 v[68:69], v[68:69], s[94:95], v[242:243]
    v_pk_fma_f32 v[100:101], v[100:101], s[94:95], v[242:243]
    v_pk_fma_f32 v[70:71], v[70:71], s[94:95], v[244:245]
    v_pk_fma_f32 v[102:103], v[102:103], s[94:95], v[244:245]
    v_max3_f32 v72, v64, v65, v66
    v_max3_f32 v104, v96, v97, v98
    v_max3_f32 v73, v67, v68, v69
    v_max3_f32 v105, v99, v100, v101
    v_max3_f32 v72, v72, v70, v71
    v_max3_f32 v104, v104, v102, v103
    v_max_f32 v72, v72, v73
    v_max_f32 v104, v104, v105
    v_mov_b32 v73, v72
    v_mov_b32 v105, v104
    s_nop 0
    v_permlane32_swap_b32 v72, v73
    v_permlane32_swap_b32 v104, v105
    v_max_f32 v72, v72, v73
    v_max_f32 v104, v104, v105
    v_mov_b32 v73, v72
    v_mov_b32 v105, v104
    s_nop 0
    v_permlane16_swap_b32 v72, v73
    v_permlane16_swap_b32 v104, v105
    v_max_f32 v72, v72, v73
    v_max_f32 v104, v104, v105
    v_mov_b32 v73, v72
    v_mov_b32 v105, v104
    v_pk_add_f32 v[64:65], v[64:65], v[72:73] neg_lo:[0,1] neg_hi:[0,1]
    v_pk_add_f32 v[96:97], v[96:97], v[104:105] neg_lo:[0,1] neg_hi:[0,1]
    v_pk_add_f32 v[66:67], v[66:67], v[72:73] neg_lo:[0,1] neg_hi:[0,1]
    v_pk_add_f32 v[98:99], v[98:99], v[104:105] neg_lo:[0,1] neg_hi:[0,1]
    v_pk_add_f32 v[68:69], v[68:69], v[72:73] neg_lo:[0,1] neg_hi:[0,1]
    v_pk_add_f32 v[100:101], v[100:101], v[104:105] neg_lo:[0,1] neg_hi:[0,1]
    v_pk_add_f32 v[70:71], v[70:71], v[72:73] neg_lo:[0,1] neg_hi:[0,1]
    v_pk_add_f32 v[102:103], v[102:103], v[104:105] neg_lo:[0,1] neg_hi:[0,1]
    v_exp_f32 v64, v64
    v_exp_f32 v96, v96
    v_exp_f32 v65, v65
    v_exp_f32 v97, v97
    v_exp_f32 v66, v66
    v_exp_f32 v98, v98
    v_exp_f32 v67, v67
    v_exp_f32 v99, v99
    v_exp_f32 v68, v68
    v_exp_f32 v100, v100
    v_exp_f32 v69, v69
    v_exp_f32 v101, v101
    v_exp_f32 v70, v70
    v_exp_f32 v102, v102
    v_exp_f32 v71, v71
    v_exp_f32 v103, v103
    v_cvt_pk_bf16_f32 v76, v64, v65
    v_cvt_pk_bf16_f32 v108, v96, v97
    v_cvt_pk_bf16_f32 v77, v66, v67
    v_cvt_pk_bf16_f32 v109, v98, v99
    v_cvt_pk_bf16_f32 v78, v68, v69
    v_cvt_pk_bf16_f32 v110, v100, v101
    v_cvt_pk_bf16_f32 v79, v70, v71
    v_cvt_pk_bf16_f32 v111, v102, v103
    s_nop 0
    v_mfma_f32_16x16x32_bf16 v[88:91], a[212:215], v[76:79], 0
    v_mfma_f32_16x16x32_bf16 v[120:123], a[212:215], v[108:111], 0
    v_mfma_f32_16x16x32_bf16 v[80:83], v[192:195], v[76:79], 0
    v_mfma_f32_16x16x32_bf16 v[112:115], v[194:197], v[108:111], 0
    v_mfma_f32_16x16x32_bf16 v[84:87], v[224:227], v[76:79], 0
    v_mfma_f32_16x16x32_bf16 v[116:119], v[226:229], v[108:111], 0
    s_nop 2
    v_rcp_f32 v88, v88
    v_rcp_f32 v120, v120
    v_mov_b32 v89, v88
    v_mov_b32 v121, v120
    v_pk_mul_f32 v[80:81], v[80:81], v[88:89]
    v_pk_mul_f32 v[112:113], v[112:113], v[120:121]
    v_pk_mul_f32 v[82:83], v[82:83], v[88:89]
    v_pk_mul_f32 v[114:115], v[114:115], v[120:121]
    v_pk_mul_f32 v[84:85], v[84:85], v[88:89]
    v_pk_mul_f32 v[116:117], v[116:117], v[120:121]
    v_pk_mul_f32 v[86:87], v[86:87], v[88:89]
    v_pk_mul_f32 v[118:119], v[118:119], v[120:121]
    v_cvt_pk_bf16_f32 v48, v80, v81
    v_cvt_pk_bf16_f32 v52, v112, v113
    v_cvt_pk_bf16_f32 v49, v82, v83
    v_cvt_pk_bf16_f32 v53, v114, v115
    v_cvt_pk_bf16_f32 v50, v84, v85
    v_cvt_pk_bf16_f32 v54, v116, v117
    v_cvt_pk_bf16_f32 v51, v86, v87
    v_cvt_pk_bf16_f32 v55, v118, v119
    s_add_u32 s60, s100, 2500
    v_mov_b32 v38, s60
    v_xor_b32 v39, s101, v38
    s_lshl_b32 s60, s2, 2
    s_add_u32 s60, s60, s51
    s_lshl_b32 s60, s60, 7
    s_add_u32 s60, s60, 524288
    v_mov_b32 v40, s60
    s_waitcnt vmcnt(0)
    s_mov_b64 exec, 1
    buffer_store_dwordx2 v[38:39], v40, s[96:99], 0 offen sc1
    s_mov_b64 exec, -1
    s_and_b32 s3, s2, 7
    s_lshr_b32 s41, s3, 2
    s_and_b32 s3, s3, 3
    s_lshl_b32 s3, s3, 2
    s_lshr_b32 s60, s2, 3
    s_and_b32 s43, s60, 7
    s_lshr_b32 s60, s60, 3
    s_add_u32 s42, s3, s60
    s_and_b32 s3, s51, 1
    s_mul_i32 s60, s41, 22
    v_add_u32 v44, s60, v1
    v_add_u32 v45, 10, v1
    v_cmp_gt_u32 vcc, 22, v1
    s_nop 1
    v_cndmask_b32 v44, v45, v44, vcc
    v_mul_u32_u24 v45, 21846, v44
    v_lshrrev_b32 v45, 16, v45
    v_lshl_add_u32 v44, v45, 2, v44
    s_lshl_b32 s60, s52, 2
    s_add_u32 s60, s60, 32
    v_add_u32 v44, s60, v44
    s_mul_i32 s60, s41, 24
    s_add_u32 s60, s60, s52
    s_sub_u32 s60, s60, 44
    v_lshl_add_u32 v45, v1, 1, s60
    s_mul_i32 s60, s52, 7
    s_sub_u32 s60, s60, 329
    v_mul_u32_u24 v46, 14, v1
    v_add_u32 v46, s60, v46
    s_cmp_eq_u32 s41, 0
    s_cselect_b32 s60, 63, 26
    v_cmp_gt_u32 vcc, s60, v1
    s_nop 1
    v_cndmask_b32 v45, v46, v45, vcc
    v_subrev_u32 v46, 22, v1
    v_cmp_gt_u32 vcc, 12, v46
    s_nop 1
    v_cndmask_b32 v42, v44, v45, vcc
    s_lshl_b32 s60, s3, 12
    s_lshl_b32 s61, s42, 13
    s_add_u32 s60, s60, s61
    v_lshl_add_u32 v32, v1, 4, s60
    s_lshl_b32 s38, s51, 12
    s_add_u32 s39, s38, 81920
    v_lshrrev_b32 v44, 4, v1
    v_and_b32 v45, 15, v1
    s_lshl_b32 s60, s3, 15
    s_lshl_b32 s61, s43, 8
    s_add_u32 s60, s60, s61
    v_lshl_add_u32 v47, v44, 11, s60
    v_lshlrev_b32 v46, 1, v44
    v_xor_b32 v46, v46, v45
    v_lshl_add_u32 v33, v46, 4, v47
    v_xor_b32 v34, 128, v33
    v_add_u32 v34, 8192, v34
    v_add_u32 v35, 16384, v33
    v_add_u32 v36, 16384, v34
    s_mov_b32 s54, 2097152
    s_mov_b32 s55, 7340032
    s_mov_b32 s15, 0x20000
    s_add_u32 s8, s6, 4194304
    s_addc_u32 s9, s7, 0
    s_mov_b32 s10, 18874368
    s_mov_b32 s11, 0x20000
    s_lshr_b32 s60, s42, 1
    s_lshl_b32 s60, s60, 14
    s_and_b32 s61, s42, 1
    s_lshl_b32 s61, s61, 8
    s_add_u32 s60, s60, s61
    s_add_u32 s60, s60, 524288
    v_lshrrev_b32 v44, 1, v1
    v_lshl_add_u32 v41, v44, 9, s60
    v_and_b32 v44, 1, v1
    v_lshl_add_u32 v41, v44, 7, v41
    s_mov_b32 s53, -1
    s_add_u32 s53, s53, 1
    v_readlane_b32 s37, v42, s53
    s_nop 1
    s_lshl_b32 s36, s37, 17
    s_cmp_lt_u32 s37, 32
    s_cselect_b32 s12, s92, s68
    s_cselect_b32 s13, s93, s69
    s_cselect_b32 s14, s54, s55
    s_cselect_b32 s60, 0, 32
    s_sub_u32 s37, s37, s60
    s_lshl_b32 s37, s37, 16
    s_add_u32 m0, s39, 0
    s_nop 0
    buffer_load_dwordx4 v33, s[12:15], s37 offen sc1 lds
    s_add_u32 m0, s39, 1024
    s_nop 0
    buffer_load_dwordx4 v34, s[12:15], s37 offen sc1 lds
    s_add_u32 m0, s39, 2048
    s_nop 0
    buffer_load_dwordx4 v35, s[12:15], s37 offen sc1 lds
    s_add_u32 m0, s39, 3072
    s_nop 0
    buffer_load_dwordx4 v36, s[12:15], s37 offen sc1 lds
    s_add_u32 s53, s53, 1
    v_readlane_b32 s37, v42, s53
    s_nop 1
    s_lshl_b32 s36, s37, 17
    s_cmp_lt_u32 s37, 32
    s_cselect_b32 s12, s92, s68
    s_cselect_b32 s13, s93, s69
    s_cselect_b32 s14, s54, s55
    s_cselect_b32 s60, 0, 32
    s_sub_u32 s37, s37, s60
    s_lshl_b32 s37, s37, 16
    s_add_u32 m0, s39, 16384
    s_nop 0
    buffer_load_dwordx4 v33, s[12:15], s37 offen sc1 lds
    s_add_u32 m0, s39, 17408
    s_nop 0
    buffer_load_dwordx4 v34, s[12:15], s37 offen sc1 lds
    s_add_u32 m0, s39, 18432
    s_nop 0
    buffer_load_dwordx4 v35, s[12:15], s37 offen sc1 lds
    s_add_u32 m0, s39, 19456
    s_nop 0
    buffer_load_dwordx4 v36, s[12:15], s37 offen sc1 lds
    s_add_u32 s53, s53, 1
    v_readlane_b32 s37, v42, s53
    s_nop 1
    s_lshl_b32 s36, s37, 17
    s_cmp_lt_u32 s37, 32
    s_cselect_b32 s12, s92, s68
    s_cselect_b32 s13, s93, s69
    s_cselect_b32 s14, s54, s55
    s_cselect_b32 s60, 0, 32
    s_sub_u32 s37, s37, s60
    s_lshl_b32 s37, s37, 16
    s_add_u32 m0, s39, 32768
    s_nop 0
    buffer_load_dwordx4 v33, s[12:15], s37 offen sc1 lds
    s_add_u32 m0, s39, 33792
    s_nop 0
    buffer_load_dwordx4 v34, s[12:15], s37 offen sc1 lds
    s_add_u32 m0, s39, 34816
    s_nop 0
    buffer_load_dwordx4 v35, s[12:15], s37 offen sc1 lds
    s_add_u32 m0, s39, 35840
    s_nop 0
    buffer_load_dwordx4 v36, s[12:15], s37 offen sc1 lds
    s_add_u32 s53, s53, 1
    v_readlane_b32 s37, v42, s53
    s_nop 1
    s_lshl_b32 s36, s37, 17
    s_cmp_lt_u32 s37, 32
    s_cselect_b32 s12, s92, s68
    s_cselect_b32 s13, s93, s69
    s_cselect_b32 s14, s54, s55
    s_cselect_b32 s60, 0, 32
    s_sub_u32 s37, s37, s60
    s_lshl_b32 s37, s37, 16
    s_add_u32 m0, s39, 49152
    s_nop 0
    buffer_load_dwordx4 v33, s[12:15], s37 offen sc1 lds
    s_add_u32 m0, s39, 50176
    s_nop 0
    buffer_load_dwordx4 v34, s[12:15], s37 offen sc1 lds
    s_add_u32 m0, s39, 51200
    s_nop 0
    buffer_load_dwordx4 v35, s[12:15], s37 offen sc1 lds
    s_add_u32 m0, s39, 52224
    s_nop 0
    buffer_load_dwordx4 v36, s[12:15], s37 offen sc1 lds
    s_add_u32 s53, s53, 1
    v_readlane_b32 s37, v42, s53
    s_nop 1
    s_lshl_b32 s36, s37, 17
    s_cmp_lt_u32 s37, 32
    s_cselect_b32 s12, s92, s68
    s_cselect_b32 s13, s93, s69
    s_cselect_b32 s14, s54, s55
    s_cselect_b32 s60, 0, 32
    s_sub_u32 s37, s37, s60
    s_lshl_b32 s37, s37, 16
    s_add_u32 m0, s39, 65536
    s_nop 0
    buffer_load_dwordx4 v33, s[12:15], s37 offen sc1 lds
    s_add_u32 m0, s39, 66560
    s_nop 0
    buffer_load_dwordx4 v34, s[12:15], s37 offen sc1 lds
    s_add_u32 m0, s39, 67584
    s_nop 0
    buffer_load_dwordx4 v35, s[12:15], s37 offen sc1 lds
    s_add_u32 m0, s39, 68608
    s_nop 0
    buffer_load_dwordx4 v36, s[12:15], s37 offen sc1 lds
    s_add_u32 s53, s53, 1
    v_readlane_b32 s37, v42, s53
    s_nop 1
    s_lshl_b32 s36, s37, 17
    s_cmp_lt_u32 s37, 32
    s_cselect_b32 s12, s92, s68
    s_cselect_b32 s13, s93, s69
    s_cselect_b32 s14, s54, s55
    s_cselect_b32 s60, 0, 32
    s_sub_u32 s37, s37, s60
    s_lshl_b32 s37, s37, 16
    v_mfma_f32_16x16x32_bf16 v[64:67], v[164:167], v[136:139], 0
    v_mfma_f32_16x16x32_bf16 v[96:99], v[168:171], v[140:143], 0
    v_mfma_f32_16x16x32_bf16 v[68:71], v[168:171], v[136:139], 0
    v_mfma_f32_16x16x32_bf16 v[100:103], v[172:175], v[140:143], 0
    s_nop 4
    v_pk_fma_f32 v[64:65], v[64:65], s[94:95], v[246:247]
    v_pk_fma_f32 v[96:97], v[96:97], s[94:95], v[246:247]
    v_pk_fma_f32 v[66:67], v[66:67], s[94:95], v[248:249]
    v_pk_fma_f32 v[98:99], v[98:99], s[94:95], v[248:249]
    v_pk_fma_f32 v[68:69], v[68:69], s[94:95], v[242:243]
    v_pk_fma_f32 v[100:101], v[100:101], s[94:95], v[242:243]
    v_pk_fma_f32 v[70:71], v[70:71], s[94:95], v[244:245]
    v_pk_fma_f32 v[102:103], v[102:103], s[94:95], v[244:245]
    v_max3_f32 v72, v64, v65, v66
    v_max3_f32 v104, v96, v97, v98
    v_max3_f32 v73, v67, v68, v69
    v_max3_f32 v105, v99, v100, v101
    v_max3_f32 v72, v72, v70, v71
    v_max3_f32 v104, v104, v102, v103
    v_max_f32 v72, v72, v73
    v_max_f32 v104, v104, v105
    v_mov_b32 v73, v72
    v_mov_b32 v105, v104
    s_nop 0
    v_permlane32_swap_b32 v72, v73
    v_permlane32_swap_b32 v104, v105
    v_max_f32 v72, v72, v73
    v_max_f32 v104, v104, v105
    v_mov_b32 v73, v72
    v_mov_b32 v105, v104
    s_nop 0
    v_permlane16_swap_b32 v72, v73
    v_permlane16_swap_b32 v104, v105
    v_max_f32 v72, v72, v73
    v_max_f32 v104, v104, v105
    v_mov_b32 v73, v72
    v_mov_b32 v105, v104
    v_pk_add_f32 v[64:65], v[64:65], v[72:73] neg_lo:[0,1] neg_hi:[0,1]
    v_pk_add_f32 v[96:97], v[96:97], v[104:105] neg_lo:[0,1] neg_hi:[0,1]
    v_pk_add_f32 v[66:67], v[66:67], v[72:73] neg_lo:[0,1] neg_hi:[0,1]
    v_pk_add_f32 v[98:99], v[98:99], v[104:105] neg_lo:[0,1] neg_hi:[0,1]
    v_pk_add_f32 v[68:69], v[68:69], v[72:73] neg_lo:[0,1] neg_hi:[0,1]
    v_pk_add_f32 v[100:101], v[100:101], v[104:105] neg_lo:[0,1] neg_hi:[0,1]
    v_pk_add_f32 v[70:71], v[70:71], v[72:73] neg_lo:[0,1] neg_hi:[0,1]
    v_pk_add_f32 v[102:103], v[102:103], v[104:105] neg_lo:[0,1] neg_hi:[0,1]
    v_exp_f32 v64, v64
    v_exp_f32 v96, v96
    v_exp_f32 v65, v65
    v_exp_f32 v97, v97
    v_exp_f32 v66, v66
    v_exp_f32 v98, v98
    v_exp_f32 v67, v67
    v_exp_f32 v99, v99
    v_exp_f32 v68, v68
    v_exp_f32 v100, v100
    v_exp_f32 v69, v69
    v_exp_f32 v101, v101
    v_exp_f32 v70, v70
    v_exp_f32 v102, v102
    v_exp_f32 v71, v71
    v_exp_f32 v103, v103
    v_cvt_pk_bf16_f32 v76, v64, v65
    v_cvt_pk_bf16_f32 v108, v96, v97
    v_cvt_pk_bf16_f32 v77, v66, v67
    v_cvt_pk_bf16_f32 v109, v98, v99
    v_cvt_pk_bf16_f32 v78, v68, v69
    v_cvt_pk_bf16_f32 v110, v100, v101
    v_cvt_pk_bf16_f32 v79, v70, v71
    v_cvt_pk_bf16_f32 v111, v102, v103
    s_nop 0
    v_mfma_f32_16x16x32_bf16 v[88:91], a[212:215], v[76:79], 0
    v_mfma_f32_16x16x32_bf16 v[120:123], a[212:215], v[108:111], 0
    v_mfma_f32_16x16x32_bf16 v[80:83], v[196:199], v[76:79], 0
    v_mfma_f32_16x16x32_bf16 v[112:115], v[198:201], v[108:111], 0
    v_mfma_f32_16x16x32_bf16 v[84:87], v[228:231], v[76:79], 0
    v_mfma_f32_16x16x32_bf16 v[116:119], v[230:233], v[108:111], 0
    s_nop 2
    v_rcp_f32 v88, v88
    v_rcp_f32 v120, v120
    v_mov_b32 v89, v88
    v_mov_b32 v121, v120
    v_pk_mul_f32 v[80:81], v[80:81], v[88:89]
    v_pk_mul_f32 v[112:113], v[112:113], v[120:121]
    v_pk_mul_f32 v[82:83], v[82:83], v[88:89]
    v_pk_mul_f32 v[114:115], v[114:115], v[120:121]
    v_pk_mul_f32 v[84:85], v[84:85], v[88:89]
    v_pk_mul_f32 v[116:117], v[116:117], v[120:121]
    v_pk_mul_f32 v[86:87], v[86:87], v[88:89]
    v_pk_mul_f32 v[118:119], v[118:119], v[120:121]
    v_cvt_pk_bf16_f32 v56, v80, v81
    v_cvt_pk_bf16_f32 v60, v112, v113
    v_cvt_pk_bf16_f32 v57, v82, v83
    v_cvt_pk_bf16_f32 v61, v114, v115
    v_cvt_pk_bf16_f32 v58, v84, v85
    v_cvt_pk_bf16_f32 v62, v116, v117
    v_cvt_pk_bf16_f32 v59, v86, v87
    v_cvt_pk_bf16_f32 v63, v118, v119
    s_mov_b32 s66, 0x80000000
    v_mov_b32 v46, v2
    v_mov_b32 v47, v2
    v_add_u32 v45, 0, v2
    s_cmp_lg_u32 s51, 0
    s_cbranch_scc1 L2_aok
    s_mov_b32 s3, 0
L2_apoll:
    buffer_load_dwordx2 v[24:25], v41, s[96:99], 0 offen sc1
    s_add_u32 s3, s3, 1
    s_waitcnt vmcnt(0)
    v_xor_b32 v25, v24, v25
    v_subrev_u32 v24, s100, v24
    v_lshrrev_b32 v24, 17, v24
    v_cmp_ne_u32 vcc, s101, v25
    v_cmp_ne_u32 s[60:61], 0, v24
    s_nop 1
    s_or_b64 exec, vcc, s[60:61]
    s_cbranch_execz L2_apoll_done
    s_cmp_lt_u32 s3, 0x8000
    s_cbranch_scc1 L2_apoll
L2_apoll_done:
    s_mov_b64 exec, -1
L2_aok:
    s_barrier
    v_readlane_b32 s60, v42, 0
    s_nop 1
    s_lshl_b32 s60, s60, 17
    s_add_u32 m0, s38, 0
    s_nop 0
    buffer_load_dwordx4 v32, s[8:11], s60 offen offset:0 sc1 lds
    buffer_load_dwordx4 v32, s[8:11], s60 offen offset:1024 sc1 lds
    buffer_load_dwordx4 v32, s[8:11], s60 offen offset:2048 sc1 lds
    buffer_load_dwordx4 v32, s[8:11], s60 offen offset:3072 sc1 lds
    v_readlane_b32 s60, v42, 1
    s_nop 1
    s_lshl_b32 s60, s60, 17
    s_add_u32 m0, s38, 16384
    s_nop 0
    buffer_load_dwordx4 v32, s[8:11], s60 offen offset:0 sc1 lds
    buffer_load_dwordx4 v32, s[8:11], s60 offen offset:1024 sc1 lds
    buffer_load_dwordx4 v32, s[8:11], s60 offen offset:2048 sc1 lds
    buffer_load_dwordx4 v32, s[8:11], s60 offen offset:3072 sc1 lds
    v_readlane_b32 s60, v42, 2
    s_nop 1
    s_lshl_b32 s60, s60, 17
    s_add_u32 m0, s38, 32768
    s_nop 0
    buffer_load_dwordx4 v32, s[8:11], s60 offen offset:0 sc1 lds
    buffer_load_dwordx4 v32, s[8:11], s60 offen offset:1024 sc1 lds
    buffer_load_dwordx4 v32, s[8:11], s60 offen offset:2048 sc1 lds
    buffer_load_dwordx4 v32, s[8:11], s60 offen offset:3072 sc1 lds
    v_readlane_b32 s60, v42, 3
    s_nop 1
    s_lshl_b32 s60, s60, 17
    s_add_u32 m0, s38, 49152
    s_nop 0
    buffer_load_dwordx4 v32, s[8:11], s60 offen offset:0 sc1 lds
    buffer_load_dwordx4 v32, s[8:11], s60 offen offset:1024 sc1 lds
    buffer_load_dwordx4 v32, s[8:11], s60 offen offset:2048 sc1 lds
    buffer_load_dwordx4 v32, s[8:11], s60 offen offset:3072 sc1 lds
    v_readlane_b32 s60, v42, 4
    s_nop 1
    s_lshl_b32 s60, s60, 17
    s_add_u32 m0, s38, 65536
    s_nop 0
    buffer_load_dwordx4 v32, s[8:11], s60 offen offset:0 sc1 lds
    buffer_load_dwordx4 v32, s[8:11], s60 offen offset:1024 sc1 lds
    buffer_load_dwordx4 v32, s[8:11], s60 offen offset:2048 sc1 lds
    buffer_load_dwordx4 v32, s[8:11], s60 offen offset:3072 sc1 lds
    s_branch L2_late
L1_wn1:
    s_waitcnt vmcnt(8)
    s_barrier
    ds_read_b64_tr_b16 a[220:221], v11 offset:6272
    ds_read_b64_tr_b16 a[222:223], v11 offset:9856
    ds_read_b128 a[0:3], v9 offset:0
    ds_read_b128 a[4:7], v9 offset:1024
    ds_read_b128 a[8:11], v9 offset:2048
    ds_read_b128 a[12:15], v9 offset:3072
    ds_read_b128 a[16:19], v9 offset:4096
    ds_read_b128 a[20:23], v9 offset:5120
    ds_read_b128 a[24:27], v9 offset:6144
    ds_read_b128 a[28:31], v9 offset:7168
    ds_read_b128 a[64:67], v10 offset:0
    ds_read_b64_tr_b16 a[88:89], v17 offset:0
    ds_read_b64_tr_b16 a[90:91], v17 offset:3072
    s_waitcnt lgkmcnt(10)
    v_mfma_f32_16x16x32_bf16 v[96:99], a[220:223], a[0:3], 0
    ds_read_b64_tr_b16 a[228:229], v11 offset:13440
    s_waitcnt lgkmcnt(10)
    v_mfma_f32_16x16x32_bf16 v[100:103], a[220:223], a[4:7], 0
    ds_read_b64_tr_b16 a[230:231], v11 offset:17024
    s_add_u32 m0, s47, 32768
    s_waitcnt lgkmcnt(10)
    v_mfma_f32_16x16x32_bf16 v[104:107], a[220:223], a[8:11], 0
    buffer_load_dwordx4 v2, s[8:11], s36 offen offset:0 sc1 lds
    buffer_load_dwordx4 v2, s[8:11], s36 offen offset:1024 sc1 lds
    s_waitcnt lgkmcnt(9)
    v_mfma_f32_16x16x32_bf16 v[108:111], a[220:223], a[12:15], 0
    buffer_load_dwordx4 v2, s[8:11], s36 offen offset:2048 sc1 lds
    buffer_load_dwordx4 v2, s[8:11], s36 offen offset:3072 sc1 lds
    s_waitcnt lgkmcnt(8)
    v_mfma_f32_16x16x32_bf16 v[112:115], a[220:223], a[16:19], 0
    s_add_u32 m0, s49, 2048
    s_waitcnt lgkmcnt(7)
    v_mfma_f32_16x16x32_bf16 v[116:119], a[220:223], a[20:23], 0
    buffer_load_dword v3, s[8:11], s36 offen sc1 lds
    s_add_u32 s36, s36, 131072
    s_waitcnt lgkmcnt(6)
    v_mfma_f32_16x16x32_bf16 v[120:123], a[220:223], a[24:27], 0
    s_add_u32 m0, s48, 40960
    s_waitcnt lgkmcnt(5)
    v_mfma_f32_16x16x32_bf16 v[124:127], a[220:223], a[28:31], 0
    buffer_load_dwordx4 v4, s[12:15], s37 offen sc1 lds
    s_add_u32 s37, s37, s42
    s_waitcnt lgkmcnt(0)
    v_mfma_f32_16x16x32_bf16 a[96:99], a[228:231], a[0:3], 0
    ds_read_b64_tr_b16 a[236:237], v11 offset:6304
    s_add_u32 m0, s48, 41984
    v_mfma_f32_16x16x32_bf16 a[100:103], a[228:231], a[4:7], 0
    ds_read_b64_tr_b16 a[238:239], v11 offset:9888
    buffer_load_dwordx4 v5, s[16:19], s38 offen sc1 lds
    v_mfma_f32_16x16x32_bf16 a[104:107], a[228:231], a[8:11], 0
    s_add_u32 s38, s38, s43
    s_add_u32 m0, s48, 43008
    v_mfma_f32_16x16x32_bf16 a[108:111], a[228:231], a[12:15], 0
    buffer_load_dwordx4 v6, s[20:23], s39 offen sc1 lds
    s_add_u32 s39, s39, s44
    v_mfma_f32_16x16x32_bf16 a[112:115], a[228:231], a[16:19], 0
    s_add_u32 m0, s48, 44032
    v_mfma_f32_16x16x32_bf16 a[116:119], a[228:231], a[20:23], 0
    buffer_load_dwordx4 v7, s[24:27], s40 offen sc1 lds
    s_add_u32 s40, s40, s45
    v_mfma_f32_16x16x32_bf16 a[192:195], a[88:91], a[64:67], 0
    v_mfma_f32_16x16x32_bf16 a[120:123], a[228:231], a[24:27], 0
    s_add_u32 m0, s48, 45056
    v_mfma_f32_16x16x32_bf16 a[124:127], a[228:231], a[28:31], 0
    buffer_load_dwordx4 v8, s[28:31], s41 offen sc1 lds
    s_add_u32 s41, s41, s46
    s_waitcnt lgkmcnt(0)
    v_mfma_f32_16x16x32_bf16 v[128:131], a[236:239], a[0:3], 0
    ds_read_b64_tr_b16 a[244:245], v11 offset:13472
    buffer_load_dword v31, v19, s[88:91], s86 offen
    v_mfma_f32_16x16x32_bf16 v[132:135], a[236:239], a[4:7], 0
    ds_read_b64_tr_b16 a[246:247], v11 offset:17056
    s_add_u32 s86, s86, s87
    v_mfma_f32_16x16x32_bf16 v[136:139], a[236:239], a[8:11], 0
    ds_read_b64_tr_b16 a[220:221], v11 offset:13504
    v_mfma_f32_16x16x32_bf16 v[140:143], a[236:239], a[12:15], 0
    ds_read_b64_tr_b16 a[222:223], v11 offset:17088
    v_mfma_f32_16x16x32_bf16 v[144:147], a[236:239], a[16:19], 0
    v_mfma_f32_16x16x32_bf16 v[148:151], a[236:239], a[20:23], 0
    v_mfma_f32_16x16x32_bf16 v[152:155], a[236:239], a[24:27], 0
    v_mfma_f32_16x16x32_bf16 v[156:159], a[236:239], a[28:31], 0
    s_waitcnt vmcnt(14) lgkmcnt(0)
    s_barrier
    v_mfma_f32_16x16x32_bf16 a[128:131], a[244:247], a[0:3], 0
    ds_read_b128 a[32:35], v9 offset:16384
    v_mfma_f32_16x16x32_bf16 a[160:163], a[220:223], a[0:3], 0
    ds_read_b64_tr_b16 a[224:225], v11 offset:6208
    v_mfma_f32_16x16x32_bf16 a[132:135], a[244:247], a[4:7], 0
    ds_read_b128 a[36:39], v9 offset:17408
    v_mfma_f32_16x16x32_bf16 a[164:167], a[220:223], a[4:7], 0
    ds_read_b64_tr_b16 a[226:227], v11 offset:9792
    v_mfma_f32_16x16x32_bf16 a[136:139], a[244:247], a[8:11], 0
    ds_read_b128 a[40:43], v9 offset:18432
    v_mfma_f32_16x16x32_bf16 a[168:171], a[220:223], a[8:11], 0
    ds_read_b64_tr_b16 a[228:229], v11 offset:26688
    v_mfma_f32_16x16x32_bf16 a[140:143], a[244:247], a[12:15], 0
    ds_read_b128 a[44:47], v9 offset:19456
    v_mfma_f32_16x16x32_bf16 a[172:175], a[220:223], a[12:15], 0
    ds_read_b64_tr_b16 a[230:231], v11 offset:30272
    v_mfma_f32_16x16x32_bf16 a[144:147], a[244:247], a[16:19], 0
    ds_read_b128 a[48:51], v9 offset:20480
    v_mfma_f32_16x16x32_bf16 a[176:179], a[220:223], a[16:19], 0
    ds_read_b128 a[64:67], v10 offset:1024
    v_mfma_f32_16x16x32_bf16 a[148:151], a[244:247], a[20:23], 0
    ds_read_b128 a[52:55], v9 offset:21504
    v_mfma_f32_16x16x32_bf16 a[180:183], a[220:223], a[20:23], 0
    ds_read_b64_tr_b16 a[88:89], v17 offset:20480
    v_mfma_f32_16x16x32_bf16 a[152:155], a[244:247], a[24:27], 0
    ds_read_b128 a[56:59], v9 offset:22528
    v_mfma_f32_16x16x32_bf16 a[184:187], a[220:223], a[24:27], 0
    ds_read_b64_tr_b16 a[90:91], v17 offset:23552
    v_mfma_f32_16x16x32_bf16 a[156:159], a[244:247], a[28:31], 0
    ds_read_b128 a[60:63], v9 offset:23552
    v_mfma_f32_16x16x32_bf16 a[188:191], a[220:223], a[28:31], 0
    s_add_u32 m0, s47, 49152
    s_waitcnt lgkmcnt(11)
    v_mfma_f32_16x16x32_bf16 v[32:35], a[224:227], a[0:3], 0
    ds_read_b64_tr_b16 a[232:233], v11 offset:13376
    s_waitcnt lgkmcnt(8)
    v_mfma_f32_16x16x32_bf16 v[32:35], a[228:231], a[32:35], v[32:35]
    ds_read_b64_tr_b16 a[234:235], v11 offset:16960
    v_mfma_f32_16x16x32_bf16 v[36:39], a[224:227], a[4:7], 0
    ds_read_b64_tr_b16 a[236:237], v11 offset:33856
    v_mfma_f32_16x16x32_bf16 v[36:39], a[228:231], a[36:39], v[36:39]
    ds_read_b64_tr_b16 a[238:239], v11 offset:37440
    v_mfma_f32_16x16x32_bf16 v[40:43], a[224:227], a[8:11], 0
    buffer_load_dwordx4 v2, s[8:11], s36 offen offset:0 sc1 lds
    v_mfma_f32_16x16x32_bf16 v[40:43], a[228:231], a[40:43], v[40:43]
    v_mfma_f32_16x16x32_bf16 v[44:47], a[224:227], a[12:15], 0
    buffer_load_dwordx4 v2, s[8:11], s36 offen offset:1024 sc1 lds
    v_mfma_f32_16x16x32_bf16 v[44:47], a[228:231], a[44:47], v[44:47]
    v_mfma_f32_16x16x32_bf16 v[48:51], a[224:227], a[16:19], 0
    buffer_load_dwordx4 v2, s[8:11], s36 offen offset:2048 sc1 lds
    s_waitcnt lgkmcnt(10)
    v_mfma_f32_16x16x32_bf16 v[48:51], a[228:231], a[48:51], v[48:51]
    v_mfma_f32_16x16x32_bf16 v[52:55], a[224:227], a[20:23], 0
    buffer_load_dwordx4 v2, s[8:11], s36 offen offset:3072 sc1 lds
    s_waitcnt lgkmcnt(8)
    v_mfma_f32_16x16x32_bf16 v[52:55], a[228:231], a[52:55], v[52:55]
    s_add_u32 m0, s49, 3072
    v_mfma_f32_16x16x32_bf16 v[56:59], a[224:227], a[24:27], 0
    buffer_load_dword v3, s[8:11], s36 offen sc1 lds
    s_waitcnt lgkmcnt(6)
    v_mfma_f32_16x16x32_bf16 v[56:59], a[228:231], a[56:59], v[56:59]
    s_add_u32 s36, s36, 131072
    v_mfma_f32_16x16x32_bf16 v[60:63], a[224:227], a[28:31], 0
    s_add_u32 m0, s48, 61440
    s_waitcnt lgkmcnt(4)
    v_mfma_f32_16x16x32_bf16 v[60:63], a[228:231], a[60:63], v[60:63]
    buffer_load_dwordx4 v4, s[12:15], s37 offen sc1 lds
    s_waitcnt lgkmcnt(0)
    v_mfma_f32_16x16x32_bf16 v[192:195], a[232:235], a[0:3], 0
    ds_read_b64_tr_b16 a[240:241], v11 offset:6240
    v_mfma_f32_16x16x32_bf16 v[192:195], a[236:239], a[32:35], v[192:195]
    ds_read_b64_tr_b16 a[242:243], v11 offset:9824
    v_mfma_f32_16x16x32_bf16 v[196:199], a[232:235], a[4:7], 0
    ds_read_b64_tr_b16 a[244:245], v11 offset:26720
    v_mfma_f32_16x16x32_bf16 v[196:199], a[236:239], a[36:39], v[196:199]
    ds_read_b64_tr_b16 a[246:247], v11 offset:30304
    v_mfma_f32_16x16x32_bf16 v[200:203], a[232:235], a[8:11], 0
    s_add_u32 s37, s37, s42
    v_mfma_f32_16x16x32_bf16 v[200:203], a[236:239], a[40:43], v[200:203]
    s_add_u32 m0, s48, 62464
    v_mfma_f32_16x16x32_bf16 a[192:195], a[88:91], a[64:67], a[192:195]
    v_mfma_f32_16x16x32_bf16 v[204:207], a[232:235], a[12:15], 0
    buffer_load_dwordx4 v5, s[16:19], s38 offen sc1 lds
    v_mfma_f32_16x16x32_bf16 v[204:207], a[236:239], a[44:47], v[204:207]
    s_add_u32 s38, s38, s43
    v_mfma_f32_16x16x32_bf16 v[208:211], a[232:235], a[16:19], 0
    s_add_u32 m0, s48, 63488
    v_mfma_f32_16x16x32_bf16 v[208:211], a[236:239], a[48:51], v[208:211]
    buffer_load_dwordx4 v6, s[20:23], s39 offen sc1 lds
    v_mfma_f32_16x16x32_bf16 v[212:215], a[232:235], a[20:23], 0
    s_add_u32 s39, s39, s44
    v_mfma_f32_16x16x32_bf16 v[212:215], a[236:239], a[52:55], v[212:215]
    s_add_u32 m0, s48, 64512
    v_mfma_f32_16x16x32_bf16 v[216:219], a[232:235], a[24:27], 0
    buffer_load_dwordx4 v7, s[24:27], s40 offen sc1 lds
    v_mfma_f32_16x16x32_bf16 v[216:219], a[236:239], a[56:59], v[216:219]
    s_add_u32 s40, s40, s45
    v_mfma_f32_16x16x32_bf16 v[220:223], a[232:235], a[28:31], 0
    s_add_u32 m0, s48, 65536
    v_mfma_f32_16x16x32_bf16 v[220:223], a[236:239], a[60:63], v[220:223]
    buffer_load_dwordx4 v8, s[28:31], s41 offen sc1 lds
    s_waitcnt lgkmcnt(0)
    v_mfma_f32_16x16x32_bf16 v[64:67], a[240:243], a[0:3], 0
    ds_read_b64_tr_b16 a[216:217], v11 offset:13408
    v_mfma_f32_16x16x32_bf16 v[64:67], a[244:247], a[32:35], v[64:67]
    ds_read_b64_tr_b16 a[218:219], v11 offset:16992
    v_mfma_f32_16x16x32_bf16 v[68:71], a[240:243], a[4:7], 0
    ds_read_b64_tr_b16 a[220:221], v11 offset:33888
    v_mfma_f32_16x16x32_bf16 v[68:71], a[244:247], a[36:39], v[68:71]
    ds_read_b64_tr_b16 a[222:223], v11 offset:37472
    v_mfma_f32_16x16x32_bf16 v[72:75], a[240:243], a[8:11], 0
    ds_read_b64_tr_b16 a[224:225], v11 offset:6336
    v_mfma_f32_16x16x32_bf16 v[72:75], a[244:247], a[40:43], v[72:75]
    ds_read_b64_tr_b16 a[226:227], v11 offset:9920
    v_mfma_f32_16x16x32_bf16 v[76:79], a[240:243], a[12:15], 0
    ds_read_b64_tr_b16 a[228:229], v11 offset:26816
    v_mfma_f32_16x16x32_bf16 v[76:79], a[244:247], a[44:47], v[76:79]
    ds_read_b64_tr_b16 a[230:231], v11 offset:30400
    v_mfma_f32_16x16x32_bf16 v[80:83], a[240:243], a[16:19], 0
    s_add_u32 s41, s41, s46
    v_mfma_f32_16x16x32_bf16 v[80:83], a[244:247], a[48:51], v[80:83]
    buffer_load_dword v31, v19, s[88:91], s86 offen
    v_mfma_f32_16x16x32_bf16 v[84:87], a[240:243], a[20:23], 0
    s_add_u32 s86, s86, s87
    v_mfma_f32_16x16x32_bf16 v[84:87], a[244:247], a[52:55], v[84:87]
    v_mfma_f32_16x16x32_bf16 v[88:91], a[240:243], a[24:27], 0
    v_mfma_f32_16x16x32_bf16 v[88:91], a[244:247], a[56:59], v[88:91]
    v_mfma_f32_16x16x32_bf16 v[92:95], a[240:243], a[28:31], 0
    v_mfma_f32_16x16x32_bf16 v[92:95], a[244:247], a[60:63], v[92:95]
    s_waitcnt vmcnt(12) lgkmcnt(0)
    s_barrier
    v_mfma_f32_16x16x32_bf16 v[224:227], a[216:219], a[0:3], 0
    ds_read_b64_tr_b16 a[232:233], v11 offset:26752
    v_mfma_f32_16x16x32_bf16 v[224:227], a[220:223], a[32:35], v[224:227]
    s_add_u32 m0, s47, 0
    v_mfma_f32_16x16x32_bf16 v[160:163], a[224:227], a[0:3], 0
    ds_read_b128 a[0:3], v9 offset:32768
    v_mfma_f32_16x16x32_bf16 v[160:163], a[228:231], a[32:35], v[160:163]
    buffer_load_dwordx4 v2, s[8:11], s36 offen offset:0 sc1 lds
    v_mfma_f32_16x16x32_bf16 v[228:231], a[216:219], a[4:7], 0
    ds_read_b64_tr_b16 a[234:235], v11 offset:30336
    v_mfma_f32_16x16x32_bf16 v[228:231], a[220:223], a[36:39], v[228:231]
    v_mfma_f32_16x16x32_bf16 v[164:167], a[224:227], a[4:7], 0
    ds_read_b128 a[4:7], v9 offset:33792
    v_mfma_f32_16x16x32_bf16 v[164:167], a[228:231], a[36:39], v[164:167]
    buffer_load_dwordx4 v2, s[8:11], s36 offen offset:1024 sc1 lds
    v_mfma_f32_16x16x32_bf16 v[232:235], a[216:219], a[8:11], 0
    ds_read_b64_tr_b16 a[236:237], v12 offset:6272
    v_mfma_f32_16x16x32_bf16 v[232:235], a[220:223], a[40:43], v[232:235]
    v_mfma_f32_16x16x32_bf16 v[168:171], a[224:227], a[8:11], 0
    ds_read_b128 a[8:11], v9 offset:34816
    v_mfma_f32_16x16x32_bf16 v[168:171], a[228:231], a[40:43], v[168:171]
    buffer_load_dwordx4 v2, s[8:11], s36 offen offset:2048 sc1 lds
    v_mfma_f32_16x16x32_bf16 v[236:239], a[216:219], a[12:15], 0
    ds_read_b64_tr_b16 a[238:239], v12 offset:9856
    v_mfma_f32_16x16x32_bf16 v[236:239], a[220:223], a[44:47], v[236:239]
    v_mfma_f32_16x16x32_bf16 v[172:175], a[224:227], a[12:15], 0
    ds_read_b128 a[12:15], v9 offset:35840
    v_mfma_f32_16x16x32_bf16 v[172:175], a[228:231], a[44:47], v[172:175]
    buffer_load_dwordx4 v2, s[8:11], s36 offen offset:3072 sc1 lds
    v_mfma_f32_16x16x32_bf16 v[240:243], a[216:219], a[16:19], 0
    ds_read_b128 a[64:67], v10 offset:2048
    v_mfma_f32_16x16x32_bf16 v[240:243], a[220:223], a[48:51], v[240:243]
    s_add_u32 m0, s49, 0
    v_mfma_f32_16x16x32_bf16 v[176:179], a[224:227], a[16:19], 0
    ds_read_b128 a[16:19], v9 offset:36864
    v_mfma_f32_16x16x32_bf16 v[176:179], a[228:231], a[48:51], v[176:179]
    buffer_load_dword v3, s[8:11], s36 offen sc1 lds
    v_mfma_f32_16x16x32_bf16 v[244:247], a[216:219], a[20:23], 0
    ds_read_b64_tr_b16 a[88:89], v18 offset:0
    v_mfma_f32_16x16x32_bf16 v[244:247], a[220:223], a[52:55], v[244:247]
    s_add_u32 s36, s36, 131072
    v_mfma_f32_16x16x32_bf16 v[180:183], a[224:227], a[20:23], 0
    ds_read_b128 a[20:23], v9 offset:37888
    v_mfma_f32_16x16x32_bf16 v[180:183], a[228:231], a[52:55], v[180:183]
    s_add_u32 m0, s48, 0
    v_mfma_f32_16x16x32_bf16 v[248:251], a[216:219], a[24:27], 0
    ds_read_b64_tr_b16 a[90:91], v18 offset:3072
    v_mfma_f32_16x16x32_bf16 v[248:251], a[220:223], a[56:59], v[248:251]
    buffer_load_dwordx4 v4, s[12:15], s37 offen sc1 lds
    v_mfma_f32_16x16x32_bf16 v[184:187], a[224:227], a[24:27], 0
    ds_read_b128 a[24:27], v9 offset:38912
    v_mfma_f32_16x16x32_bf16 v[184:187], a[228:231], a[56:59], v[184:187]
    s_add_u32 s37, s37, s42
    v_mfma_f32_16x16x32_bf16 v[252:255], a[216:219], a[28:31], 0
    s_add_u32 m0, s48, 1024
    v_mfma_f32_16x16x32_bf16 v[252:255], a[220:223], a[60:63], v[252:255]
    buffer_load_dwordx4 v5, s[16:19], s38 offen sc1 lds
    v_mfma_f32_16x16x32_bf16 v[188:191], a[224:227], a[28:31], 0
    ds_read_b128 a[28:31], v9 offset:39936
    v_mfma_f32_16x16x32_bf16 v[188:191], a[228:231], a[60:63], v[188:191]
    s_add_u32 s38, s38, s43
L1_loop1:
    s_waitcnt lgkmcnt(12)
    v_mfma_f32_16x16x32_bf16 v[96:99], a[232:235], a[32:35], v[96:99]
    ds_read_b64_tr_b16 a[240:241], v11 offset:33920
    s_waitcnt lgkmcnt(9)
    v_mfma_f32_16x16x32_bf16 v[96:99], a[236:239], a[0:3], v[96:99]
    ds_read_b64_tr_b16 a[242:243], v11 offset:37504
    v_mfma_f32_16x16x32_bf16 v[100:103], a[232:235], a[36:39], v[100:103]
    ds_read_b64_tr_b16 a[244:245], v12 offset:13440
    v_mfma_f32_16x16x32_bf16 v[100:103], a[236:239], a[4:7], v[100:103]
    ds_read_b64_tr_b16 a[246:247], v12 offset:17024
    v_mfma_f32_16x16x32_bf16 v[104:107], a[232:235], a[40:43], v[104:107]
    s_add_u32 m0, s48, 2048
    v_mfma_f32_16x16x32_bf16 v[104:107], a[236:239], a[8:11], v[104:107]
    buffer_load_dwordx4 v6, s[20:23], s39 offen sc1 lds
    v_mfma_f32_16x16x32_bf16 v[108:111], a[232:235], a[44:47], v[108:111]
    s_add_u32 s39, s39, s44
    s_waitcnt lgkmcnt(11)
    v_mfma_f32_16x16x32_bf16 v[108:111], a[236:239], a[12:15], v[108:111]
    s_add_u32 m0, s48, 3072
    v_mfma_f32_16x16x32_bf16 v[112:115], a[232:235], a[48:51], v[112:115]
    s_waitcnt lgkmcnt(9)
    v_mfma_f32_16x16x32_bf16 v[112:115], a[236:239], a[16:19], v[112:115]
    buffer_load_dwordx4 v7, s[24:27], s40 offen sc1 lds
    v_mfma_f32_16x16x32_bf16 v[116:119], a[232:235], a[52:55], v[116:119]
    s_add_u32 s40, s40, s45
    s_waitcnt lgkmcnt(7)
    v_mfma_f32_16x16x32_bf16 v[116:119], a[236:239], a[20:23], v[116:119]
    s_add_u32 m0, s48, 4096
    v_mfma_f32_16x16x32_bf16 v[120:123], a[232:235], a[56:59], v[120:123]
    s_waitcnt lgkmcnt(5)
    v_mfma_f32_16x16x32_bf16 v[120:123], a[236:239], a[24:27], v[120:123]
    buffer_load_dwordx4 v8, s[28:31], s41 offen sc1 lds
    v_mfma_f32_16x16x32_bf16 v[124:127], a[232:235], a[60:63], v[124:127]
    s_add_u32 s41, s41, s46
    s_waitcnt lgkmcnt(4)
    v_mfma_f32_16x16x32_bf16 v[124:127], a[236:239], a[28:31], v[124:127]
    s_waitcnt lgkmcnt(0)
    v_mfma_f32_16x16x32_bf16 a[96:99], a[240:243], a[32:35], a[96:99]
    ds_read_b64_tr_b16 a[216:217], v11 offset:26784
    v_mfma_f32_16x16x32_bf16 a[96:99], a[244:247], a[0:3], a[96:99]
    ds_read_b64_tr_b16 a[218:219], v11 offset:30368
    v_mfma_f32_16x16x32_bf16 a[100:103], a[240:243], a[36:39], a[100:103]
    ds_read_b64_tr_b16 a[220:221], v12 offset:6304
    v_mfma_f32_16x16x32_bf16 a[100:103], a[244:247], a[4:7], a[100:103]
    ds_read_b64_tr_b16 a[222:223], v12 offset:9888
    v_mfma_f32_16x16x32_bf16 a[104:107], a[240:243], a[40:43], a[104:107]
    buffer_load_dword v31, v19, s[88:91], s86 offen
    v_mfma_f32_16x16x32_bf16 a[104:107], a[244:247], a[8:11], a[104:107]
    s_add_u32 s86, s86, s87
    v_mfma_f32_16x16x32_bf16 a[192:195], a[88:91], a[64:67], a[192:195]
    v_mfma_f32_16x16x32_bf16 a[108:111], a[240:243], a[44:47], a[108:111]
    v_mfma_f32_16x16x32_bf16 a[108:111], a[244:247], a[12:15], a[108:111]
    v_mfma_f32_16x16x32_bf16 a[112:115], a[240:243], a[48:51], a[112:115]
    v_mfma_f32_16x16x32_bf16 a[112:115], a[244:247], a[16:19], a[112:115]
    v_mfma_f32_16x16x32_bf16 a[116:119], a[240:243], a[52:55], a[116:119]
    v_mfma_f32_16x16x32_bf16 a[116:119], a[244:247], a[20:23], a[116:119]
    v_mfma_f32_16x16x32_bf16 a[120:123], a[240:243], a[56:59], a[120:123]
    v_mfma_f32_16x16x32_bf16 a[120:123], a[244:247], a[24:27], a[120:123]
    v_mfma_f32_16x16x32_bf16 a[124:127], a[240:243], a[60:63], a[124:127]
    v_mfma_f32_16x16x32_bf16 a[124:127], a[244:247], a[28:31], a[124:127]
    s_waitcnt lgkmcnt(0)
    v_mfma_f32_16x16x32_bf16 v[128:131], a[216:219], a[32:35], v[128:131]
    ds_read_b64_tr_b16 a[224:225], v11 offset:33952
    v_mfma_f32_16x16x32_bf16 v[128:131], a[220:223], a[0:3], v[128:131]
    ds_read_b64_tr_b16 a[226:227], v11 offset:37536
    v_mfma_f32_16x16x32_bf16 v[132:135], a[216:219], a[36:39], v[132:135]
    ds_read_b64_tr_b16 a[228:229], v12 offset:13472
    v_mfma_f32_16x16x32_bf16 v[132:135], a[220:223], a[4:7], v[132:135]
    ds_read_b64_tr_b16 a[230:231], v12 offset:17056
    v_mfma_f32_16x16x32_bf16 v[136:139], a[216:219], a[40:43], v[136:139]
    ds_read_b64_tr_b16 a[232:233], v11 offset:33984
    v_mfma_f32_16x16x32_bf16 v[136:139], a[220:223], a[8:11], v[136:139]
    ds_read_b64_tr_b16 a[234:235], v11 offset:37568
    v_mfma_f32_16x16x32_bf16 v[140:143], a[216:219], a[44:47], v[140:143]
    ds_read_b64_tr_b16 a[236:237], v12 offset:13504
    v_mfma_f32_16x16x32_bf16 v[140:143], a[220:223], a[12:15], v[140:143]
    ds_read_b64_tr_b16 a[238:239], v12 offset:17088
    v_mfma_f32_16x16x32_bf16 v[144:147], a[216:219], a[48:51], v[144:147]
    v_mfma_f32_16x16x32_bf16 v[144:147], a[220:223], a[16:19], v[144:147]
    v_mfma_f32_16x16x32_bf16 v[148:151], a[216:219], a[52:55], v[148:151]
    v_mfma_f32_16x16x32_bf16 v[148:151], a[220:223], a[20:23], v[148:151]
    v_mfma_f32_16x16x32_bf16 v[152:155], a[216:219], a[56:59], v[152:155]
    v_mfma_f32_16x16x32_bf16 v[152:155], a[220:223], a[24:27], v[152:155]
    v_mfma_f32_16x16x32_bf16 v[156:159], a[216:219], a[60:63], v[156:159]
    v_mfma_f32_16x16x32_bf16 v[156:159], a[220:223], a[28:31], v[156:159]
    s_waitcnt vmcnt(12) lgkmcnt(0)
    s_barrier
    v_mfma_f32_16x16x32_bf16 a[128:131], a[224:227], a[32:35], a[128:131]
    ds_read_b64_tr_b16 a[240:241], v12 offset:6208
    v_mfma_f32_16x16x32_bf16 a[128:131], a[228:231], a[0:3], a[128:131]
    s_add_u32 m0, s47, 16384
    v_mfma_f32_16x16x32_bf16 a[160:163], a[232:235], a[32:35], a[160:163]
    ds_read_b128 a[32:35], v9 offset:49152
    v_mfma_f32_16x16x32_bf16 a[160:163], a[236:239], a[0:3], a[160:163]
    buffer_load_dwordx4 v2, s[8:11], s36 offen offset:0 sc1 lds
    v_mfma_f32_16x16x32_bf16 a[132:135], a[224:227], a[36:39], a[132:135]
    ds_read_b64_tr_b16 a[242:243], v12 offset:9792
    v_mfma_f32_16x16x32_bf16 a[132:135], a[228:231], a[4:7], a[132:135]
    v_mfma_f32_16x16x32_bf16 a[164:167], a[232:235], a[36:39], a[164:167]
    ds_read_b128 a[36:39], v9 offset:50176
    v_mfma_f32_16x16x32_bf16 a[164:167], a[236:239], a[4:7], a[164:167]
    buffer_load_dwordx4 v2, s[8:11], s36 offen offset:1024 sc1 lds
    v_mfma_f32_16x16x32_bf16 a[136:139], a[224:227], a[40:43], a[136:139]
    ds_read_b64_tr_b16 a[244:245], v12 offset:26688
    v_mfma_f32_16x16x32_bf16 a[136:139], a[228:231], a[8:11], a[136:139]
    v_mfma_f32_16x16x32_bf16 a[168:171], a[232:235], a[40:43], a[168:171]
    ds_read_b128 a[40:43], v9 offset:51200
    v_mfma_f32_16x16x32_bf16 a[168:171], a[236:239], a[8:11], a[168:171]
    buffer_load_dwordx4 v2, s[8:11], s36 offen offset:2048 sc1 lds
    v_mfma_f32_16x16x32_bf16 a[140:143], a[224:227], a[44:47], a[140:143]
    ds_read_b64_tr_b16 a[246:247], v12 offset:30272
    v_mfma_f32_16x16x32_bf16 a[140:143], a[228:231], a[12:15], a[140:143]
    v_mfma_f32_16x16x32_bf16 a[172:175], a[232:235], a[44:47], a[172:175]
    ds_read_b128 a[44:47], v9 offset:52224
    v_mfma_f32_16x16x32_bf16 a[172:175], a[236:239], a[12:15], a[172:175]
    buffer_load_dwordx4 v2, s[8:11], s36 offen offset:3072 sc1 lds
    v_mfma_f32_16x16x32_bf16 a[144:147], a[224:227], a[48:51], a[144:147]
    ds_read_b128 a[64:67], v10 offset:3072
    v_mfma_f32_16x16x32_bf16 a[144:147], a[228:231], a[16:19], a[144:147]
    s_add_u32 m0, s49, 1024
    v_mfma_f32_16x16x32_bf16 a[176:179], a[232:235], a[48:51], a[176:179]
    ds_read_b128 a[48:51], v9 offset:53248
    v_mfma_f32_16x16x32_bf16 a[176:179], a[236:239], a[16:19], a[176:179]
    buffer_load_dword v3, s[8:11], s36 offen sc1 lds
    v_mfma_f32_16x16x32_bf16 a[148:151], a[224:227], a[52:55], a[148:151]
    ds_read_b64_tr_b16 a[88:89], v18 offset:20480
    v_mfma_f32_16x16x32_bf16 a[148:151], a[228:231], a[20:23], a[148:151]
    s_add_u32 s36, s36, 131072
    v_mfma_f32_16x16x32_bf16 a[180:183], a[232:235], a[52:55], a[180:183]
    ds_read_b128 a[52:55], v9 offset:54272
    v_mfma_f32_16x16x32_bf16 a[180:183], a[236:239], a[20:23], a[180:183]
    s_add_u32 m0, s48, 20480
    v_mfma_f32_16x16x32_bf16 a[152:155], a[224:227], a[56:59], a[152:155]
    ds_read_b64_tr_b16 a[90:91], v18 offset:23552
    v_mfma_f32_16x16x32_bf16 a[152:155], a[228:231], a[24:27], a[152:155]
    buffer_load_dwordx4 v4, s[12:15], s37 offen sc1 lds
    v_mfma_f32_16x16x32_bf16 a[184:187], a[232:235], a[56:59], a[184:187]
    ds_read_b128 a[56:59], v9 offset:55296
    v_mfma_f32_16x16x32_bf16 a[184:187], a[236:239], a[24:27], a[184:187]
    s_add_u32 s37, s37, s42
    v_mfma_f32_16x16x32_bf16 a[156:159], a[224:227], a[60:63], a[156:159]
    s_add_u32 m0, s48, 21504
    v_mfma_f32_16x16x32_bf16 a[156:159], a[228:231], a[28:31], a[156:159]
    buffer_load_dwordx4 v5, s[16:19], s38 offen sc1 lds
    v_mfma_f32_16x16x32_bf16 a[188:191], a[232:235], a[60:63], a[188:191]
    ds_read_b128 a[60:63], v9 offset:56320
    v_mfma_f32_16x16x32_bf16 a[188:191], a[236:239], a[28:31], a[188:191]
    s_add_u32 s38, s38, s43
    s_waitcnt lgkmcnt(12)
    v_mfma_f32_16x16x32_bf16 v[32:35], a[240:243], a[0:3], v[32:35]
    ds_read_b64_tr_b16 a[216:217], v12 offset:13376
    s_waitcnt lgkmcnt(9)
    v_mfma_f32_16x16x32_bf16 v[32:35], a[244:247], a[32:35], v[32:35]
    ds_read_b64_tr_b16 a[218:219], v12 offset:16960
    v_mfma_f32_16x16x32_bf16 v[36:39], a[240:243], a[4:7], v[36:39]
    ds_read_b64_tr_b16 a[220:221], v12 offset:33856
    v_mfma_f32_16x16x32_bf16 v[36:39], a[244:247], a[36:39], v[36:39]
    ds_read_b64_tr_b16 a[222:223], v12 offset:37440
    v_mfma_f32_16x16x32_bf16 v[40:43], a[240:243], a[8:11], v[40:43]
    s_add_u32 m0, s48, 22528
    v_mfma_f32_16x16x32_bf16 v[40:43], a[244:247], a[40:43], v[40:43]
    buffer_load_dwordx4 v6, s[20:23], s39 offen sc1 lds
    v_mfma_f32_16x16x32_bf16 v[44:47], a[240:243], a[12:15], v[44:47]
    s_add_u32 s39, s39, s44
    s_waitcnt lgkmcnt(11)
    v_mfma_f32_16x16x32_bf16 v[44:47], a[244:247], a[44:47], v[44:47]
    s_add_u32 m0, s48, 23552
    v_mfma_f32_16x16x32_bf16 v[48:51], a[240:243], a[16:19], v[48:51]
    s_waitcnt lgkmcnt(9)
    v_mfma_f32_16x16x32_bf16 v[48:51], a[244:247], a[48:51], v[48:51]
    buffer_load_dwordx4 v7, s[24:27], s40 offen sc1 lds
    v_mfma_f32_16x16x32_bf16 v[52:55], a[240:243], a[20:23], v[52:55]
    s_add_u32 s40, s40, s45
    s_waitcnt lgkmcnt(7)
    v_mfma_f32_16x16x32_bf16 v[52:55], a[244:247], a[52:55], v[52:55]
    s_add_u32 m0, s48, 24576
    v_mfma_f32_16x16x32_bf16 v[56:59], a[240:243], a[24:27], v[56:59]
    s_waitcnt lgkmcnt(5)
    v_mfma_f32_16x16x32_bf16 v[56:59], a[244:247], a[56:59], v[56:59]
    buffer_load_dwordx4 v8, s[28:31], s41 offen sc1 lds
    v_mfma_f32_16x16x32_bf16 v[60:63], a[240:243], a[28:31], v[60:63]
    s_add_u32 s41, s41, s46
    s_waitcnt lgkmcnt(4)
    v_mfma_f32_16x16x32_bf16 v[60:63], a[244:247], a[60:63], v[60:63]
    s_waitcnt lgkmcnt(0)
    v_mfma_f32_16x16x32_bf16 v[192:195], a[216:219], a[0:3], v[192:195]
    ds_read_b64_tr_b16 a[224:225], v12 offset:6240
    v_mfma_f32_16x16x32_bf16 v[192:195], a[220:223], a[32:35], v[192:195]
    ds_read_b64_tr_b16 a[226:227], v12 offset:9824
    v_mfma_f32_16x16x32_bf16 v[196:199], a[216:219], a[4:7], v[196:199]
    ds_read_b64_tr_b16 a[228:229], v12 offset:26720
    v_mfma_f32_16x16x32_bf16 v[196:199], a[220:223], a[36:39], v[196:199]
    ds_read_b64_tr_b16 a[230:231], v12 offset:30304
    v_mfma_f32_16x16x32_bf16 v[200:203], a[216:219], a[8:11], v[200:203]
    buffer_load_dword v31, v19, s[88:91], s86 offen
    v_mfma_f32_16x16x32_bf16 v[200:203], a[220:223], a[40:43], v[200:203]
    s_add_u32 s86, s86, s87
    v_mfma_f32_16x16x32_bf16 a[192:195], a[88:91], a[64:67], a[192:195]
    v_mfma_f32_16x16x32_bf16 v[204:207], a[216:219], a[12:15], v[204:207]
    v_mfma_f32_16x16x32_bf16 v[204:207], a[220:223], a[44:47], v[204:207]
    v_mfma_f32_16x16x32_bf16 v[208:211], a[216:219], a[16:19], v[208:211]
    v_mfma_f32_16x16x32_bf16 v[208:211], a[220:223], a[48:51], v[208:211]
    v_mfma_f32_16x16x32_bf16 v[212:215], a[216:219], a[20:23], v[212:215]
    v_mfma_f32_16x16x32_bf16 v[212:215], a[220:223], a[52:55], v[212:215]
    v_mfma_f32_16x16x32_bf16 v[216:219], a[216:219], a[24:27], v[216:219]
    v_mfma_f32_16x16x32_bf16 v[216:219], a[220:223], a[56:59], v[216:219]
    v_mfma_f32_16x16x32_bf16 v[220:223], a[216:219], a[28:31], v[220:223]
    v_mfma_f32_16x16x32_bf16 v[220:223], a[220:223], a[60:63], v[220:223]
    s_waitcnt lgkmcnt(0)
    v_mfma_f32_16x16x32_bf16 v[64:67], a[224:227], a[0:3], v[64:67]
    ds_read_b64_tr_b16 a[232:233], v12 offset:13408
    v_mfma_f32_16x16x32_bf16 v[64:67], a[228:231], a[32:35], v[64:67]
    ds_read_b64_tr_b16 a[234:235], v12 offset:16992
    v_mfma_f32_16x16x32_bf16 v[68:71], a[224:227], a[4:7], v[68:71]
    ds_read_b64_tr_b16 a[236:237], v12 offset:33888
    v_mfma_f32_16x16x32_bf16 v[68:71], a[228:231], a[36:39], v[68:71]
    ds_read_b64_tr_b16 a[238:239], v12 offset:37472
    v_mfma_f32_16x16x32_bf16 v[72:75], a[224:227], a[8:11], v[72:75]
    ds_read_b64_tr_b16 a[240:241], v12 offset:6336
    v_mfma_f32_16x16x32_bf16 v[72:75], a[228:231], a[40:43], v[72:75]
    ds_read_b64_tr_b16 a[242:243], v12 offset:9920
    v_mfma_f32_16x16x32_bf16 v[76:79], a[224:227], a[12:15], v[76:79]
    ds_read_b64_tr_b16 a[244:245], v12 offset:26816
    v_mfma_f32_16x16x32_bf16 v[76:79], a[228:231], a[44:47], v[76:79]
    ds_read_b64_tr_b16 a[246:247], v12 offset:30400
    v_mfma_f32_16x16x32_bf16 v[80:83], a[224:227], a[16:19], v[80:83]
    v_mfma_f32_16x16x32_bf16 v[80:83], a[228:231], a[48:51], v[80:83]
    v_mfma_f32_16x16x32_bf16 v[84:87], a[224:227], a[20:23], v[84:87]
    v_mfma_f32_16x16x32_bf16 v[84:87], a[228:231], a[52:55], v[84:87]
    v_mfma_f32_16x16x32_bf16 v[88:91], a[224:227], a[24:27], v[88:91]
    v_mfma_f32_16x16x32_bf16 v[88:91], a[228:231], a[56:59], v[88:91]
    v_mfma_f32_16x16x32_bf16 v[92:95], a[224:227], a[28:31], v[92:95]
    v_mfma_f32_16x16x32_bf16 v[92:95], a[228:231], a[60:63], v[92:95]
    s_waitcnt vmcnt(12) lgkmcnt(0)
    s_barrier
    v_mfma_f32_16x16x32_bf16 v[224:227], a[232:235], a[0:3], v[224:227]
    ds_read_b64_tr_b16 a[216:217], v12 offset:26752
    v_mfma_f32_16x16x32_bf16 v[224:227], a[236:239], a[32:35], v[224:227]
    s_add_u32 m0, s47, 32768
    v_mfma_f32_16x16x32_bf16 v[160:163], a[240:243], a[0:3], v[160:163]
    ds_read_b128 a[0:3], v9 offset:0
    v_mfma_f32_16x16x32_bf16 v[160:163], a[244:247], a[32:35], v[160:163]
    buffer_load_dwordx4 v2, s[8:11], s36 offen offset:0 sc1 lds
    v_mfma_f32_16x16x32_bf16 v[228:231], a[232:235], a[4:7], v[228:231]
    ds_read_b64_tr_b16 a[218:219], v12 offset:30336
    v_mfma_f32_16x16x32_bf16 v[228:231], a[236:239], a[36:39], v[228:231]
    v_mfma_f32_16x16x32_bf16 v[164:167], a[240:243], a[4:7], v[164:167]
    ds_read_b128 a[4:7], v9 offset:1024
    v_mfma_f32_16x16x32_bf16 v[164:167], a[244:247], a[36:39], v[164:167]
    buffer_load_dwordx4 v2, s[8:11], s36 offen offset:1024 sc1 lds
    v_mfma_f32_16x16x32_bf16 v[232:235], a[232:235], a[8:11], v[232:235]
    ds_read_b64_tr_b16 a[220:221], v11 offset:6272
    v_mfma_f32_16x16x32_bf16 v[232:235], a[236:239], a[40:43], v[232:235]
    v_mfma_f32_16x16x32_bf16 v[168:171], a[240:243], a[8:11], v[168:171]
    ds_read_b128 a[8:11], v9 offset:2048
    v_mfma_f32_16x16x32_bf16 v[168:171], a[244:247], a[40:43], v[168:171]
    buffer_load_dwordx4 v2, s[8:11], s36 offen offset:2048 sc1 lds
    v_mfma_f32_16x16x32_bf16 v[236:239], a[232:235], a[12:15], v[236:239]
    ds_read_b64_tr_b16 a[222:223], v11 offset:9856
    v_mfma_f32_16x16x32_bf16 v[236:239], a[236:239], a[44:47], v[236:239]
    v_mfma_f32_16x16x32_bf16 v[172:175], a[240:243], a[12:15], v[172:175]
    ds_read_b128 a[12:15], v9 offset:3072
    v_mfma_f32_16x16x32_bf16 v[172:175], a[244:247], a[44:47], v[172:175]
    buffer_load_dwordx4 v2, s[8:11], s36 offen offset:3072 sc1 lds
    v_mfma_f32_16x16x32_bf16 v[240:243], a[232:235], a[16:19], v[240:243]
    ds_read_b128 a[64:67], v10 offset:0
    v_mfma_f32_16x16x32_bf16 v[240:243], a[236:239], a[48:51], v[240:243]
    s_add_u32 m0, s49, 2048
    v_mfma_f32_16x16x32_bf16 v[176:179], a[240:243], a[16:19], v[176:179]
    ds_read_b128 a[16:19], v9 offset:4096
    v_mfma_f32_16x16x32_bf16 v[176:179], a[244:247], a[48:51], v[176:179]
    buffer_load_dword v3, s[8:11], s36 offen sc1 lds
    v_mfma_f32_16x16x32_bf16 v[244:247], a[232:235], a[20:23], v[244:247]
    ds_read_b64_tr_b16 a[88:89], v17 offset:0
    v_mfma_f32_16x16x32_bf16 v[244:247], a[236:239], a[52:55], v[244:247]
    s_add_u32 s36, s36, 131072
    v_mfma_f32_16x16x32_bf16 v[180:183], a[240:243], a[20:23], v[180:183]
    ds_read_b128 a[20:23], v9 offset:5120
    v_mfma_f32_16x16x32_bf16 v[180:183], a[244:247], a[52:55], v[180:183]
    s_add_u32 m0, s48, 40960
    v_mfma_f32_16x16x32_bf16 v[248:251], a[232:235], a[24:27], v[248:251]
    ds_read_b64_tr_b16 a[90:91], v17 offset:3072
    v_mfma_f32_16x16x32_bf16 v[248:251], a[236:239], a[56:59], v[248:251]
    buffer_load_dwordx4 v4, s[12:15], s37 offen sc1 lds
    v_mfma_f32_16x16x32_bf16 v[184:187], a[240:243], a[24:27], v[184:187]
    ds_read_b128 a[24:27], v9 offset:6144
    v_mfma_f32_16x16x32_bf16 v[184:187], a[244:247], a[56:59], v[184:187]
    s_add_u32 s37, s37, s42
    v_mfma_f32_16x16x32_bf16 v[252:255], a[232:235], a[28:31], v[252:255]
    s_add_u32 m0, s48, 41984
    v_mfma_f32_16x16x32_bf16 v[252:255], a[236:239], a[60:63], v[252:255]
    s_add_u32 s50, s50, 1
    v_mfma_f32_16x16x32_bf16 v[188:191], a[240:243], a[28:31], v[188:191]
    ds_read_b128 a[28:31], v9 offset:7168
    s_cmp_eq_u32 s50, 8
    v_mfma_f32_16x16x32_bf16 v[188:191], a[244:247], a[60:63], v[188:191]
    s_cbranch_scc1 L1_tail1
    s_waitcnt lgkmcnt(12)
    v_mfma_f32_16x16x32_bf16 v[96:99], a[216:219], a[32:35], v[96:99]
    ds_read_b64_tr_b16 a[224:225], v12 offset:33920
    s_waitcnt lgkmcnt(9)
    v_mfma_f32_16x16x32_bf16 v[96:99], a[220:223], a[0:3], v[96:99]
    ds_read_b64_tr_b16 a[226:227], v12 offset:37504
    v_mfma_f32_16x16x32_bf16 v[100:103], a[216:219], a[36:39], v[100:103]
    ds_read_b64_tr_b16 a[228:229], v11 offset:13440
    v_mfma_f32_16x16x32_bf16 v[100:103], a[220:223], a[4:7], v[100:103]
    ds_read_b64_tr_b16 a[230:231], v11 offset:17024
    v_mfma_f32_16x16x32_bf16 v[104:107], a[216:219], a[40:43], v[104:107]
    buffer_load_dwordx4 v5, s[16:19], s38 offen sc1 lds
    v_mfma_f32_16x16x32_bf16 v[104:107], a[220:223], a[8:11], v[104:107]
    s_add_u32 s38, s38, s43
    v_mfma_f32_16x16x32_bf16 v[108:111], a[216:219], a[44:47], v[108:111]
    s_add_u32 m0, s48, 43008
    s_waitcnt lgkmcnt(11)
    v_mfma_f32_16x16x32_bf16 v[108:111], a[220:223], a[12:15], v[108:111]
    v_mfma_f32_16x16x32_bf16 v[112:115], a[216:219], a[48:51], v[112:115]
    buffer_load_dwordx4 v6, s[20:23], s39 offen sc1 lds
    s_waitcnt lgkmcnt(9)
    v_mfma_f32_16x16x32_bf16 v[112:115], a[220:223], a[16:19], v[112:115]
    s_add_u32 s39, s39, s44
    v_mfma_f32_16x16x32_bf16 v[116:119], a[216:219], a[52:55], v[116:119]
    s_add_u32 m0, s48, 44032
    s_waitcnt lgkmcnt(7)
    v_mfma_f32_16x16x32_bf16 v[116:119], a[220:223], a[20:23], v[116:119]
    v_mfma_f32_16x16x32_bf16 v[120:123], a[216:219], a[56:59], v[120:123]
    buffer_load_dwordx4 v7, s[24:27], s40 offen sc1 lds
    s_waitcnt lgkmcnt(5)
    v_mfma_f32_16x16x32_bf16 v[120:123], a[220:223], a[24:27], v[120:123]
    s_add_u32 s40, s40, s45
    v_mfma_f32_16x16x32_bf16 v[124:127], a[216:219], a[60:63], v[124:127]
    s_add_u32 m0, s48, 45056
    s_waitcnt lgkmcnt(4)
    v_mfma_f32_16x16x32_bf16 v[124:127], a[220:223], a[28:31], v[124:127]
    s_waitcnt lgkmcnt(0)
    v_mfma_f32_16x16x32_bf16 a[96:99], a[224:227], a[32:35], a[96:99]
    ds_read_b64_tr_b16 a[232:233], v12 offset:26784
    v_mfma_f32_16x16x32_bf16 a[96:99], a[228:231], a[0:3], a[96:99]
    ds_read_b64_tr_b16 a[234:235], v12 offset:30368
    v_mfma_f32_16x16x32_bf16 a[100:103], a[224:227], a[36:39], a[100:103]
    ds_read_b64_tr_b16 a[236:237], v11 offset:6304
    v_mfma_f32_16x16x32_bf16 a[100:103], a[228:231], a[4:7], a[100:103]
    ds_read_b64_tr_b16 a[238:239], v11 offset:9888
    v_mfma_f32_16x16x32_bf16 a[104:107], a[224:227], a[40:43], a[104:107]
    buffer_load_dwordx4 v8, s[28:31], s41 offen sc1 lds
    v_mfma_f32_16x16x32_bf16 a[104:107], a[228:231], a[8:11], a[104:107]
    s_add_u32 s41, s41, s46
    v_mfma_f32_16x16x32_bf16 a[192:195], a[88:91], a[64:67], a[192:195]
    v_mfma_f32_16x16x32_bf16 a[108:111], a[224:227], a[44:47], a[108:111]
    v_mfma_f32_16x16x32_bf16 a[108:111], a[228:231], a[12:15], a[108:111]
    v_mfma_f32_16x16x32_bf16 a[112:115], a[224:227], a[48:51], a[112:115]
    buffer_load_dword v31, v19, s[88:91], s86 offen
    v_mfma_f32_16x16x32_bf16 a[112:115], a[228:231], a[16:19], a[112:115]
    s_add_u32 s86, s86, s87
    v_mfma_f32_16x16x32_bf16 a[116:119], a[224:227], a[52:55], a[116:119]
    v_mfma_f32_16x16x32_bf16 a[116:119], a[228:231], a[20:23], a[116:119]
    v_mfma_f32_16x16x32_bf16 a[120:123], a[224:227], a[56:59], a[120:123]
    v_mfma_f32_16x16x32_bf16 a[120:123], a[228:231], a[24:27], a[120:123]
    v_mfma_f32_16x16x32_bf16 a[124:127], a[224:227], a[60:63], a[124:127]
    v_mfma_f32_16x16x32_bf16 a[124:127], a[228:231], a[28:31], a[124:127]
    s_waitcnt lgkmcnt(0)
    v_mfma_f32_16x16x32_bf16 v[128:131], a[232:235], a[32:35], v[128:131]
    ds_read_b64_tr_b16 a[240:241], v12 offset:33952
    v_mfma_f32_16x16x32_bf16 v[128:131], a[236:239], a[0:3], v[128:131]
    ds_read_b64_tr_b16 a[242:243], v12 offset:37536
    v_mfma_f32_16x16x32_bf16 v[132:135], a[232:235], a[36:39], v[132:135]
    ds_read_b64_tr_b16 a[244:245], v11 offset:13472
    v_mfma_f32_16x16x32_bf16 v[132:135], a[236:239], a[4:7], v[132:135]
    ds_read_b64_tr_b16 a[246:247], v11 offset:17056
    v_mfma_f32_16x16x32_bf16 v[136:139], a[232:235], a[40:43], v[136:139]
    ds_read_b64_tr_b16 a[216:217], v12 offset:33984
    v_mfma_f32_16x16x32_bf16 v[136:139], a[236:239], a[8:11], v[136:139]
    ds_read_b64_tr_b16 a[218:219], v12 offset:37568
    v_mfma_f32_16x16x32_bf16 v[140:143], a[232:235], a[44:47], v[140:143]
    ds_read_b64_tr_b16 a[220:221], v11 offset:13504
    v_mfma_f32_16x16x32_bf16 v[140:143], a[236:239], a[12:15], v[140:143]
    ds_read_b64_tr_b16 a[222:223], v11 offset:17088
    v_mfma_f32_16x16x32_bf16 v[144:147], a[232:235], a[48:51], v[144:147]
    v_mfma_f32_16x16x32_bf16 v[144:147], a[236:239], a[16:19], v[144:147]
    v_mfma_f32_16x16x32_bf16 v[148:151], a[232:235], a[52:55], v[148:151]
    v_mfma_f32_16x16x32_bf16 v[148:151], a[236:239], a[20:23], v[148:151]
    v_mfma_f32_16x16x32_bf16 v[152:155], a[232:235], a[56:59], v[152:155]
    v_mfma_f32_16x16x32_bf16 v[152:155], a[236:239], a[24:27], v[152:155]
    v_mfma_f32_16x16x32_bf16 v[156:159], a[232:235], a[60:63], v[156:159]
    v_mfma_f32_16x16x32_bf16 v[156:159], a[236:239], a[28:31], v[156:159]
    s_waitcnt vmcnt(12) lgkmcnt(0)
    s_barrier
    v_mfma_f32_16x16x32_bf16 a[128:131], a[240:243], a[32:35], a[128:131]
    ds_read_b64_tr_b16 a[224:225], v11 offset:6208
    v_mfma_f32_16x16x32_bf16 a[128:131], a[244:247], a[0:3], a[128:131]
    s_add_u32 m0, s47, 49152
    v_mfma_f32_16x16x32_bf16 a[160:163], a[216:219], a[32:35], a[160:163]
    ds_read_b128 a[32:35], v9 offset:16384
    v_mfma_f32_16x16x32_bf16 a[160:163], a[220:223], a[0:3], a[160:163]
    buffer_load_dwordx4 v2, s[8:11], s36 offen offset:0 sc1 lds
    v_mfma_f32_16x16x32_bf16 a[132:135], a[240:243], a[36:39], a[132:135]
    ds_read_b64_tr_b16 a[226:227], v11 offset:9792
    v_mfma_f32_16x16x32_bf16 a[132:135], a[244:247], a[4:7], a[132:135]
    v_mfma_f32_16x16x32_bf16 a[164:167], a[216:219], a[36:39], a[164:167]
    ds_read_b128 a[36:39], v9 offset:17408
    v_mfma_f32_16x16x32_bf16 a[164:167], a[220:223], a[4:7], a[164:167]
    buffer_load_dwordx4 v2, s[8:11], s36 offen offset:1024 sc1 lds
    v_mfma_f32_16x16x32_bf16 a[136:139], a[240:243], a[40:43], a[136:139]
    ds_read_b64_tr_b16 a[228:229], v11 offset:26688
    v_mfma_f32_16x16x32_bf16 a[136:139], a[244:247], a[8:11], a[136:139]
    v_mfma_f32_16x16x32_bf16 a[168:171], a[216:219], a[40:43], a[168:171]
    ds_read_b128 a[40:43], v9 offset:18432
    v_mfma_f32_16x16x32_bf16 a[168:171], a[220:223], a[8:11], a[168:171]
    buffer_load_dwordx4 v2, s[8:11], s36 offen offset:2048 sc1 lds
    v_mfma_f32_16x16x32_bf16 a[140:143], a[240:243], a[44:47], a[140:143]
    ds_read_b64_tr_b16 a[230:231], v11 offset:30272
    v_mfma_f32_16x16x32_bf16 a[140:143], a[244:247], a[12:15], a[140:143]
    v_mfma_f32_16x16x32_bf16 a[172:175], a[216:219], a[44:47], a[172:175]
    ds_read_b128 a[44:47], v9 offset:19456
    v_mfma_f32_16x16x32_bf16 a[172:175], a[220:223], a[12:15], a[172:175]
    buffer_load_dwordx4 v2, s[8:11], s36 offen offset:3072 sc1 lds
    v_mfma_f32_16x16x32_bf16 a[144:147], a[240:243], a[48:51], a[144:147]
    ds_read_b128 a[64:67], v10 offset:1024
    v_mfma_f32_16x16x32_bf16 a[144:147], a[244:247], a[16:19], a[144:147]
    s_add_u32 m0, s49, 3072
    v_mfma_f32_16x16x32_bf16 a[176:179], a[216:219], a[48:51], a[176:179]
    ds_read_b128 a[48:51], v9 offset:20480
    v_mfma_f32_16x16x32_bf16 a[176:179], a[220:223], a[16:19], a[176:179]
    buffer_load_dword v3, s[8:11], s36 offen sc1 lds
    v_mfma_f32_16x16x32_bf16 a[148:151], a[240:243], a[52:55], a[148:151]
    ds_read_b64_tr_b16 a[88:89], v17 offset:20480
    v_mfma_f32_16x16x32_bf16 a[148:151], a[244:247], a[20:23], a[148:151]
    s_add_u32 s36, s36, 131072
    v_mfma_f32_16x16x32_bf16 a[180:183], a[216:219], a[52:55], a[180:183]
    ds_read_b128 a[52:55], v9 offset:21504
    v_mfma_f32_16x16x32_bf16 a[180:183], a[220:223], a[20:23], a[180:183]
    s_add_u32 m0, s48, 61440
    v_mfma_f32_16x16x32_bf16 a[152:155], a[240:243], a[56:59], a[152:155]
    ds_read_b64_tr_b16 a[90:91], v17 offset:23552
    v_mfma_f32_16x16x32_bf16 a[152:155], a[244:247], a[24:27], a[152:155]
    buffer_load_dwordx4 v4, s[12:15], s37 offen sc1 lds
    v_mfma_f32_16x16x32_bf16 a[184:187], a[216:219], a[56:59], a[184:187]
    ds_read_b128 a[56:59], v9 offset:22528
    v_mfma_f32_16x16x32_bf16 a[184:187], a[220:223], a[24:27], a[184:187]
    s_add_u32 s37, s37, s42
    v_mfma_f32_16x16x32_bf16 a[156:159], a[240:243], a[60:63], a[156:159]
    s_add_u32 m0, s48, 62464
    v_mfma_f32_16x16x32_bf16 a[156:159], a[244:247], a[28:31], a[156:159]
    buffer_load_dwordx4 v5, s[16:19], s38 offen sc1 lds
    v_mfma_f32_16x16x32_bf16 a[188:191], a[216:219], a[60:63], a[188:191]
    ds_read_b128 a[60:63], v9 offset:23552
    v_mfma_f32_16x16x32_bf16 a[188:191], a[220:223], a[28:31], a[188:191]
    s_add_u32 s38, s38, s43
    s_waitcnt lgkmcnt(12)
    v_mfma_f32_16x16x32_bf16 v[32:35], a[224:227], a[0:3], v[32:35]
    ds_read_b64_tr_b16 a[232:233], v11 offset:13376
    s_waitcnt lgkmcnt(9)
    v_mfma_f32_16x16x32_bf16 v[32:35], a[228:231], a[32:35], v[32:35]
    ds_read_b64_tr_b16 a[234:235], v11 offset:16960
    v_mfma_f32_16x16x32_bf16 v[36:39], a[224:227], a[4:7], v[36:39]
    ds_read_b64_tr_b16 a[236:237], v11 offset:33856
    v_mfma_f32_16x16x32_bf16 v[36:39], a[228:231], a[36:39], v[36:39]
    ds_read_b64_tr_b16 a[238:239], v11 offset:37440
    v_mfma_f32_16x16x32_bf16 v[40:43], a[224:227], a[8:11], v[40:43]
    s_add_u32 m0, s48, 63488
    v_mfma_f32_16x16x32_bf16 v[40:43], a[228:231], a[40:43], v[40:43]
    buffer_load_dwordx4 v6, s[20:23], s39 offen sc1 lds
    v_mfma_f32_16x16x32_bf16 v[44:47], a[224:227], a[12:15], v[44:47]
    s_add_u32 s39, s39, s44
    s_waitcnt lgkmcnt(11)
    v_mfma_f32_16x16x32_bf16 v[44:47], a[228:231], a[44:47], v[44:47]
    s_add_u32 m0, s48, 64512
    v_mfma_f32_16x16x32_bf16 v[48:51], a[224:227], a[16:19], v[48:51]
    s_waitcnt lgkmcnt(9)
    v_mfma_f32_16x16x32_bf16 v[48:51], a[228:231], a[48:51], v[48:51]
    buffer_load_dwordx4 v7, s[24:27], s40 offen sc1 lds
    v_mfma_f32_16x16x32_bf16 v[52:55], a[224:227], a[20:23], v[52:55]
    s_add_u32 s40, s40, s45
    s_waitcnt lgkmcnt(7)
    v_mfma_f32_16x16x32_bf16 v[52:55], a[228:231], a[52:55], v[52:55]
    s_add_u32 m0, s48, 65536
    v_mfma_f32_16x16x32_bf16 v[56:59], a[224:227], a[24:27], v[56:59]
    s_waitcnt lgkmcnt(5)
    v_mfma_f32_16x16x32_bf16 v[56:59], a[228:231], a[56:59], v[56:59]
    buffer_load_dwordx4 v8, s[28:31], s41 offen sc1 lds
    v_mfma_f32_16x16x32_bf16 v[60:63], a[224:227], a[28:31], v[60:63]
    s_add_u32 s41, s41, s46
    s_waitcnt lgkmcnt(4)
    v_mfma_f32_16x16x32_bf16 v[60:63], a[228:231], a[60:63], v[60:63]
    s_waitcnt lgkmcnt(0)
    v_mfma_f32_16x16x32_bf16 v[192:195], a[232:235], a[0:3], v[192:195]
    ds_read_b64_tr_b16 a[240:241], v11 offset:6240
    v_mfma_f32_16x16x32_bf16 v[192:195], a[236:239], a[32:35], v[192:195]
    ds_read_b64_tr_b16 a[242:243], v11 offset:9824
    v_mfma_f32_16x16x32_bf16 v[196:199], a[232:235], a[4:7], v[196:199]
    ds_read_b64_tr_b16 a[244:245], v11 offset:26720
    v_mfma_f32_16x16x32_bf16 v[196:199], a[236:239], a[36:39], v[196:199]
    ds_read_b64_tr_b16 a[246:247], v11 offset:30304
    v_mfma_f32_16x16x32_bf16 v[200:203], a[232:235], a[8:11], v[200:203]
    buffer_load_dword v31, v19, s[88:91], s86 offen
    v_mfma_f32_16x16x32_bf16 v[200:203], a[236:239], a[40:43], v[200:203]
    s_add_u32 s86, s86, s87
    v_mfma_f32_16x16x32_bf16 a[192:195], a[88:91], a[64:67], a[192:195]
    v_mfma_f32_16x16x32_bf16 v[204:207], a[232:235], a[12:15], v[204:207]
    v_mfma_f32_16x16x32_bf16 v[204:207], a[236:239], a[44:47], v[204:207]
    v_mfma_f32_16x16x32_bf16 v[208:211], a[232:235], a[16:19], v[208:211]
    v_mfma_f32_16x16x32_bf16 v[208:211], a[236:239], a[48:51], v[208:211]
    v_mfma_f32_16x16x32_bf16 v[212:215], a[232:235], a[20:23], v[212:215]
    v_mfma_f32_16x16x32_bf16 v[212:215], a[236:239], a[52:55], v[212:215]
    v_mfma_f32_16x16x32_bf16 v[216:219], a[232:235], a[24:27], v[216:219]
    v_mfma_f32_16x16x32_bf16 v[216:219], a[236:239], a[56:59], v[216:219]
    v_mfma_f32_16x16x32_bf16 v[220:223], a[232:235], a[28:31], v[220:223]
    v_mfma_f32_16x16x32_bf16 v[220:223], a[236:239], a[60:63], v[220:223]
    s_waitcnt lgkmcnt(0)
    v_mfma_f32_16x16x32_bf16 v[64:67], a[240:243], a[0:3], v[64:67]
    ds_read_b64_tr_b16 a[216:217], v11 offset:13408
    v_mfma_f32_16x16x32_bf16 v[64:67], a[244:247], a[32:35], v[64:67]
    ds_read_b64_tr_b16 a[218:219], v11 offset:16992
    v_mfma_f32_16x16x32_bf16 v[68:71], a[240:243], a[4:7], v[68:71]
    ds_read_b64_tr_b16 a[220:221], v11 offset:33888
    v_mfma_f32_16x16x32_bf16 v[68:71], a[244:247], a[36:39], v[68:71]
    ds_read_b64_tr_b16 a[222:223], v11 offset:37472
    v_mfma_f32_16x16x32_bf16 v[72:75], a[240:243], a[8:11], v[72:75]
    ds_read_b64_tr_b16 a[224:225], v11 offset:6336
    v_mfma_f32_16x16x32_bf16 v[72:75], a[244:247], a[40:43], v[72:75]
    ds_read_b64_tr_b16 a[226:227], v11 offset:9920
    v_mfma_f32_16x16x32_bf16 v[76:79], a[240:243], a[12:15], v[76:79]
    ds_read_b64_tr_b16 a[228:229], v11 offset:26816
    v_mfma_f32_16x16x32_bf16 v[76:79], a[244:247], a[44:47], v[76:79]
    ds_read_b64_tr_b16 a[230:231], v11 offset:30400
    v_mfma_f32_16x16x32_bf16 v[80:83], a[240:243], a[16:19], v[80:83]
    v_mfma_f32_16x16x32_bf16 v[80:83], a[244:247], a[48:51], v[80:83]
    v_mfma_f32_16x16x32_bf16 v[84:87], a[240:243], a[20:23], v[84:87]
    v_mfma_f32_16x16x32_bf16 v[84:87], a[244:247], a[52:55], v[84:87]
    v_mfma_f32_16x16x32_bf16 v[88:91], a[240:243], a[24:27], v[88:91]
    s_cmp_eq_u32 s50, 7
    v_mfma_f32_16x16x32_bf16 v[88:91], a[244:247], a[56:59], v[88:91]
    s_cselect_b32 s48, 170000, s48
    v_mfma_f32_16x16x32_bf16 v[92:95], a[240:243], a[28:31], v[92:95]
    s_cselect_b32 s47, 170000, s47
    v_mfma_f32_16x16x32_bf16 v[92:95], a[244:247], a[60:63], v[92:95]
    s_cselect_b32 s49, 170000, s49
    s_waitcnt vmcnt(12) lgkmcnt(0)
    s_barrier
    v_mfma_f32_16x16x32_bf16 v[224:227], a[216:219], a[0:3], v[224:227]
    ds_read_b64_tr_b16 a[232:233], v11 offset:26752
    v_mfma_f32_16x16x32_bf16 v[224:227], a[220:223], a[32:35], v[224:227]
    s_add_u32 m0, s47, 0
    v_mfma_f32_16x16x32_bf16 v[160:163], a[224:227], a[0:3], v[160:163]
    ds_read_b128 a[0:3], v9 offset:32768
    v_mfma_f32_16x16x32_bf16 v[160:163], a[228:231], a[32:35], v[160:163]
    buffer_load_dwordx4 v2, s[8:11], s36 offen offset:0 sc1 lds
    v_mfma_f32_16x16x32_bf16 v[228:231], a[216:219], a[4:7], v[228:231]
    ds_read_b64_tr_b16 a[234:235], v11 offset:30336
    v_mfma_f32_16x16x32_bf16 v[228:231], a[220:223], a[36:39], v[228:231]
    v_mfma_f32_16x16x32_bf16 v[164:167], a[224:227], a[4:7], v[164:167]
    ds_read_b128 a[4:7], v9 offset:33792
    v_mfma_f32_16x16x32_bf16 v[164:167], a[228:231], a[36:39], v[164:167]
    buffer_load_dwordx4 v2, s[8:11], s36 offen offset:1024 sc1 lds
    v_mfma_f32_16x16x32_bf16 v[232:235], a[216:219], a[8:11], v[232:235]
    ds_read_b64_tr_b16 a[236:237], v12 offset:6272
    v_mfma_f32_16x16x32_bf16 v[232:235], a[220:223], a[40:43], v[232:235]
    v_mfma_f32_16x16x32_bf16 v[168:171], a[224:227], a[8:11], v[168:171]
    ds_read_b128 a[8:11], v9 offset:34816
    v_mfma_f32_16x16x32_bf16 v[168:171], a[228:231], a[40:43], v[168:171]
    buffer_load_dwordx4 v2, s[8:11], s36 offen offset:2048 sc1 lds
    v_mfma_f32_16x16x32_bf16 v[236:239], a[216:219], a[12:15], v[236:239]
    ds_read_b64_tr_b16 a[238:239], v12 offset:9856
    v_mfma_f32_16x16x32_bf16 v[236:239], a[220:223], a[44:47], v[236:239]
    v_mfma_f32_16x16x32_bf16 v[172:175], a[224:227], a[12:15], v[172:175]
    ds_read_b128 a[12:15], v9 offset:35840
    v_mfma_f32_16x16x32_bf16 v[172:175], a[228:231], a[44:47], v[172:175]
    buffer_load_dwordx4 v2, s[8:11], s36 offen offset:3072 sc1 lds
    v_mfma_f32_16x16x32_bf16 v[240:243], a[216:219], a[16:19], v[240:243]
    ds_read_b128 a[64:67], v10 offset:2048
    v_mfma_f32_16x16x32_bf16 v[240:243], a[220:223], a[48:51], v[240:243]
    s_add_u32 m0, s49, 0
    v_mfma_f32_16x16x32_bf16 v[176:179], a[224:227], a[16:19], v[176:179]
    ds_read_b128 a[16:19], v9 offset:36864
    v_mfma_f32_16x16x32_bf16 v[176:179], a[228:231], a[48:51], v[176:179]
    buffer_load_dword v3, s[8:11], s36 offen sc1 lds
    v_mfma_f32_16x16x32_bf16 v[244:247], a[216:219], a[20:23], v[244:247]
    ds_read_b64_tr_b16 a[88:89], v18 offset:0
    v_mfma_f32_16x16x32_bf16 v[244:247], a[220:223], a[52:55], v[244:247]
    s_add_u32 s36, s36, 131072
    v_mfma_f32_16x16x32_bf16 v[180:183], a[224:227], a[20:23], v[180:183]
    ds_read_b128 a[20:23], v9 offset:37888
    v_mfma_f32_16x16x32_bf16 v[180:183], a[228:231], a[52:55], v[180:183]
    s_add_u32 m0, s48, 0
    v_mfma_f32_16x16x32_bf16 v[248:251], a[216:219], a[24:27], v[248:251]
    ds_read_b64_tr_b16 a[90:91], v18 offset:3072
    v_mfma_f32_16x16x32_bf16 v[248:251], a[220:223], a[56:59], v[248:251]
    buffer_load_dwordx4 v4, s[12:15], s37 offen sc1 lds
    v_mfma_f32_16x16x32_bf16 v[184:187], a[224:227], a[24:27], v[184:187]
    ds_read_b128 a[24:27], v9 offset:38912
    v_mfma_f32_16x16x32_bf16 v[184:187], a[228:231], a[56:59], v[184:187]
    s_add_u32 s37, s37, s42
    v_mfma_f32_16x16x32_bf16 v[252:255], a[216:219], a[28:31], v[252:255]
    s_add_u32 m0, s48, 1024
    v_mfma_f32_16x16x32_bf16 v[252:255], a[220:223], a[60:63], v[252:255]
    buffer_load_dwordx4 v5, s[16:19], s38 offen sc1 lds
    v_mfma_f32_16x16x32_bf16 v[188:191], a[224:227], a[28:31], v[188:191]
    ds_read_b128 a[28:31], v9 offset:39936
    v_mfma_f32_16x16x32_bf16 v[188:191], a[228:231], a[60:63], v[188:191]
    s_add_u32 s38, s38, s43
    s_branch L1_loop1
L1_tail1:
    s_waitcnt lgkmcnt(12)
    v_mfma_f32_16x16x32_bf16 v[96:99], a[216:219], a[32:35], v[96:99]
    ds_read_b64_tr_b16 a[224:225], v12 offset:33920
    v_mfma_f32_16x16x32_bf16 v[100:103], a[216:219], a[36:39], v[100:103]
    ds_read_b64_tr_b16 a[226:227], v12 offset:37504
    v_mfma_f32_16x16x32_bf16 v[104:107], a[216:219], a[40:43], v[104:107]
    v_mfma_f32_16x16x32_bf16 v[108:111], a[216:219], a[44:47], v[108:111]
    s_lshl_b32 s60, s54, 14
    s_lshl_b32 s61, s52, 13
    s_add_u32 s60, s60, s61
    v_lshl_add_u32 v2, v1, 4, s60
    v_mfma_f32_16x16x32_bf16 v[112:115], a[216:219], a[48:51], v[112:115]
    v_add_u32 v3, 4096, v2
    s_mul_i32 s62, s55, 7
    s_and_b32 s63, s55, 1
    v_mfma_f32_16x16x32_bf16 v[116:119], a[216:219], a[52:55], v[116:119]
    s_add_u32 s62, s62, s63
    s_lshr_b32 s62, s62, 1
    s_add_u32 s62, s62, 32
    v_mfma_f32_16x16x32_bf16 v[120:123], a[216:219], a[56:59], v[120:123]
    s_lshl_b32 s62, s62, 17
    s_add_u32 s64, s62, 131072
    s_add_u32 s65, s62, 262144
    v_mfma_f32_16x16x32_bf16 v[124:127], a[216:219], a[60:63], v[124:127]
    s_lshl_b32 s60, s52, 14
    s_add_u32 s60, s60, 4096
    v_lshl_add_u32 v4, v1, 4, s60
    s_waitcnt lgkmcnt(0)
    v_mfma_f32_16x16x32_bf16 a[96:99], a[224:227], a[32:35], a[96:99]
    ds_read_b64_tr_b16 a[232:233], v12 offset:26784
    v_and_b32 v20, 15, v1
    v_lshrrev_b32 v21, 4, v1
    v_lshl_add_u32 v5, v20, 5, s60
    v_mfma_f32_16x16x32_bf16 a[100:103], a[224:227], a[36:39], a[100:103]
    ds_read_b64_tr_b16 a[234:235], v12 offset:30368
    v_lshl_add_u32 v5, v21, 3, v5
    s_mul_i32 s60, s52, 40960
    s_sub_u32 s61, 40960, s60
    v_mfma_f32_16x16x32_bf16 a[104:107], a[224:227], a[40:43], a[104:107]
    v_lshl_add_u32 v6, v1, 4, s60
    v_lshl_add_u32 v7, v21, 7, s61
    v_lshl_add_u32 v7, v20, 1, v7
    v_accvgpr_read_b32 v20, a192
    v_mfma_f32_16x16x32_bf16 a[108:111], a[224:227], a[44:47], a[108:111]
    v_accvgpr_read_b32 v21, a193
    v_accvgpr_read_b32 v22, a194
    v_accvgpr_read_b32 v23, a195
    v_mfma_f32_16x16x32_bf16 a[112:115], a[224:227], a[48:51], a[112:115]
    v_cvt_pk_bf16_f32 v24, v20, v21
    v_cvt_pk_bf16_f32 v25, v22, v23
    ds_write_b64 v6, v[24:25] offset:8
    v_mfma_f32_16x16x32_bf16 a[116:119], a[224:227], a[52:55], a[116:119]
    ds_write_b16 v7, v24 offset:1536
    ds_write_b16_d16_hi v7, v24 offset:1568
    ds_write_b16 v7, v25 offset:1600
    v_mfma_f32_16x16x32_bf16 a[120:123], a[224:227], a[56:59], a[120:123]
    ds_write_b16_d16_hi v7, v25 offset:1632
    s_mov_b32 s94, 0x3e8293ee
    s_mov_b32 s95, 0x3e8293ee
    v_mfma_f32_16x16x32_bf16 a[124:127], a[224:227], a[60:63], a[124:127]
    s_lshl_b32 s67, s55, 17
    s_add_u32 s66, s62, 393216
    s_sub_u32 s61, s62, 131072
    s_waitcnt lgkmcnt(5)
    v_mfma_f32_16x16x32_bf16 v[128:131], a[232:235], a[32:35], v[128:131]
    ds_read_b64_tr_b16 a[240:241], v12 offset:33952
    s_add_u32 s61, s61, 512
    s_cmp_eq_u32 s63, 1
    s_cselect_b32 s66, s61, s66
    v_mfma_f32_16x16x32_bf16 v[132:135], a[232:235], a[36:39], v[132:135]
    ds_read_b64_tr_b16 a[242:243], v12 offset:37536
    v_pk_mul_f32 v[32:33], v[32:33], v[192:193]
    v_pk_mul_f32 v[34:35], v[34:35], v[194:195]
    v_cvt_pk_bf16_f32 v32, v32, v33
    v_cvt_pk_bf16_f32 v33, v34, v35
    v_mfma_f32_16x16x32_bf16 v[136:139], a[232:235], a[40:43], v[136:139]
    ds_read_b64_tr_b16 a[216:217], v12 offset:33984
    v_pk_mul_f32 v[64:65], v[64:65], v[224:225]
    v_pk_mul_f32 v[66:67], v[66:67], v[226:227]
    v_cvt_pk_bf16_f32 v34, v64, v65
    v_mfma_f32_16x16x32_bf16 v[140:143], a[232:235], a[44:47], v[140:143]
    ds_read_b64_tr_b16 a[218:219], v12 offset:37568
    v_cvt_pk_bf16_f32 v35, v66, v67
    buffer_store_dwordx4 v[32:35], v2, s[32:35], s64 offen offset:0 sc1
    v_pk_mul_f32 v[36:37], v[36:37], v[196:197]
    v_mfma_f32_16x16x32_bf16 v[144:147], a[232:235], a[48:51], v[144:147]
    v_pk_mul_f32 v[38:39], v[38:39], v[198:199]
    v_cvt_pk_bf16_f32 v36, v36, v37
    v_cvt_pk_bf16_f32 v37, v38, v39
    v_mfma_f32_16x16x32_bf16 v[148:151], a[232:235], a[52:55], v[148:151]
    v_pk_mul_f32 v[68:69], v[68:69], v[228:229]
    v_pk_mul_f32 v[70:71], v[70:71], v[230:231]
    v_cvt_pk_bf16_f32 v38, v68, v69
    v_mfma_f32_16x16x32_bf16 v[152:155], a[232:235], a[56:59], v[152:155]
    v_cvt_pk_bf16_f32 v39, v70, v71
    buffer_store_dwordx4 v[36:39], v2, s[32:35], s64 offen offset:1024 sc1
    v_pk_mul_f32 v[40:41], v[40:41], v[200:201]
    v_mfma_f32_16x16x32_bf16 v[156:159], a[232:235], a[60:63], v[156:159]
    v_pk_mul_f32 v[42:43], v[42:43], v[202:203]
    v_cvt_pk_bf16_f32 v40, v40, v41
    v_cvt_pk_bf16_f32 v41, v42, v43
    s_waitcnt lgkmcnt(2)
    v_mfma_f32_16x16x32_bf16 a[128:131], a[240:243], a[32:35], a[128:131]
    v_pk_mul_f32 v[72:73], v[72:73], v[232:233]
    v_pk_mul_f32 v[74:75], v[74:75], v[234:235]
    v_cvt_pk_bf16_f32 v42, v72, v73
    v_mfma_f32_16x16x32_bf16 a[132:135], a[240:243], a[36:39], a[132:135]
    v_cvt_pk_bf16_f32 v43, v74, v75
    buffer_store_dwordx4 v[40:43], v2, s[32:35], s64 offen offset:2048 sc1
    v_pk_mul_f32 v[44:45], v[44:45], v[204:205]
    v_pk_mul_f32 v[46:47], v[46:47], v[206:207]
    v_mfma_f32_16x16x32_bf16 a[136:139], a[240:243], a[40:43], a[136:139]
    v_cvt_pk_bf16_f32 v44, v44, v45
    v_cvt_pk_bf16_f32 v45, v46, v47
    v_pk_mul_f32 v[76:77], v[76:77], v[236:237]
    v_mfma_f32_16x16x32_bf16 a[140:143], a[240:243], a[44:47], a[140:143]
    v_pk_mul_f32 v[78:79], v[78:79], v[238:239]
    v_cvt_pk_bf16_f32 v46, v76, v77
    v_cvt_pk_bf16_f32 v47, v78, v79
    v_mfma_f32_16x16x32_bf16 a[144:147], a[240:243], a[48:51], a[144:147]
    buffer_store_dwordx4 v[44:47], v2, s[32:35], s64 offen offset:3072 sc1
    v_pk_mul_f32 v[48:49], v[48:49], v[208:209]
    v_pk_mul_f32 v[50:51], v[50:51], v[210:211]
    v_mfma_f32_16x16x32_bf16 a[148:151], a[240:243], a[52:55], a[148:151]
    v_cvt_pk_bf16_f32 v48, v48, v49
    v_cvt_pk_bf16_f32 v49, v50, v51
    v_pk_mul_f32 v[80:81], v[80:81], v[240:241]
    v_mfma_f32_16x16x32_bf16 a[152:155], a[240:243], a[56:59], a[152:155]
    v_pk_mul_f32 v[82:83], v[82:83], v[242:243]
    v_cvt_pk_bf16_f32 v50, v80, v81
    v_cvt_pk_bf16_f32 v51, v82, v83
    v_mfma_f32_16x16x32_bf16 a[156:159], a[240:243], a[60:63], a[156:159]
    buffer_store_dwordx4 v[48:51], v3, s[32:35], s64 offen offset:0 sc1
    v_pk_mul_f32 v[52:53], v[52:53], v[212:213]
    v_pk_mul_f32 v[54:55], v[54:55], v[214:215]
    s_waitcnt lgkmcnt(0)
    v_mfma_f32_16x16x32_bf16 a[160:163], a[216:219], a[32:35], a[160:163]
    v_cvt_pk_bf16_f32 v52, v52, v53
    v_cvt_pk_bf16_f32 v53, v54, v55
    v_pk_mul_f32 v[84:85], v[84:85], v[244:245]
    v_pk_mul_f32 v[86:87], v[86:87], v[246:247]
    v_mfma_f32_16x16x32_bf16 a[164:167], a[216:219], a[36:39], a[164:167]
    v_cvt_pk_bf16_f32 v54, v84, v85
    v_cvt_pk_bf16_f32 v55, v86, v87
    buffer_store_dwordx4 v[52:55], v3, s[32:35], s64 offen offset:1024 sc1
    v_mfma_f32_16x16x32_bf16 a[168:171], a[216:219], a[40:43], a[168:171]
    v_pk_mul_f32 v[56:57], v[56:57], v[216:217]
    v_pk_mul_f32 v[58:59], v[58:59], v[218:219]
    v_cvt_pk_bf16_f32 v56, v56, v57
    v_mfma_f32_16x16x32_bf16 a[172:175], a[216:219], a[44:47], a[172:175]
    v_cvt_pk_bf16_f32 v57, v58, v59
    v_pk_mul_f32 v[88:89], v[88:89], v[248:249]
    v_pk_mul_f32 v[90:91], v[90:91], v[250:251]
    v_mfma_f32_16x16x32_bf16 a[176:179], a[216:219], a[48:51], a[176:179]
    v_cvt_pk_bf16_f32 v58, v88, v89
    v_cvt_pk_bf16_f32 v59, v90, v91
    buffer_store_dwordx4 v[56:59], v3, s[32:35], s64 offen offset:2048 sc1
    v_mfma_f32_16x16x32_bf16 a[180:183], a[216:219], a[52:55], a[180:183]
    v_pk_mul_f32 v[60:61], v[60:61], v[220:221]
    v_pk_mul_f32 v[62:63], v[62:63], v[222:223]
    v_cvt_pk_bf16_f32 v60, v60, v61
    v_mfma_f32_16x16x32_bf16 a[184:187], a[216:219], a[56:59], a[184:187]
    v_cvt_pk_bf16_f32 v61, v62, v63
    v_pk_mul_f32 v[92:93], v[92:93], v[252:253]
    v_pk_mul_f32 v[94:95], v[94:95], v[254:255]
    v_mfma_f32_16x16x32_bf16 a[188:191], a[216:219], a[60:63], a[188:191]
    v_cvt_pk_bf16_f32 v62, v92, v93
    v_cvt_pk_bf16_f32 v63, v94, v95
    buffer_store_dwordx4 v[60:63], v3, s[32:35], s64 offen offset:3072 sc1
    s_waitcnt lgkmcnt(0)
    s_barrier
    ds_read_b128 v[192:195], v4 offset:0
    ds_read_b128 v[196:199], v4 offset:2048
    ds_read_b128 v[232:235], v4 offset:10240
    ds_read_b128 v[200:203], v4 offset:4096
    ds_read_b128 v[236:239], v4 offset:11264
    ds_read_b128 v[204:207], v4 offset:6144
    ds_read_b128 v[240:243], v4 offset:12288
    ds_read_b128 v[208:211], v4 offset:8192
    ds_read_b128 v[244:247], v4 offset:13312
    ds_read_b64 v[212:213], v5 offset:1024
    ds_read_b64 v[222:223], v5 offset:1536
    ds_read_b64 v[214:215], v5 offset:3072
    ds_read_b64 v[224:225], v5 offset:3584
    ds_read_b64 v[216:217], v5 offset:5120
    ds_read_b64 v[226:227], v5 offset:5632
    ds_read_b64 v[218:219], v5 offset:7168
    ds_read_b64 v[228:229], v5 offset:7680
    ds_read_b64 v[220:221], v5 offset:9216
    ds_read_b64 v[230:231], v5 offset:9728
    v_accvgpr_read_b32 v20, a96
    v_accvgpr_read_b32 v21, a97
    v_accvgpr_read_b32 v22, a98
    v_accvgpr_read_b32 v23, a99
    v_pk_mul_f32 v[96:97], v[96:97], v[20:21]
    v_pk_mul_f32 v[98:99], v[98:99], v[22:23]
    v_cvt_pk_bf16_f32 v96, v96, v97
    v_cvt_pk_bf16_f32 v97, v98, v99
    v_accvgpr_read_b32 v24, a128
    v_accvgpr_read_b32 v25, a129
    v_accvgpr_read_b32 v26, a130
    v_accvgpr_read_b32 v27, a131
    v_pk_mul_f32 v[128:129], v[128:129], v[24:25]
    v_pk_mul_f32 v[130:131], v[130:131], v[26:27]
    v_cvt_pk_bf16_f32 v98, v128, v129
    v_cvt_pk_bf16_f32 v99, v130, v131
    buffer_store_dwordx4 v[96:99], v2, s[32:35], s65 offen offset:0 sc1
    v_accvgpr_read_b32 v20, a100
    v_accvgpr_read_b32 v21, a101
    v_accvgpr_read_b32 v22, a102
    v_accvgpr_read_b32 v23, a103
    v_pk_mul_f32 v[100:101], v[100:101], v[20:21]
    v_pk_mul_f32 v[102:103], v[102:103], v[22:23]
    v_cvt_pk_bf16_f32 v100, v100, v101
    v_cvt_pk_bf16_f32 v101, v102, v103
    v_accvgpr_read_b32 v24, a132
    v_accvgpr_read_b32 v25, a133
    v_accvgpr_read_b32 v26, a134
    v_accvgpr_read_b32 v27, a135
    v_pk_mul_f32 v[132:133], v[132:133], v[24:25]
    v_pk_mul_f32 v[134:135], v[134:135], v[26:27]
    v_cvt_pk_bf16_f32 v102, v132, v133
    v_cvt_pk_bf16_f32 v103, v134, v135
    buffer_store_dwordx4 v[100:103], v2, s[32:35], s65 offen offset:1024 sc1
    v_accvgpr_read_b32 v20, a104
    v_accvgpr_read_b32 v21, a105
    v_accvgpr_read_b32 v22, a106
    v_accvgpr_read_b32 v23, a107
    v_pk_mul_f32 v[104:105], v[104:105], v[20:21]
    v_pk_mul_f32 v[106:107], v[106:107], v[22:23]
    v_cvt_pk_bf16_f32 v104, v104, v105
    v_cvt_pk_bf16_f32 v105, v106, v107
    v_accvgpr_read_b32 v24, a136
    v_accvgpr_read_b32 v25, a137
    v_accvgpr_read_b32 v26, a138
    v_accvgpr_read_b32 v27, a139
    v_pk_mul_f32 v[136:137], v[136:137], v[24:25]
    v_pk_mul_f32 v[138:139], v[138:139], v[26:27]
    v_cvt_pk_bf16_f32 v106, v136, v137
    v_cvt_pk_bf16_f32 v107, v138, v139
    buffer_store_dwordx4 v[104:107], v2, s[32:35], s65 offen offset:2048 sc1
    v_accvgpr_read_b32 v20, a108
    v_accvgpr_read_b32 v21, a109
    v_accvgpr_read_b32 v22, a110
    v_accvgpr_read_b32 v23, a111
    v_pk_mul_f32 v[108:109], v[108:109], v[20:21]
    v_pk_mul_f32 v[110:111], v[110:111], v[22:23]
    v_cvt_pk_bf16_f32 v108, v108, v109
    v_cvt_pk_bf16_f32 v109, v110, v111
    v_accvgpr_read_b32 v24, a140
    v_accvgpr_read_b32 v25, a141
    v_accvgpr_read_b32 v26, a142
    v_accvgpr_read_b32 v27, a143
    v_pk_mul_f32 v[140:141], v[140:141], v[24:25]
    v_pk_mul_f32 v[142:143], v[142:143], v[26:27]
    v_cvt_pk_bf16_f32 v110, v140, v141
    v_cvt_pk_bf16_f32 v111, v142, v143
    buffer_store_dwordx4 v[108:111], v2, s[32:35], s65 offen offset:3072 sc1
    v_accvgpr_read_b32 v20, a112
    v_accvgpr_read_b32 v21, a113
    v_accvgpr_read_b32 v22, a114
    v_accvgpr_read_b32 v23, a115
    v_pk_mul_f32 v[112:113], v[112:113], v[20:21]
    v_pk_mul_f32 v[114:115], v[114:115], v[22:23]
    v_cvt_pk_bf16_f32 v112, v112, v113
    v_cvt_pk_bf16_f32 v113, v114, v115
    v_accvgpr_read_b32 v24, a144
    v_accvgpr_read_b32 v25, a145
    v_accvgpr_read_b32 v26, a146
    v_accvgpr_read_b32 v27, a147
    v_pk_mul_f32 v[144:145], v[144:145], v[24:25]
    v_pk_mul_f32 v[146:147], v[146:147], v[26:27]
    v_cvt_pk_bf16_f32 v114, v144, v145
    v_cvt_pk_bf16_f32 v115, v146, v147
    buffer_store_dwordx4 v[112:115], v3, s[32:35], s65 offen offset:0 sc1
    v_accvgpr_read_b32 v20, a116
    v_accvgpr_read_b32 v21, a117
    v_accvgpr_read_b32 v22, a118
    v_accvgpr_read_b32 v23, a119
    v_pk_mul_f32 v[116:117], v[116:117], v[20:21]
    v_pk_mul_f32 v[118:119], v[118:119], v[22:23]
    v_cvt_pk_bf16_f32 v116, v116, v117
    v_cvt_pk_bf16_f32 v117, v118, v119
    v_accvgpr_read_b32 v24, a148
    v_accvgpr_read_b32 v25, a149
    v_accvgpr_read_b32 v26, a150
    v_accvgpr_read_b32 v27, a151
    v_pk_mul_f32 v[148:149], v[148:149], v[24:25]
    v_pk_mul_f32 v[150:151], v[150:151], v[26:27]
    v_cvt_pk_bf16_f32 v118, v148, v149
    v_cvt_pk_bf16_f32 v119, v150, v151
    buffer_store_dwordx4 v[116:119], v3, s[32:35], s65 offen offset:1024 sc1
    v_accvgpr_read_b32 v20, a120
    v_accvgpr_read_b32 v21, a121
    v_accvgpr_read_b32 v22, a122
    v_accvgpr_read_b32 v23, a123
    v_pk_mul_f32 v[120:121], v[120:121], v[20:21]
    v_pk_mul_f32 v[122:123], v[122:123], v[22:23]
    v_cvt_pk_bf16_f32 v120, v120, v121
    v_cvt_pk_bf16_f32 v121, v122, v123
    v_accvgpr_read_b32 v24, a152
    v_accvgpr_read_b32 v25, a153
    v_accvgpr_read_b32 v26, a154
    v_accvgpr_read_b32 v27, a155
    v_pk_mul_f32 v[152:153], v[152:153], v[24:25]
    v_pk_mul_f32 v[154:155], v[154:155], v[26:27]
    v_cvt_pk_bf16_f32 v122, v152, v153
    v_cvt_pk_bf16_f32 v123, v154, v155
    buffer_store_dwordx4 v[120:123], v3, s[32:35], s65 offen offset:2048 sc1
    v_accvgpr_read_b32 v20, a124
    v_accvgpr_read_b32 v21, a125
    v_accvgpr_read_b32 v22, a126
    v_accvgpr_read_b32 v23, a127
    v_pk_mul_f32 v[124:125], v[124:125], v[20:21]
    v_pk_mul_f32 v[126:127], v[126:127], v[22:23]
    v_cvt_pk_bf16_f32 v124, v124, v125
    v_cvt_pk_bf16_f32 v125, v126, v127
    v_accvgpr_read_b32 v24, a156
    v_accvgpr_read_b32 v25, a157
    v_accvgpr_read_b32 v26, a158
    v_accvgpr_read_b32 v27, a159
    v_pk_mul_f32 v[156:157], v[156:157], v[24:25]
    v_pk_mul_f32 v[158:159], v[158:159], v[26:27]
    v_cvt_pk_bf16_f32 v126, v156, v157
    v_cvt_pk_bf16_f32 v127, v158, v159
    buffer_store_dwordx4 v[124:127], v3, s[32:35], s65 offen offset:3072 sc1
    v_accvgpr_read_b32 v248, a200
    v_accvgpr_read_b32 v249, a201
    v_accvgpr_read_b32 v250, a202
    v_accvgpr_read_b32 v251, a203
    v_accvgpr_read_b32 v252, a204
    v_accvgpr_read_b32 v253, a205
    v_accvgpr_read_b32 v254, a206
    v_accvgpr_read_b32 v255, a207
    s_waitcnt lgkmcnt(0)
    v_mfma_f32_16x16x32_bf16 v[64:67], v[192:195], v[232:235], 0
    v_mfma_f32_16x16x32_bf16 v[128:131], v[196:199], v[236:239], 0
    v_mfma_f32_16x16x32_bf16 v[68:71], v[196:199], v[232:235], 0
    v_mfma_f32_16x16x32_bf16 v[132:135], v[200:203], v[236:239], 0
    s_nop 4
    v_pk_fma_f32 v[64:65], v[64:65], s[94:95], v[252:253]
    v_pk_fma_f32 v[128:129], v[128:129], s[94:95], v[252:253]
    v_pk_fma_f32 v[66:67], v[66:67], s[94:95], v[254:255]
    v_pk_fma_f32 v[130:131], v[130:131], s[94:95], v[254:255]
    v_pk_fma_f32 v[68:69], v[68:69], s[94:95], v[248:249]
    v_pk_fma_f32 v[132:133], v[132:133], s[94:95], v[248:249]
    v_pk_fma_f32 v[70:71], v[70:71], s[94:95], v[250:251]
    v_pk_fma_f32 v[134:135], v[134:135], s[94:95], v[250:251]
    v_max3_f32 v72, v64, v65, v66
    v_max3_f32 v136, v128, v129, v130
    v_max3_f32 v73, v67, v68, v69
    v_max3_f32 v137, v131, v132, v133
    v_max3_f32 v72, v72, v70, v71
    v_max3_f32 v136, v136, v134, v135
    v_max_f32 v72, v72, v73
    v_max_f32 v136, v136, v137
    v_mov_b32 v73, v72
    v_mov_b32 v137, v136
    s_nop 0
    v_permlane32_swap_b32 v72, v73
    v_permlane32_swap_b32 v136, v137
    v_max_f32 v72, v72, v73
    v_max_f32 v136, v136, v137
    v_mov_b32 v73, v72
    v_mov_b32 v137, v136
    s_nop 0
    v_permlane16_swap_b32 v72, v73
    v_permlane16_swap_b32 v136, v137
    v_max_f32 v72, v72, v73
    v_max_f32 v136, v136, v137
    v_mov_b32 v73, v72
    v_mov_b32 v137, v136
    v_pk_add_f32 v[64:65], v[64:65], v[72:73] neg_lo:[0,1] neg_hi:[0,1]
    v_pk_add_f32 v[128:129], v[128:129], v[136:137] neg_lo:[0,1] neg_hi:[0,1]
    v_pk_add_f32 v[66:67], v[66:67], v[72:73] neg_lo:[0,1] neg_hi:[0,1]
    v_pk_add_f32 v[130:131], v[130:131], v[136:137] neg_lo:[0,1] neg_hi:[0,1]
    v_pk_add_f32 v[68:69], v[68:69], v[72:73] neg_lo:[0,1] neg_hi:[0,1]
    v_pk_add_f32 v[132:133], v[132:133], v[136:137] neg_lo:[0,1] neg_hi:[0,1]
    v_pk_add_f32 v[70:71], v[70:71], v[72:73] neg_lo:[0,1] neg_hi:[0,1]
    v_pk_add_f32 v[134:135], v[134:135], v[136:137] neg_lo:[0,1] neg_hi:[0,1]
    v_exp_f32 v64, v64
    v_exp_f32 v128, v128
    v_exp_f32 v65, v65
    v_exp_f32 v129, v129
    v_exp_f32 v66, v66
    v_exp_f32 v130, v130
    v_exp_f32 v67, v67
    v_exp_f32 v131, v131
    v_exp_f32 v68, v68
    v_exp_f32 v132, v132
    v_exp_f32 v69, v69
    v_exp_f32 v133, v133
    v_exp_f32 v70, v70
    v_exp_f32 v134, v134
    v_exp_f32 v71, v71
    v_exp_f32 v135, v135
    v_cvt_pk_bf16_f32 v76, v64, v65
    v_cvt_pk_bf16_f32 v140, v128, v129
    v_cvt_pk_bf16_f32 v77, v66, v67
    v_cvt_pk_bf16_f32 v141, v130, v131
    v_cvt_pk_bf16_f32 v78, v68, v69
    v_cvt_pk_bf16_f32 v142, v132, v133
    v_cvt_pk_bf16_f32 v79, v70, v71
    v_cvt_pk_bf16_f32 v143, v134, v135
    s_nop 0
    v_mfma_f32_16x16x32_bf16 v[88:91], a[212:215], v[76:79], 0
    v_mfma_f32_16x16x32_bf16 v[152:155], a[212:215], v[140:143], 0
    v_mfma_f32_16x16x32_bf16 v[80:83], v[212:215], v[76:79], 0
    v_mfma_f32_16x16x32_bf16 v[144:147], v[214:217], v[140:143], 0
    v_mfma_f32_16x16x32_bf16 v[84:87], v[222:225], v[76:79], 0
    v_mfma_f32_16x16x32_bf16 v[148:151], v[224:227], v[140:143], 0
    s_nop 2
    v_rcp_f32 v88, v88
    v_rcp_f32 v152, v152
    v_mov_b32 v89, v88
    v_mov_b32 v153, v152
    v_pk_mul_f32 v[80:81], v[80:81], v[88:89]
    v_pk_mul_f32 v[144:145], v[144:145], v[152:153]
    v_pk_mul_f32 v[82:83], v[82:83], v[88:89]
    v_pk_mul_f32 v[146:147], v[146:147], v[152:153]
    v_pk_mul_f32 v[84:85], v[84:85], v[88:89]
    v_pk_mul_f32 v[148:149], v[148:149], v[152:153]
    v_pk_mul_f32 v[86:87], v[86:87], v[88:89]
    v_pk_mul_f32 v[150:151], v[150:151], v[152:153]
    v_cvt_pk_bf16_f32 v48, v80, v81
    v_cvt_pk_bf16_f32 v52, v144, v145
    v_cvt_pk_bf16_f32 v49, v82, v83
    v_cvt_pk_bf16_f32 v53, v146, v147
    v_cvt_pk_bf16_f32 v50, v84, v85
    v_cvt_pk_bf16_f32 v54, v148, v149
    v_cvt_pk_bf16_f32 v51, v86, v87
    v_cvt_pk_bf16_f32 v55, v150, v151
    s_add_u32 s60, s100, 2500
    v_mov_b32 v38, s60
    v_xor_b32 v39, s101, v38
    s_lshl_b32 s60, s2, 2
    s_add_u32 s60, s60, s51
    s_lshl_b32 s60, s60, 7
    s_add_u32 s60, s60, 524288
    v_mov_b32 v40, s60
    s_waitcnt vmcnt(0)
    s_mov_b64 exec, 1
    buffer_store_dwordx2 v[38:39], v40, s[96:99], 0 offen sc1
    s_mov_b64 exec, -1
    s_and_b32 s3, s2, 7
    s_lshr_b32 s41, s3, 2
    s_and_b32 s3, s3, 3
    s_lshl_b32 s3, s3, 2
    s_lshr_b32 s60, s2, 3
    s_and_b32 s43, s60, 7
    s_lshr_b32 s60, s60, 3
    s_add_u32 s42, s3, s60
    s_and_b32 s3, s51, 1
    s_mul_i32 s60, s41, 22
    v_add_u32 v44, s60, v1
    v_add_u32 v45, 10, v1
    v_cmp_gt_u32 vcc, 22, v1
    s_nop 1
    v_cndmask_b32 v44, v45, v44, vcc
    v_mul_u32_u24 v45, 21846, v44
    v_lshrrev_b32 v45, 16, v45
    v_lshl_add_u32 v44, v45, 2, v44
    s_lshl_b32 s60, s52, 2
    s_add_u32 s60, s60, 32
    v_add_u32 v44, s60, v44
    s_mul_i32 s60, s41, 24
    s_add_u32 s60, s60, s52
    s_sub_u32 s60, s60, 44
    v_lshl_add_u32 v45, v1, 1, s60
    s_mul_i32 s60, s52, 7
    s_sub_u32 s60, s60, 329
    v_mul_u32_u24 v46, 14, v1
    v_add_u32 v46, s60, v46
    s_cmp_eq_u32 s41, 0
    s_cselect_b32 s60, 63, 26
    v_cmp_gt_u32 vcc, s60, v1
    s_nop 1
    v_cndmask_b32 v45, v46, v45, vcc
    v_subrev_u32 v46, 22, v1
    v_cmp_gt_u32 vcc, 12, v46
    s_nop 1
    v_cndmask_b32 v42, v44, v45, vcc
    s_lshl_b32 s60, s3, 12
    s_lshl_b32 s61, s42, 13
    s_add_u32 s60, s60, s61
    v_lshl_add_u32 v32, v1, 4, s60
    s_lshl_b32 s38, s51, 12
    s_add_u32 s39, s38, 81920
    v_lshrrev_b32 v44, 4, v1
    v_and_b32 v45, 15, v1
    s_lshl_b32 s60, s3, 15
    s_lshl_b32 s61, s43, 8
    s_add_u32 s60, s60, s61
    v_lshl_add_u32 v47, v44, 11, s60
    v_lshlrev_b32 v46, 1, v44
    v_xor_b32 v46, v46, v45
    v_lshl_add_u32 v33, v46, 4, v47
    v_xor_b32 v34, 128, v33
    v_add_u32 v34, 8192, v34
    v_add_u32 v35, 16384, v33
    v_add_u32 v36, 16384, v34
    s_mov_b32 s54, 2097152
    s_mov_b32 s55, 7340032
    s_mov_b32 s15, 0x20000
    s_add_u32 s8, s6, 4194304
    s_addc_u32 s9, s7, 0
    s_mov_b32 s10, 18874368
    s_mov_b32 s11, 0x20000
    s_lshr_b32 s60, s42, 1
    s_lshl_b32 s60, s60, 14
    s_and_b32 s61, s42, 1
    s_lshl_b32 s61, s61, 8
    s_add_u32 s60, s60, s61
    s_add_u32 s60, s60, 524288
    v_lshrrev_b32 v44, 1, v1
    v_lshl_add_u32 v41, v44, 9, s60
    v_and_b32 v44, 1, v1
    v_lshl_add_u32 v41, v44, 7, v41
    s_mov_b32 s53, -1
    s_add_u32 s53, s53, 1
    v_readlane_b32 s37, v42, s53
    s_nop 1
    s_lshl_b32 s36, s37, 17
    s_cmp_lt_u32 s37, 32
    s_cselect_b32 s12, s92, s68
    s_cselect_b32 s13, s93, s69
    s_cselect_b32 s14, s54, s55
    s_cselect_b32 s60, 0, 32
    s_sub_u32 s37, s37, s60
    s_lshl_b32 s37, s37, 16
    s_add_u32 m0, s39, 0
    s_nop 0
    buffer_load_dwordx4 v33, s[12:15], s37 offen sc1 lds
    s_add_u32 m0, s39, 1024
    s_nop 0
    buffer_load_dwordx4 v34, s[12:15], s37 offen sc1 lds
    s_add_u32 m0, s39, 2048
    s_nop 0
    buffer_load_dwordx4 v35, s[12:15], s37 offen sc1 lds
    s_add_u32 m0, s39, 3072
    s_nop 0
    buffer_load_dwordx4 v36, s[12:15], s37 offen sc1 lds
    s_add_u32 s53, s53, 1
    v_readlane_b32 s37, v42, s53
    s_nop 1
    s_lshl_b32 s36, s37, 17
    s_cmp_lt_u32 s37, 32
    s_cselect_b32 s12, s92, s68
    s_cselect_b32 s13, s93, s69
    s_cselect_b32 s14, s54, s55
    s_cselect_b32 s60, 0, 32
    s_sub_u32 s37, s37, s60
    s_lshl_b32 s37, s37, 16
    s_add_u32 m0, s39, 16384
    s_nop 0
    buffer_load_dwordx4 v33, s[12:15], s37 offen sc1 lds
    s_add_u32 m0, s39, 17408
    s_nop 0
    buffer_load_dwordx4 v34, s[12:15], s37 offen sc1 lds
    s_add_u32 m0, s39, 18432
    s_nop 0
    buffer_load_dwordx4 v35, s[12:15], s37 offen sc1 lds
    s_add_u32 m0, s39, 19456
    s_nop 0
    buffer_load_dwordx4 v36, s[12:15], s37 offen sc1 lds
    s_add_u32 s53, s53, 1
    v_readlane_b32 s37, v42, s53
    s_nop 1
    s_lshl_b32 s36, s37, 17
    s_cmp_lt_u32 s37, 32
    s_cselect_b32 s12, s92, s68
    s_cselect_b32 s13, s93, s69
    s_cselect_b32 s14, s54, s55
    s_cselect_b32 s60, 0, 32
    s_sub_u32 s37, s37, s60
    s_lshl_b32 s37, s37, 16
    s_add_u32 m0, s39, 32768
    s_nop 0
    buffer_load_dwordx4 v33, s[12:15], s37 offen sc1 lds
    s_add_u32 m0, s39, 33792
    s_nop 0
    buffer_load_dwordx4 v34, s[12:15], s37 offen sc1 lds
    s_add_u32 m0, s39, 34816
    s_nop 0
    buffer_load_dwordx4 v35, s[12:15], s37 offen sc1 lds
    s_add_u32 m0, s39, 35840
    s_nop 0
    buffer_load_dwordx4 v36, s[12:15], s37 offen sc1 lds
    s_add_u32 s53, s53, 1
    v_readlane_b32 s37, v42, s53
    s_nop 1
    s_lshl_b32 s36, s37, 17
    s_cmp_lt_u32 s37, 32
    s_cselect_b32 s12, s92, s68
    s_cselect_b32 s13, s93, s69
    s_cselect_b32 s14, s54, s55
    s_cselect_b32 s60, 0, 32
    s_sub_u32 s37, s37, s60
    s_lshl_b32 s37, s37, 16
    s_add_u32 m0, s39, 49152
    s_nop 0
    buffer_load_dwordx4 v33, s[12:15], s37 offen sc1 lds
    s_add_u32 m0, s39, 50176
    s_nop 0
    buffer_load_dwordx4 v34, s[12:15], s37 offen sc1 lds
    s_add_u32 m0, s39, 51200
    s_nop 0
    buffer_load_dwordx4 v35, s[12:15], s37 offen sc1 lds
    s_add_u32 m0, s39, 52224
    s_nop 0
    buffer_load_dwordx4 v36, s[12:15], s37 offen sc1 lds
    s_add_u32 s53, s53, 1
    v_readlane_b32 s37, v42, s53
    s_nop 1
    s_lshl_b32 s36, s37, 17
    s_cmp_lt_u32 s37, 32
    s_cselect_b32 s12, s92, s68
    s_cselect_b32 s13, s93, s69
    s_cselect_b32 s14, s54, s55
    s_cselect_b32 s60, 0, 32
    s_sub_u32 s37, s37, s60
    s_lshl_b32 s37, s37, 16
    s_add_u32 m0, s39, 65536
    s_nop 0
    buffer_load_dwordx4 v33, s[12:15], s37 offen sc1 lds
    s_add_u32 m0, s39, 66560
    s_nop 0
    buffer_load_dwordx4 v34, s[12:15], s37 offen sc1 lds
    s_add_u32 m0, s39, 67584
    s_nop 0
    buffer_load_dwordx4 v35, s[12:15], s37 offen sc1 lds
    s_add_u32 m0, s39, 68608
    s_nop 0
    buffer_load_dwordx4 v36, s[12:15], s37 offen sc1 lds
    s_add_u32 s53, s53, 1
    v_readlane_b32 s37, v42, s53
    s_nop 1
    s_lshl_b32 s36, s37, 17
    s_cmp_lt_u32 s37, 32
    s_cselect_b32 s12, s92, s68
    s_cselect_b32 s13, s93, s69
    s_cselect_b32 s14, s54, s55
    s_cselect_b32 s60, 0, 32
    s_sub_u32 s37, s37, s60
    s_lshl_b32 s37, s37, 16
    v_mfma_f32_16x16x32_bf16 v[64:67], v[200:203], v[240:243], 0
    v_mfma_f32_16x16x32_bf16 v[128:131], v[204:207], v[244:247], 0
    v_mfma_f32_16x16x32_bf16 v[68:71], v[204:207], v[240:243], 0
    v_mfma_f32_16x16x32_bf16 v[132:135], v[208:211], v[244:247], 0
    s_nop 4
    v_pk_fma_f32 v[64:65], v[64:65], s[94:95], v[252:253]
    v_pk_fma_f32 v[128:129], v[128:129], s[94:95], v[252:253]
    v_pk_fma_f32 v[66:67], v[66:67], s[94:95], v[254:255]
    v_pk_fma_f32 v[130:131], v[130:131], s[94:95], v[254:255]
    v_pk_fma_f32 v[68:69], v[68:69], s[94:95], v[248:249]
    v_pk_fma_f32 v[132:133], v[132:133], s[94:95], v[248:249]
    v_pk_fma_f32 v[70:71], v[70:71], s[94:95], v[250:251]
    v_pk_fma_f32 v[134:135], v[134:135], s[94:95], v[250:251]
    v_max3_f32 v72, v64, v65, v66
    v_max3_f32 v136, v128, v129, v130
    v_max3_f32 v73, v67, v68, v69
    v_max3_f32 v137, v131, v132, v133
    v_max3_f32 v72, v72, v70, v71
    v_max3_f32 v136, v136, v134, v135
    v_max_f32 v72, v72, v73
    v_max_f32 v136, v136, v137
    v_mov_b32 v73, v72
    v_mov_b32 v137, v136
    s_nop 0
    v_permlane32_swap_b32 v72, v73
    v_permlane32_swap_b32 v136, v137
    v_max_f32 v72, v72, v73
    v_max_f32 v136, v136, v137
    v_mov_b32 v73, v72
    v_mov_b32 v137, v136
    s_nop 0
    v_permlane16_swap_b32 v72, v73
    v_permlane16_swap_b32 v136, v137
    v_max_f32 v72, v72, v73
    v_max_f32 v136, v136, v137
    v_mov_b32 v73, v72
    v_mov_b32 v137, v136
    v_pk_add_f32 v[64:65], v[64:65], v[72:73] neg_lo:[0,1] neg_hi:[0,1]
    v_pk_add_f32 v[128:129], v[128:129], v[136:137] neg_lo:[0,1] neg_hi:[0,1]
    v_pk_add_f32 v[66:67], v[66:67], v[72:73] neg_lo:[0,1] neg_hi:[0,1]
    v_pk_add_f32 v[130:131], v[130:131], v[136:137] neg_lo:[0,1] neg_hi:[0,1]
    v_pk_add_f32 v[68:69], v[68:69], v[72:73] neg_lo:[0,1] neg_hi:[0,1]
    v_pk_add_f32 v[132:133], v[132:133], v[136:137] neg_lo:[0,1] neg_hi:[0,1]
    v_pk_add_f32 v[70:71], v[70:71], v[72:73] neg_lo:[0,1] neg_hi:[0,1]
    v_pk_add_f32 v[134:135], v[134:135], v[136:137] neg_lo:[0,1] neg_hi:[0,1]
    v_exp_f32 v64, v64
    v_exp_f32 v128, v128
    v_exp_f32 v65, v65
    v_exp_f32 v129, v129
    v_exp_f32 v66, v66
    v_exp_f32 v130, v130
    v_exp_f32 v67, v67
    v_exp_f32 v131, v131
    v_exp_f32 v68, v68
    v_exp_f32 v132, v132
    v_exp_f32 v69, v69
    v_exp_f32 v133, v133
    v_exp_f32 v70, v70
    v_exp_f32 v134, v134
    v_exp_f32 v71, v71
    v_exp_f32 v135, v135
    v_cvt_pk_bf16_f32 v76, v64, v65
    v_cvt_pk_bf16_f32 v140, v128, v129
    v_cvt_pk_bf16_f32 v77, v66, v67
    v_cvt_pk_bf16_f32 v141, v130, v131
    v_cvt_pk_bf16_f32 v78, v68, v69
    v_cvt_pk_bf16_f32 v142, v132, v133
    v_cvt_pk_bf16_f32 v79, v70, v71
    v_cvt_pk_bf16_f32 v143, v134, v135
    s_nop 0
    v_mfma_f32_16x16x32_bf16 v[88:91], a[212:215], v[76:79], 0
    v_mfma_f32_16x16x32_bf16 v[152:155], a[212:215], v[140:143], 0
    v_mfma_f32_16x16x32_bf16 v[80:83], v[216:219], v[76:79], 0
    v_mfma_f32_16x16x32_bf16 v[144:147], v[218:221], v[140:143], 0
    v_mfma_f32_16x16x32_bf16 v[84:87], v[226:229], v[76:79], 0
    v_mfma_f32_16x16x32_bf16 v[148:151], v[228:231], v[140:143], 0
    s_nop 2
    v_rcp_f32 v88, v88
    v_rcp_f32 v152, v152
    v_mov_b32 v89, v88
    v_mov_b32 v153, v152
    v_pk_mul_f32 v[80:81], v[80:81], v[88:89]
    v_pk_mul_f32 v[144:145], v[144:145], v[152:153]
    v_pk_mul_f32 v[82:83], v[82:83], v[88:89]
    v_pk_mul_f32 v[146:147], v[146:147], v[152:153]
    v_pk_mul_f32 v[84:85], v[84:85], v[88:89]
    v_pk_mul_f32 v[148:149], v[148:149], v[152:153]
    v_pk_mul_f32 v[86:87], v[86:87], v[88:89]
    v_pk_mul_f32 v[150:151], v[150:151], v[152:153]
    v_cvt_pk_bf16_f32 v56, v80, v81
    v_cvt_pk_bf16_f32 v60, v144, v145
    v_cvt_pk_bf16_f32 v57, v82, v83
    v_cvt_pk_bf16_f32 v61, v146, v147
    v_cvt_pk_bf16_f32 v58, v84, v85
    v_cvt_pk_bf16_f32 v62, v148, v149
    v_cvt_pk_bf16_f32 v59, v86, v87
    v_cvt_pk_bf16_f32 v63, v150, v151
    v_accvgpr_read_b32 v20, a160
    v_accvgpr_read_b32 v21, a161
    v_accvgpr_read_b32 v22, a162
    v_accvgpr_read_b32 v23, a163
    v_pk_mul_f32 v[160:161], v[160:161], v[20:21]
    v_pk_mul_f32 v[162:163], v[162:163], v[22:23]
    v_cvt_pk_bf16_f32 v160, v160, v161
    v_cvt_pk_bf16_f32 v161, v162, v163
    v_accvgpr_read_b32 v24, a164
    v_accvgpr_read_b32 v25, a165
    v_accvgpr_read_b32 v26, a166
    v_accvgpr_read_b32 v27, a167
    v_pk_mul_f32 v[164:165], v[164:165], v[24:25]
    v_pk_mul_f32 v[166:167], v[166:167], v[26:27]
    v_cvt_pk_bf16_f32 v162, v164, v165
    v_cvt_pk_bf16_f32 v163, v166, v167
    s_nop 0
    v_permlane16_swap_b32 v160, v162
    v_permlane16_swap_b32 v161, v163
    v_accvgpr_write_b32 a0, v160
    v_accvgpr_write_b32 a1, v161
    v_accvgpr_write_b32 a2, v162
    v_accvgpr_write_b32 a3, v163
    v_accvgpr_read_b32 v20, a168
    v_accvgpr_read_b32 v21, a169
    v_accvgpr_read_b32 v22, a170
    v_accvgpr_read_b32 v23, a171
    v_pk_mul_f32 v[168:169], v[168:169], v[20:21]
    v_pk_mul_f32 v[170:171], v[170:171], v[22:23]
    v_cvt_pk_bf16_f32 v168, v168, v169
    v_cvt_pk_bf16_f32 v169, v170, v171
    v_accvgpr_read_b32 v24, a172
    v_accvgpr_read_b32 v25, a173
    v_accvgpr_read_b32 v26, a174
    v_accvgpr_read_b32 v27, a175
    v_pk_mul_f32 v[172:173], v[172:173], v[24:25]
    v_pk_mul_f32 v[174:175], v[174:175], v[26:27]
    v_cvt_pk_bf16_f32 v170, v172, v173
    v_cvt_pk_bf16_f32 v171, v174, v175
    s_nop 0
    v_permlane16_swap_b32 v168, v170
    v_permlane16_swap_b32 v169, v171
    v_accvgpr_write_b32 a4, v168
    v_accvgpr_write_b32 a5, v169
    v_accvgpr_write_b32 a6, v170
    v_accvgpr_write_b32 a7, v171
    v_accvgpr_read_b32 v20, a176
    v_accvgpr_read_b32 v21, a177
    v_accvgpr_read_b32 v22, a178
    v_accvgpr_read_b32 v23, a179
    v_pk_mul_f32 v[176:177], v[176:177], v[20:21]
    v_pk_mul_f32 v[178:179], v[178:179], v[22:23]
    v_cvt_pk_bf16_f32 v176, v176, v177
    v_cvt_pk_bf16_f32 v177, v178, v179
    v_accvgpr_read_b32 v24, a180
    v_accvgpr_read_b32 v25, a181
    v_accvgpr_read_b32 v26, a182
    v_accvgpr_read_b32 v27, a183
    v_pk_mul_f32 v[180:181], v[180:181], v[24:25]
    v_pk_mul_f32 v[182:183], v[182:183], v[26:27]
    v_cvt_pk_bf16_f32 v178, v180, v181
    v_cvt_pk_bf16_f32 v179, v182, v183
    s_nop 0
    v_permlane16_swap_b32 v176, v178
    v_permlane16_swap_b32 v177, v179
    v_accvgpr_write_b32 a8, v176
    v_accvgpr_write_b32 a9, v177
    v_accvgpr_write_b32 a10, v178
    v_accvgpr_write_b32 a11, v179
    v_accvgpr_read_b32 v20, a184
    v_accvgpr_read_b32 v21, a185
    v_accvgpr_read_b32 v22, a186
    v_accvgpr_read_b32 v23, a187
    v_pk_mul_f32 v[184:185], v[184:185], v[20:21]
    v_pk_mul_f32 v[186:187], v[186:187], v[22:23]
    v_cvt_pk_bf16_f32 v184, v184, v185
    v_cvt_pk_bf16_f32 v185, v186, v187
    v_accvgpr_read_b32 v24, a188
    v_accvgpr_read_b32 v25, a189
    v_accvgpr_read_b32 v26, a190
    v_accvgpr_read_b32 v27, a191
    v_pk_mul_f32 v[188:189], v[188:189], v[24:25]
    v_pk_mul_f32 v[190:191], v[190:191], v[26:27]
    v_cvt_pk_bf16_f32 v186, v188, v189
    v_cvt_pk_bf16_f32 v187, v190, v191
    s_nop 0
    v_permlane16_swap_b32 v184, v186
    v_permlane16_swap_b32 v185, v187
    v_accvgpr_write_b32 a12, v184
    v_accvgpr_write_b32 a13, v185
    v_accvgpr_write_b32 a14, v186
    v_accvgpr_write_b32 a15, v187
    v_lshrrev_b32 v20, 4, v1
    v_and_b32 v21, 1, v20
    v_lshrrev_b32 v22, 1, v20
    v_lshlrev_b32 v20, 8, v20
    v_sub_u32 v46, v2, v20
    v_lshl_add_u32 v46, v21, 10, v46
    v_lshl_add_u32 v46, v22, 8, v46
    v_add_u32 v47, 4096, v46
    v_add_u32 v45, 4096, v2
    s_barrier
    v_readlane_b32 s60, v42, 0
    s_nop 1
    s_lshl_b32 s60, s60, 17
    s_add_u32 m0, s38, 0
    s_nop 0
    buffer_load_dwordx4 v32, s[8:11], s60 offen offset:0 sc1 lds
    buffer_load_dwordx4 v32, s[8:11], s60 offen offset:1024 sc1 lds
    buffer_load_dwordx4 v32, s[8:11], s60 offen offset:2048 sc1 lds
    buffer_load_dwordx4 v32, s[8:11], s60 offen offset:3072 sc1 lds
    v_readlane_b32 s60, v42, 1
    s_nop 1
    s_lshl_b32 s60, s60, 17
    s_add_u32 m0, s38, 16384
    s_nop 0
    buffer_load_dwordx4 v32, s[8:11], s60 offen offset:0 sc1 lds
    buffer_load_dwordx4 v32, s[8:11], s60 offen offset:1024 sc1 lds
    buffer_load_dwordx4 v32, s[8:11], s60 offen offset:2048 sc1 lds
    buffer_load_dwordx4 v32, s[8:11], s60 offen offset:3072 sc1 lds
    v_readlane_b32 s60, v42, 2
    s_nop 1
    s_lshl_b32 s60, s60, 17
    s_add_u32 m0, s38, 32768
    s_nop 0
    buffer_load_dwordx4 v32, s[8:11], s60 offen offset:0 sc1 lds
    buffer_load_dwordx4 v32, s[8:11], s60 offen offset:1024 sc1 lds
    buffer_load_dwordx4 v32, s[8:11], s60 offen offset:2048 sc1 lds
    buffer_load_dwordx4 v32, s[8:11], s60 offen offset:3072 sc1 lds
    v_readlane_b32 s60, v42, 3
    s_nop 1
    s_lshl_b32 s60, s60, 17
    s_add_u32 m0, s38, 49152
    s_nop 0
    buffer_load_dwordx4 v32, s[8:11], s60 offen offset:0 sc1 lds
    buffer_load_dwordx4 v32, s[8:11], s60 offen offset:1024 sc1 lds
    buffer_load_dwordx4 v32, s[8:11], s60 offen offset:2048 sc1 lds
    buffer_load_dwordx4 v32, s[8:11], s60 offen offset:3072 sc1 lds
    v_readlane_b32 s60, v42, 4
    s_nop 1
    s_lshl_b32 s60, s60, 17
    s_add_u32 m0, s38, 65536
    s_nop 0
    buffer_load_dwordx4 v32, s[8:11], s60 offen offset:0 sc1 lds
    buffer_load_dwordx4 v32, s[8:11], s60 offen offset:1024 sc1 lds
    buffer_load_dwordx4 v32, s[8:11], s60 offen offset:2048 sc1 lds
    buffer_load_dwordx4 v32, s[8:11], s60 offen offset:3072 sc1 lds
L2_late:
    s_load_dwordx2 s[56:57], s[0:1], 56
    s_load_dwordx2 s[58:59], s[0:1], 0
    s_and_b32 s3, s51, 1
    s_mov_b32 s40, 0
    s_lshl_b32 s60, s52, 12
    v_lshl_add_u32 v2, v1, 4, s60
    v_add_u32 v3, 65536, v2
    v_lshrrev_b32 v24, 2, v1
    v_and_b32 v25, 7, v24
    v_lshlrev_b32 v25, 5, v25
    v_and_b32 v26, 3, v1
    v_lshlrev_b32 v26, 3, v26
    v_add_u32 v26, 81920, v26
    v_lshl_add_u32 v18, v24, 8, v26
    s_lshl_b32 s60, s3, 6
    s_lshl_b32 s45, s41, 7
    s_add_u32 s45, s45, s60
    s_xor_b32 s61, s45, 0
    v_xor_b32 v27, s61, v25
    v_add_u32 v4, v27, v18
    v_add_u32 v8, 65536, v4
    s_xor_b32 s61, s45, 32
    v_xor_b32 v27, s61, v25
    v_add_u32 v5, v27, v18
    v_add_u32 v9, 65536, v5
    s_xor_b32 s61, s45, 128
    v_xor_b32 v27, s61, v25
    v_add_u32 v6, v27, v18
    v_add_u32 v10, 65536, v6
    s_xor_b32 s61, s45, 160
    v_xor_b32 v27, s61, v25
    v_add_u32 v7, v27, v18
    v_add_u32 v11, 65536, v7
    s_waitcnt vmcnt(16)
    s_barrier
    ds_read_b64_tr_b16 v[160:161], v4 offset:0
    ds_read_b64_tr_b16 v[162:163], v4 offset:4096
    ds_read_b128 v[128:131], v2 offset:0
    ds_read_b64_tr_b16 v[176:177], v4 offset:8192
    ds_read_b64_tr_b16 v[178:179], v4 offset:12288
    ds_read_b128 v[144:147], v2 offset:8192
    ds_read_b128 v[132:135], v2 offset:1024
    ds_read_b128 v[148:151], v2 offset:9216
    ds_read_b128 v[136:139], v2 offset:2048
    ds_read_b128 v[152:155], v2 offset:10240
    ds_read_b128 v[140:143], v2 offset:3072
    ds_read_b128 v[156:159], v2 offset:11264
    ds_read_b64_tr_b16 v[164:165], v5 offset:0
    ds_read_b64_tr_b16 v[166:167], v5 offset:4096
    ds_read_b64_tr_b16 v[180:181], v5 offset:8192
    ds_read_b64_tr_b16 v[182:183], v5 offset:12288
    ds_read_b64_tr_b16 v[168:169], v6 offset:0
    ds_read_b64_tr_b16 v[170:171], v6 offset:4096
    ds_read_b64_tr_b16 v[184:185], v6 offset:8192
    ds_read_b64_tr_b16 v[186:187], v6 offset:12288
    ds_read_b64_tr_b16 v[172:173], v7 offset:0
    ds_read_b64_tr_b16 v[174:175], v7 offset:4096
    ds_read_b64_tr_b16 v[188:189], v7 offset:8192
    ds_read_b64_tr_b16 v[190:191], v7 offset:12288
    s_waitcnt vmcnt(12) lgkmcnt(0)
    s_barrier
    v_mfma_f32_16x16x32_bf16 v[64:67], v[160:163], v[128:131], 0
    ds_read_b64_tr_b16 v[224:225], v4 offset:16384
    s_add_u32 m0, s39, 0
    s_lshl_b32 s44, s51, 11
    s_add_u32 s44, s44, 81920
    v_mfma_f32_16x16x32_bf16 v[64:67], v[176:179], v[144:147], v[64:67]
    ds_read_b64_tr_b16 v[226:227], v4 offset:20480
    buffer_load_dwordx4 v33, s[12:15], s37 offen sc1 lds
    v_and_b32 v25, 6, v24
    v_mfma_f32_16x16x32_bf16 v[68:71], v[160:163], v[132:135], 0
    ds_read_b128 v[192:195], v2 offset:16384
    v_lshlrev_b32 v25, 4, v25
    v_mfma_f32_16x16x32_bf16 v[68:71], v[176:179], v[148:151], v[68:71]
    ds_read_b64_tr_b16 v[240:241], v4 offset:24576
    s_add_u32 m0, s39, 1024
    v_lshl_add_u32 v26, v24, 7, v26
    v_mfma_f32_16x16x32_bf16 v[72:75], v[160:163], v[136:139], 0
    ds_read_b64_tr_b16 v[242:243], v4 offset:28672
    buffer_load_dwordx4 v34, s[12:15], s37 offen sc1 lds
    s_lshl_b32 s46, s3, 6
    v_mfma_f32_16x16x32_bf16 v[72:75], v[176:179], v[152:155], v[72:75]
    ds_read_b128 v[208:211], v2 offset:24576
    s_or_b32 s61, s46, 0
    v_xor_b32 v27, s61, v25
    v_mfma_f32_16x16x32_bf16 v[76:79], v[160:163], v[140:143], 0
    ds_read_b128 v[196:199], v2 offset:17408
    s_add_u32 m0, s39, 2048
    v_add_u32 v20, v27, v26
    v_mfma_f32_16x16x32_bf16 v[76:79], v[176:179], v[156:159], v[76:79]
    ds_read_b128 v[212:215], v2 offset:25600
    buffer_load_dwordx4 v35, s[12:15], s37 offen sc1 lds
    v_add_u32 v22, 65536, v20
    v_mfma_f32_16x16x32_bf16 v[80:83], v[164:167], v[128:131], 0
    ds_read_b128 v[200:203], v2 offset:18432
    s_or_b32 s61, s46, 32
    v_mfma_f32_16x16x32_bf16 v[80:83], v[180:183], v[144:147], v[80:83]
    ds_read_b128 v[216:219], v2 offset:26624
    s_add_u32 m0, s39, 3072
    v_xor_b32 v27, s61, v25
    v_mfma_f32_16x16x32_bf16 v[84:87], v[164:167], v[132:135], 0
    ds_read_b128 v[204:207], v2 offset:19456
    buffer_load_dwordx4 v36, s[12:15], s37 offen sc1 lds
    v_add_u32 v21, v27, v26
    v_mfma_f32_16x16x32_bf16 v[84:87], v[180:183], v[148:151], v[84:87]
    ds_read_b128 v[220:223], v2 offset:27648
    v_add_u32 v23, 65536, v21
    v_lshrrev_b32 v24, 3, v1
    v_mfma_f32_16x16x32_bf16 v[88:91], v[164:167], v[136:139], 0
    ds_read_b64_tr_b16 v[228:229], v5 offset:16384
    s_add_u32 m0, s38, 0
    v_and_b32 v25, 6, v24
    v_mfma_f32_16x16x32_bf16 v[88:91], v[180:183], v[152:155], v[88:91]
    ds_read_b64_tr_b16 v[230:231], v5 offset:20480
    buffer_load_dwordx4 v32, s[8:11], s36 offen offset:0 sc1 lds
    v_and_b32 v26, 7, v1
    v_mfma_f32_16x16x32_bf16 v[92:95], v[164:167], v[140:143], 0
    ds_read_b64_tr_b16 v[244:245], v5 offset:24576
    v_xor_b32 v25, v25, v26
    v_mfma_f32_16x16x32_bf16 v[92:95], v[180:183], v[156:159], v[92:95]
    ds_read_b64_tr_b16 v[246:247], v5 offset:28672
    s_lshl_b32 s46, s3, 15
    v_mfma_f32_16x16x32_bf16 v[96:99], v[168:171], v[128:131], 0
    ds_read_b64_tr_b16 v[232:233], v6 offset:16384
    buffer_load_dwordx4 v32, s[8:11], s36 offen offset:1024 sc1 lds
    s_lshl_b32 s61, s43, 8
    s_or_b32 s46, s46, s61
    v_mfma_f32_16x16x32_bf16 v[96:99], v[184:187], v[144:147], v[96:99]
    ds_read_b64_tr_b16 v[234:235], v6 offset:20480
    s_lshl_b32 s61, s41, 7
    v_mfma_f32_16x16x32_bf16 v[100:103], v[168:171], v[132:135], 0
    ds_read_b64_tr_b16 v[248:249], v6 offset:24576
    s_or_b32 s46, s46, s61
    v_mfma_f32_16x16x32_bf16 v[100:103], v[184:187], v[148:151], v[100:103]
    ds_read_b64_tr_b16 v[250:251], v6 offset:28672
    buffer_load_dwordx4 v32, s[8:11], s36 offen offset:2048 sc1 lds
    v_lshl_add_u32 v24, v24, 11, s46
    v_mfma_f32_16x16x32_bf16 v[104:107], v[168:171], v[136:139], 0
    ds_read_b64_tr_b16 v[236:237], v7 offset:16384
    v_lshl_add_u32 v18, v25, 4, v24
    v_mfma_f32_16x16x32_bf16 v[104:107], v[184:187], v[152:155], v[104:107]
    ds_read_b64_tr_b16 v[238:239], v7 offset:20480
    v_add_u32 v19, 16384, v18
    v_mfma_f32_16x16x32_bf16 v[108:111], v[168:171], v[140:143], 0
    ds_read_b64_tr_b16 v[252:253], v7 offset:24576
    buffer_load_dwordx4 v32, s[8:11], s36 offen offset:3072 sc1 lds
    v_mfma_f32_16x16x32_bf16 v[108:111], v[184:187], v[156:159], v[108:111]
    ds_read_b64_tr_b16 v[254:255], v7 offset:28672
    s_add_u32 s53, s53, 1
    v_readlane_b32 s37, v42, s53
    v_mfma_f32_16x16x32_bf16 v[112:115], v[172:175], v[128:131], 0
    s_nop 0
    s_lshl_b32 s36, s37, 17
    s_cmp_lt_u32 s37, 32
    buffer_store_dwordx4 v[48:51], v45, s[32:35], s67 offen offset:0 sc1
    v_mfma_f32_16x16x32_bf16 v[112:115], v[188:191], v[144:147], v[112:115]
    s_cselect_b32 s12, s92, s68
    s_cselect_b32 s13, s93, s69
    v_mfma_f32_16x16x32_bf16 v[116:119], v[172:175], v[132:135], 0
    s_cselect_b32 s14, s54, s55
    s_cselect_b32 s60, 0, 32
    buffer_store_dwordx4 v[52:55], v45, s[32:35], s67 offen offset:1024 sc1
    v_mfma_f32_16x16x32_bf16 v[116:119], v[188:191], v[148:151], v[116:119]
    s_sub_u32 s37, s37, s60
    s_lshl_b32 s37, s37, 16
    v_mfma_f32_16x16x32_bf16 v[120:123], v[172:175], v[136:139], 0
    buffer_store_dwordx4 v[56:59], v45, s[32:35], s67 offen offset:2048 sc1
    v_mfma_f32_16x16x32_bf16 v[120:123], v[188:191], v[152:155], v[120:123]
    v_mfma_f32_16x16x32_bf16 v[124:127], v[172:175], v[140:143], 0
    v_mfma_f32_16x16x32_bf16 v[124:127], v[188:191], v[156:159], v[124:127]
    s_waitcnt vmcnt(19) lgkmcnt(0)
    s_barrier
    v_mfma_f32_16x16x32_bf16 v[64:67], v[224:227], v[192:195], v[64:67]
    ds_read_b64_tr_b16 v[160:161], v4 offset:32768
    s_add_u32 m0, s39, 16384
    s_mov_b32 s20, s58
    s_mov_b32 s21, s59
    v_mfma_f32_16x16x32_bf16 v[64:67], v[240:243], v[208:211], v[64:67]
    ds_read_b64_tr_b16 v[162:163], v4 offset:36864
    buffer_load_dwordx4 v33, s[12:15], s37 offen sc1 lds
    s_mov_b32 s22, 4194304
    v_mfma_f32_16x16x32_bf16 v[68:71], v[224:227], v[196:199], v[68:71]
    ds_read_b128 v[128:131], v2 offset:32768
    s_mov_b32 s23, 0x20000
    v_mfma_f32_16x16x32_bf16 v[68:71], v[240:243], v[212:215], v[68:71]
    ds_read_b64_tr_b16 v[176:177], v4 offset:40960
    s_add_u32 m0, s39, 17408
    s_mov_b32 s24, s56
    v_mfma_f32_16x16x32_bf16 v[72:75], v[224:227], v[200:203], v[72:75]
    ds_read_b64_tr_b16 v[178:179], v4 offset:45056
    buffer_load_dwordx4 v34, s[12:15], s37 offen sc1 lds
    s_mov_b32 s25, s57
    s_mov_b32 s26, 4194304
    v_mfma_f32_16x16x32_bf16 v[72:75], v[240:243], v[216:219], v[72:75]
    ds_read_b128 v[144:147], v2 offset:40960
    s_mov_b32 s27, 0x20000
    v_mfma_f32_16x16x32_bf16 v[76:79], v[224:227], v[204:207], v[76:79]
    ds_read_b128 v[132:135], v2 offset:33792
    s_add_u32 m0, s39, 18432
    s_lshl_b32 s46, s42, 18
    v_mfma_f32_16x16x32_bf16 v[76:79], v[240:243], v[220:223], v[76:79]
    ds_read_b128 v[148:151], v2 offset:41984
    buffer_load_dwordx4 v35, s[12:15], s37 offen sc1 lds
    s_lshl_b32 s61, s52, 17
    v_mfma_f32_16x16x32_bf16 v[80:83], v[228:231], v[192:195], v[80:83]
    ds_read_b128 v[136:139], v2 offset:34816
    s_or_b32 s46, s46, s61
    s_lshl_b32 s61, s43, 8
    v_mfma_f32_16x16x32_bf16 v[80:83], v[244:247], v[208:211], v[80:83]
    ds_read_b128 v[152:155], v2 offset:43008
    s_add_u32 m0, s39, 19456
    s_or_b32 s46, s46, s61
    v_mfma_f32_16x16x32_bf16 v[84:87], v[228:231], v[196:199], v[84:87]
    ds_read_b128 v[140:143], v2 offset:35840
    buffer_load_dwordx4 v36, s[12:15], s37 offen sc1 lds
    s_or_b32 s46, s46, s45
    v_mfma_f32_16x16x32_bf16 v[84:87], v[244:247], v[212:215], v[84:87]
    ds_read_b128 v[156:159], v2 offset:44032
    v_and_b32 v25, 15, v1
    v_mfma_f32_16x16x32_bf16 v[88:91], v[228:231], v[200:203], v[88:91]
    ds_read_b64_tr_b16 v[164:165], v5 offset:32768
    s_add_u32 m0, s38, 16384
    v_lshl_add_u32 v25, v25, 11, s46
    v_mfma_f32_16x16x32_bf16 v[88:91], v[244:247], v[216:219], v[88:91]
    ds_read_b64_tr_b16 v[166:167], v5 offset:36864
    buffer_load_dwordx4 v32, s[8:11], s36 offen offset:0 sc1 lds
    v_lshrrev_b32 v24, 4, v1
    v_and_b32 v26, 1, v24
    v_mfma_f32_16x16x32_bf16 v[92:95], v[228:231], v[204:207], v[92:95]
    ds_read_b64_tr_b16 v[180:181], v5 offset:40960
    v_lshl_add_u32 v25, v26, 5, v25
    v_mfma_f32_16x16x32_bf16 v[92:95], v[244:247], v[220:223], v[92:95]
    ds_read_b64_tr_b16 v[182:183], v5 offset:45056
    v_lshrrev_b32 v26, 1, v24
    v_mfma_f32_16x16x32_bf16 v[96:99], v[232:235], v[192:195], v[96:99]
    ds_read_b64_tr_b16 v[168:169], v6 offset:32768
    buffer_load_dwordx4 v32, s[8:11], s36 offen offset:1024 sc1 lds
    v_lshl_add_u32 v12, v26, 4, v25
    v_mfma_f32_16x16x32_bf16 v[96:99], v[248:251], v[208:211], v[96:99]
    ds_read_b64_tr_b16 v[170:171], v6 offset:36864
    s_lshl_b32 s46, s42, 6
    s_lshl_b32 s61, s43, 3
    v_mfma_f32_16x16x32_bf16 v[100:103], v[232:235], v[196:199], v[100:103]
    ds_read_b64_tr_b16 v[184:185], v6 offset:40960
    s_or_b32 s46, s46, s61
    v_mfma_f32_16x16x32_bf16 v[100:103], v[248:251], v[212:215], v[100:103]
    ds_read_b64_tr_b16 v[186:187], v6 offset:45056
    buffer_load_dwordx4 v32, s[8:11], s36 offen offset:2048 sc1 lds
    s_lshl_b32 s61, s41, 2
    v_mfma_f32_16x16x32_bf16 v[104:107], v[232:235], v[200:203], v[104:107]
    ds_read_b64_tr_b16 v[172:173], v7 offset:32768
    s_or_b32 s46, s46, s61
    v_mfma_f32_16x16x32_bf16 v[104:107], v[248:251], v[216:219], v[104:107]
    ds_read_b64_tr_b16 v[174:175], v7 offset:36864
    s_or_b32 s46, s46, s51
    v_mfma_f32_16x16x32_bf16 v[108:111], v[232:235], v[204:207], v[108:111]
    ds_read_b64_tr_b16 v[188:189], v7 offset:40960
    buffer_load_dwordx4 v32, s[8:11], s36 offen offset:3072 sc1 lds
    v_mfma_f32_16x16x32_bf16 v[108:111], v[248:251], v[220:223], v[108:111]
    ds_read_b64_tr_b16 v[190:191], v7 offset:45056
    s_add_u32 s53, s53, 1
    v_readlane_b32 s37, v42, s53
    v_mfma_f32_16x16x32_bf16 v[112:115], v[236:239], v[192:195], v[112:115]
    s_nop 0
    s_lshl_b32 s36, s37, 17
    s_cmp_lt_u32 s37, 32
    buffer_store_dwordx4 v[60:63], v45, s[32:35], s67 offen offset:3072 sc1
    v_mfma_f32_16x16x32_bf16 v[112:115], v[252:255], v[208:211], v[112:115]
    s_cselect_b32 s12, s92, s68
    s_cselect_b32 s13, s93, s69
    v_mfma_f32_16x16x32_bf16 v[116:119], v[236:239], v[196:199], v[116:119]
    s_cselect_b32 s14, s54, s55
    s_cselect_b32 s60, 0, 32
    buffer_store_dwordx4 a[0:3], v46, s[32:35], s66 offen offset:0 sc1
    v_mfma_f32_16x16x32_bf16 v[116:119], v[252:255], v[212:215], v[116:119]
    s_sub_u32 s37, s37, s60
    s_lshl_b32 s37, s37, 16
    v_mfma_f32_16x16x32_bf16 v[120:123], v[236:239], v[200:203], v[120:123]
    buffer_store_dwordx4 a[4:7], v46, s[32:35], s66 offen offset:2048 sc1
    v_mfma_f32_16x16x32_bf16 v[120:123], v[252:255], v[216:219], v[120:123]
    v_mfma_f32_16x16x32_bf16 v[124:127], v[236:239], v[204:207], v[124:127]
    v_mfma_f32_16x16x32_bf16 v[124:127], v[252:255], v[220:223], v[124:127]
    s_waitcnt vmcnt(26) lgkmcnt(0)
    s_barrier
    v_mfma_f32_16x16x32_bf16 v[64:67], v[160:163], v[128:131], v[64:67]
    ds_read_b64_tr_b16 v[224:225], v4 offset:49152
    s_add_u32 m0, s39, 32768
    s_xor_b32 s47, s46, 4
    s_lshl_b32 s61, s46, 7
    v_mfma_f32_16x16x32_bf16 v[64:67], v[176:179], v[144:147], v[64:67]
    ds_read_b64_tr_b16 v[226:227], v4 offset:53248
    buffer_load_dwordx4 v33, s[12:15], s37 offen sc1 lds
    v_mov_b32 v16, s61
    v_mfma_f32_16x16x32_bf16 v[68:71], v[160:163], v[132:135], v[68:71]
    ds_read_b128 v[192:195], v2 offset:49152
    s_lshl_b32 s61, s47, 7
    v_mfma_f32_16x16x32_bf16 v[68:71], v[176:179], v[148:151], v[68:71]
    ds_read_b64_tr_b16 v[240:241], v4 offset:57344
    s_add_u32 m0, s39, 33792
    v_mov_b32 v17, s61
    v_mfma_f32_16x16x32_bf16 v[72:75], v[160:163], v[136:139], v[72:75]
    ds_read_b64_tr_b16 v[242:243], v4 offset:61440
    buffer_load_dwordx4 v34, s[12:15], s37 offen sc1 lds
    s_lshl_b32 s46, s46, 12
    s_lshl_b32 s47, s47, 12
    v_mfma_f32_16x16x32_bf16 v[72:75], v[176:179], v[152:155], v[72:75]
    ds_read_b128 v[208:211], v2 offset:57344
    v_lshl_add_u32 v14, v1, 4, s46
    v_mfma_f32_16x16x32_bf16 v[76:79], v[160:163], v[140:143], v[76:79]
    ds_read_b128 v[196:199], v2 offset:50176
    s_add_u32 m0, s39, 34816
    v_lshl_add_u32 v15, v1, 4, s47
    v_mfma_f32_16x16x32_bf16 v[76:79], v[176:179], v[156:159], v[76:79]
    ds_read_b128 v[212:215], v2 offset:58368
    buffer_load_dwordx4 v35, s[12:15], s37 offen sc1 lds
    s_add_u32 s16, s6, 25165824
    s_addc_u32 s17, s7, 0
    v_mfma_f32_16x16x32_bf16 v[80:83], v[164:167], v[128:131], v[80:83]
    ds_read_b128 v[200:203], v2 offset:51200
    s_mov_b32 s18, 4194304
    v_mfma_f32_16x16x32_bf16 v[80:83], v[180:183], v[144:147], v[80:83]
    ds_read_b128 v[216:219], v2 offset:59392
    s_add_u32 m0, s39, 35840
    s_mov_b32 s19, 0x20000
    v_mfma_f32_16x16x32_bf16 v[84:87], v[164:167], v[132:135], v[84:87]
    ds_read_b128 v[204:207], v2 offset:52224
    buffer_load_dwordx4 v36, s[12:15], s37 offen sc1 lds
    v_add_u32 v40, 131072, v40
    v_mfma_f32_16x16x32_bf16 v[84:87], v[180:183], v[148:151], v[84:87]
    ds_read_b128 v[220:223], v2 offset:60416
    s_lshl_b32 s46, s51, 4
    v_mfma_f32_16x16x32_bf16 v[88:91], v[164:167], v[136:139], v[88:91]
    ds_read_b64_tr_b16 v[228:229], v5 offset:49152
    s_add_u32 m0, s38, 32768
    v_readlane_b32 s47, v41, s46
    v_mfma_f32_16x16x32_bf16 v[88:91], v[180:183], v[152:155], v[88:91]
    ds_read_b64_tr_b16 v[230:231], v5 offset:53248
    buffer_load_dwordx4 v32, s[8:11], s36 offen offset:0 sc1 lds
    s_add_u32 s47, s47, 131072
    v_bfe_u32 v24, v1, 1, 3
    v_mfma_f32_16x16x32_bf16 v[92:95], v[164:167], v[140:143], v[92:95]
    ds_read_b64_tr_b16 v[244:245], v5 offset:57344
    v_lshl_add_u32 v41, v24, 9, s47
    v_mfma_f32_16x16x32_bf16 v[92:95], v[180:183], v[156:159], v[92:95]
    ds_read_b64_tr_b16 v[246:247], v5 offset:61440
    v_and_b32 v24, 1, v1
    v_mfma_f32_16x16x32_bf16 v[96:99], v[168:171], v[128:131], v[96:99]
    ds_read_b64_tr_b16 v[232:233], v6 offset:49152
    buffer_load_dwordx4 v32, s[8:11], s36 offen offset:1024 sc1 lds
    v_lshl_add_u32 v41, v24, 7, v41
    v_mfma_f32_16x16x32_bf16 v[96:99], v[184:187], v[144:147], v[96:99]
    ds_read_b64_tr_b16 v[234:235], v6 offset:53248
    s_mul_i32 s65, s41, 21
    s_sub_u32 s65, s65, 1
    v_mfma_f32_16x16x32_bf16 v[100:103], v[168:171], v[132:135], v[100:103]
    ds_read_b64_tr_b16 v[248:249], v6 offset:57344
    s_mov_b32 s64, 0xffff0000
    v_mfma_f32_16x16x32_bf16 v[100:103], v[184:187], v[148:151], v[100:103]
    ds_read_b64_tr_b16 v[250:251], v6 offset:61440
    buffer_load_dwordx4 v32, s[8:11], s36 offen offset:2048 sc1 lds
    s_mov_b32 s61, 32768
    v_mfma_f32_16x16x32_bf16 v[104:107], v[168:171], v[136:139], v[104:107]
    ds_read_b64_tr_b16 v[236:237], v7 offset:49152
    s_mov_b32 s62, 65536
    v_mfma_f32_16x16x32_bf16 v[104:107], v[184:187], v[152:155], v[104:107]
    ds_read_b64_tr_b16 v[238:239], v7 offset:53248
    s_mov_b32 s63, 98304
    v_mfma_f32_16x16x32_bf16 v[108:111], v[168:171], v[140:143], v[108:111]
    ds_read_b64_tr_b16 v[252:253], v7 offset:57344
    buffer_load_dwordx4 v32, s[8:11], s36 offen offset:3072 sc1 lds
    v_mfma_f32_16x16x32_bf16 v[108:111], v[184:187], v[156:159], v[108:111]
    ds_read_b64_tr_b16 v[254:255], v7 offset:61440
    s_add_u32 s53, s53, 1
    v_readlane_b32 s37, v42, s53
    v_mfma_f32_16x16x32_bf16 v[112:115], v[172:175], v[128:131], v[112:115]
    s_nop 0
    s_lshl_b32 s36, s37, 17
    s_cmp_lt_u32 s37, 32
    buffer_store_dwordx4 a[8:11], v47, s[32:35], s66 offen offset:0 sc1
    v_mfma_f32_16x16x32_bf16 v[112:115], v[188:191], v[144:147], v[112:115]
    s_cselect_b32 s12, s92, s68
    s_cselect_b32 s13, s93, s69
    v_mfma_f32_16x16x32_bf16 v[116:119], v[172:175], v[132:135], v[116:119]
    s_cselect_b32 s14, s54, s55
    s_cselect_b32 s60, 0, 32
    buffer_store_dwordx4 a[12:15], v47, s[32:35], s66 offen offset:2048 sc1
    v_mfma_f32_16x16x32_bf16 v[116:119], v[188:191], v[148:151], v[116:119]
    s_sub_u32 s37, s37, s60
    s_lshl_b32 s37, s37, 16
    v_mfma_f32_16x16x32_bf16 v[120:123], v[172:175], v[136:139], v[120:123]
    v_mfma_f32_16x16x32_bf16 v[120:123], v[188:191], v[152:155], v[120:123]
    v_mfma_f32_16x16x32_bf16 v[124:127], v[172:175], v[140:143], v[124:127]
    v_mfma_f32_16x16x32_bf16 v[124:127], v[188:191], v[156:159], v[124:127]
    s_waitcnt vmcnt(32) lgkmcnt(0)
    s_barrier
    v_mfma_f32_16x16x32_bf16 v[64:67], v[224:227], v[192:195], v[64:67]
    ds_read_b64_tr_b16 v[160:161], v8 offset:0
    s_add_u32 m0, s39, 49152
    v_mfma_f32_16x16x32_bf16 v[64:67], v[240:243], v[208:211], v[64:67]
    ds_read_b64_tr_b16 v[162:163], v8 offset:4096
    buffer_load_dwordx4 v33, s[12:15], s37 offen sc1 lds
    v_mfma_f32_16x16x32_bf16 v[68:71], v[224:227], v[196:199], v[68:71]
    ds_read_b128 v[128:131], v3 offset:0
    v_mfma_f32_16x16x32_bf16 v[68:71], v[240:243], v[212:215], v[68:71]
    ds_read_b64_tr_b16 v[176:177], v8 offset:8192
    s_add_u32 m0, s39, 50176
    v_mfma_f32_16x16x32_bf16 v[72:75], v[224:227], v[200:203], v[72:75]
    ds_read_b64_tr_b16 v[178:179], v8 offset:12288
    buffer_load_dwordx4 v34, s[12:15], s37 offen sc1 lds
    v_mfma_f32_16x16x32_bf16 v[72:75], v[240:243], v[216:219], v[72:75]
    ds_read_b128 v[144:147], v3 offset:8192
    v_mfma_f32_16x16x32_bf16 v[76:79], v[224:227], v[204:207], v[76:79]
    ds_read_b128 v[132:135], v3 offset:1024
    s_add_u32 m0, s39, 51200
    v_mfma_f32_16x16x32_bf16 v[76:79], v[240:243], v[220:223], v[76:79]
    ds_read_b128 v[148:151], v3 offset:9216
    buffer_load_dwordx4 v35, s[12:15], s37 offen sc1 lds
    v_mfma_f32_16x16x32_bf16 v[80:83], v[228:231], v[192:195], v[80:83]
    ds_read_b128 v[136:139], v3 offset:2048
    v_mfma_f32_16x16x32_bf16 v[80:83], v[244:247], v[208:211], v[80:83]
    ds_read_b128 v[152:155], v3 offset:10240
    s_add_u32 m0, s39, 52224
    v_mfma_f32_16x16x32_bf16 v[84:87], v[228:231], v[196:199], v[84:87]
    ds_read_b128 v[140:143], v3 offset:3072
    buffer_load_dwordx4 v36, s[12:15], s37 offen sc1 lds
    v_mfma_f32_16x16x32_bf16 v[84:87], v[244:247], v[212:215], v[84:87]
    ds_read_b128 v[156:159], v3 offset:11264
    v_mfma_f32_16x16x32_bf16 v[88:91], v[228:231], v[200:203], v[88:91]
    ds_read_b64_tr_b16 v[164:165], v9 offset:0
    s_add_u32 m0, s38, 49152
    v_mfma_f32_16x16x32_bf16 v[88:91], v[244:247], v[216:219], v[88:91]
    ds_read_b64_tr_b16 v[166:167], v9 offset:4096
    buffer_load_dwordx4 v32, s[8:11], s36 offen offset:0 sc1 lds
    v_mfma_f32_16x16x32_bf16 v[92:95], v[228:231], v[204:207], v[92:95]
    ds_read_b64_tr_b16 v[180:181], v9 offset:8192
    v_mfma_f32_16x16x32_bf16 v[92:95], v[244:247], v[220:223], v[92:95]
    ds_read_b64_tr_b16 v[182:183], v9 offset:12288
    v_mfma_f32_16x16x32_bf16 v[96:99], v[232:235], v[192:195], v[96:99]
    ds_read_b64_tr_b16 v[168:169], v10 offset:0
    buffer_load_dwordx4 v32, s[8:11], s36 offen offset:1024 sc1 lds
    v_mfma_f32_16x16x32_bf16 v[96:99], v[248:251], v[208:211], v[96:99]
    ds_read_b64_tr_b16 v[170:171], v10 offset:4096
    v_mfma_f32_16x16x32_bf16 v[100:103], v[232:235], v[196:199], v[100:103]
    ds_read_b64_tr_b16 v[184:185], v10 offset:8192
    v_mfma_f32_16x16x32_bf16 v[100:103], v[248:251], v[212:215], v[100:103]
    ds_read_b64_tr_b16 v[186:187], v10 offset:12288
    buffer_load_dwordx4 v32, s[8:11], s36 offen offset:2048 sc1 lds
    v_mfma_f32_16x16x32_bf16 v[104:107], v[232:235], v[200:203], v[104:107]
    ds_read_b64_tr_b16 v[172:173], v11 offset:0
    v_mfma_f32_16x16x32_bf16 v[104:107], v[248:251], v[216:219], v[104:107]
    ds_read_b64_tr_b16 v[174:175], v11 offset:4096
    v_mfma_f32_16x16x32_bf16 v[108:111], v[232:235], v[204:207], v[108:111]
    ds_read_b64_tr_b16 v[188:189], v11 offset:8192
    buffer_load_dwordx4 v32, s[8:11], s36 offen offset:3072 sc1 lds
    v_mfma_f32_16x16x32_bf16 v[108:111], v[248:251], v[220:223], v[108:111]
    ds_read_b64_tr_b16 v[190:191], v11 offset:12288
    s_add_u32 s53, s53, 1
    v_readlane_b32 s37, v42, s53
    v_mfma_f32_16x16x32_bf16 v[112:115], v[236:239], v[192:195], v[112:115]
    s_nop 0
    s_lshl_b32 s36, s37, 17
    s_cmp_lt_u32 s37, 32
    v_mfma_f32_16x16x32_bf16 v[112:115], v[252:255], v[208:211], v[112:115]
    s_cselect_b32 s12, s92, s68
    s_cselect_b32 s13, s93, s69
    v_mfma_f32_16x16x32_bf16 v[116:119], v[236:239], v[196:199], v[116:119]
    s_cselect_b32 s14, s54, s55
    s_cselect_b32 s60, 0, 32
    v_mfma_f32_16x16x32_bf16 v[116:119], v[252:255], v[212:215], v[116:119]
    s_sub_u32 s37, s37, s60
    s_lshl_b32 s37, s37, 16
    v_mfma_f32_16x16x32_bf16 v[120:123], v[236:239], v[200:203], v[120:123]
    v_mfma_f32_16x16x32_bf16 v[120:123], v[252:255], v[216:219], v[120:123]
    v_mfma_f32_16x16x32_bf16 v[124:127], v[236:239], v[204:207], v[124:127]
    v_mfma_f32_16x16x32_bf16 v[124:127], v[252:255], v[220:223], v[124:127]
    s_waitcnt vmcnt(32) lgkmcnt(0)
    s_barrier
    v_mfma_f32_16x16x32_bf16 v[64:67], v[160:163], v[128:131], v[64:67]
    ds_read_b64_tr_b16 v[224:225], v4 offset:0
    s_add_u32 m0, s39, 65536
    v_mfma_f32_16x16x32_bf16 v[64:67], v[176:179], v[144:147], v[64:67]
    ds_read_b64_tr_b16 v[226:227], v4 offset:4096
    buffer_load_dwordx4 v33, s[12:15], s37 offen sc1 lds
    v_mfma_f32_16x16x32_bf16 v[68:71], v[160:163], v[132:135], v[68:71]
    ds_read_b128 v[192:195], v2 offset:0
    v_mfma_f32_16x16x32_bf16 v[68:71], v[176:179], v[148:151], v[68:71]
    ds_read_b64_tr_b16 v[240:241], v4 offset:8192
    s_add_u32 m0, s39, 66560
    v_mfma_f32_16x16x32_bf16 v[72:75], v[160:163], v[136:139], v[72:75]
    ds_read_b64_tr_b16 v[242:243], v4 offset:12288
    buffer_load_dwordx4 v34, s[12:15], s37 offen sc1 lds
    v_mfma_f32_16x16x32_bf16 v[72:75], v[176:179], v[152:155], v[72:75]
    ds_read_b128 v[208:211], v2 offset:8192
    v_mfma_f32_16x16x32_bf16 v[76:79], v[160:163], v[140:143], v[76:79]
    ds_read_b128 v[196:199], v2 offset:1024
    s_add_u32 m0, s39, 67584
    v_mfma_f32_16x16x32_bf16 v[76:79], v[176:179], v[156:159], v[76:79]
    ds_read_b128 v[212:215], v2 offset:9216
    buffer_load_dwordx4 v35, s[12:15], s37 offen sc1 lds
    v_mfma_f32_16x16x32_bf16 v[80:83], v[164:167], v[128:131], v[80:83]
    ds_read_b128 v[200:203], v2 offset:2048
    v_mfma_f32_16x16x32_bf16 v[80:83], v[180:183], v[144:147], v[80:83]
    ds_read_b128 v[216:219], v2 offset:10240
    s_add_u32 m0, s39, 68608
    v_mfma_f32_16x16x32_bf16 v[84:87], v[164:167], v[132:135], v[84:87]
    ds_read_b128 v[204:207], v2 offset:3072
    buffer_load_dwordx4 v36, s[12:15], s37 offen sc1 lds
    v_mfma_f32_16x16x32_bf16 v[84:87], v[180:183], v[148:151], v[84:87]
    ds_read_b128 v[220:223], v2 offset:11264
    v_mfma_f32_16x16x32_bf16 v[88:91], v[164:167], v[136:139], v[88:91]
    ds_read_b64_tr_b16 v[228:229], v5 offset:0
    s_add_u32 m0, s38, 65536
    v_mfma_f32_16x16x32_bf16 v[88:91], v[180:183], v[152:155], v[88:91]
    ds_read_b64_tr_b16 v[230:231], v5 offset:4096
    buffer_load_dwordx4 v32, s[8:11], s36 offen offset:0 sc1 lds
    v_mfma_f32_16x16x32_bf16 v[92:95], v[164:167], v[140:143], v[92:95]
    ds_read_b64_tr_b16 v[244:245], v5 offset:8192
    v_mfma_f32_16x16x32_bf16 v[92:95], v[180:183], v[156:159], v[92:95]
    ds_read_b64_tr_b16 v[246:247], v5 offset:12288
    v_mfma_f32_16x16x32_bf16 v[96:99], v[168:171], v[128:131], v[96:99]
    ds_read_b64_tr_b16 v[232:233], v6 offset:0
    buffer_load_dwordx4 v32, s[8:11], s36 offen offset:1024 sc1 lds
    v_mfma_f32_16x16x32_bf16 v[96:99], v[184:187], v[144:147], v[96:99]
    ds_read_b64_tr_b16 v[234:235], v6 offset:4096
    v_mfma_f32_16x16x32_bf16 v[100:103], v[168:171], v[132:135], v[100:103]
    ds_read_b64_tr_b16 v[248:249], v6 offset:8192
    v_mfma_f32_16x16x32_bf16 v[100:103], v[184:187], v[148:151], v[100:103]
    ds_read_b64_tr_b16 v[250:251], v6 offset:12288
    buffer_load_dwordx4 v32, s[8:11], s36 offen offset:2048 sc1 lds
    v_mfma_f32_16x16x32_bf16 v[104:107], v[168:171], v[136:139], v[104:107]
    ds_read_b64_tr_b16 v[236:237], v7 offset:0
    v_mfma_f32_16x16x32_bf16 v[104:107], v[184:187], v[152:155], v[104:107]
    ds_read_b64_tr_b16 v[238:239], v7 offset:4096
    v_mfma_f32_16x16x32_bf16 v[108:111], v[168:171], v[140:143], v[108:111]
    ds_read_b64_tr_b16 v[252:253], v7 offset:8192
    buffer_load_dwordx4 v32, s[8:11], s36 offen offset:3072 sc1 lds
    v_mfma_f32_16x16x32_bf16 v[108:111], v[184:187], v[156:159], v[108:111]
    ds_read_b64_tr_b16 v[254:255], v7 offset:12288
    s_add_u32 s53, s53, 1
    v_readlane_b32 s37, v42, s53
    v_mfma_f32_16x16x32_bf16 v[112:115], v[172:175], v[128:131], v[112:115]
    s_nop 0
    s_lshl_b32 s36, s37, 17
    s_cmp_lt_u32 s37, 32
    v_mfma_f32_16x16x32_bf16 v[112:115], v[188:191], v[144:147], v[112:115]
    s_cselect_b32 s12, s92, s68
    s_cselect_b32 s13, s93, s69
    v_mfma_f32_16x16x32_bf16 v[116:119], v[172:175], v[132:135], v[116:119]
    s_cselect_b32 s14, s54, s55
    s_cselect_b32 s60, 0, 32
    v_mfma_f32_16x16x32_bf16 v[116:119], v[188:191], v[148:151], v[116:119]
    s_sub_u32 s37, s37, s60
    s_lshl_b32 s37, s37, 16
    v_mfma_f32_16x16x32_bf16 v[120:123], v[172:175], v[136:139], v[120:123]
    v_mfma_f32_16x16x32_bf16 v[120:123], v[188:191], v[152:155], v[120:123]
    v_mfma_f32_16x16x32_bf16 v[124:127], v[172:175], v[140:143], v[124:127]
    v_mfma_f32_16x16x32_bf16 v[124:127], v[188:191], v[156:159], v[124:127]
    s_waitcnt vmcnt(29) lgkmcnt(0)
    s_barrier
    v_mfma_f32_16x16x32_bf16 v[64:67], v[224:227], v[192:195], v[64:67]
    ds_read_b64_tr_b16 v[160:161], v4 offset:16384
    s_add_u32 m0, s39, 0
    v_mfma_f32_16x16x32_bf16 v[64:67], v[240:243], v[208:211], v[64:67]
    ds_read_b64_tr_b16 v[162:163], v4 offset:20480
    buffer_load_dwordx4 v33, s[12:15], s37 offen sc1 lds
    v_mfma_f32_16x16x32_bf16 v[68:71], v[224:227], v[196:199], v[68:71]
    ds_read_b128 v[128:131], v2 offset:16384
    v_mfma_f32_16x16x32_bf16 v[68:71], v[240:243], v[212:215], v[68:71]
    ds_read_b64_tr_b16 v[176:177], v4 offset:24576
    s_add_u32 m0, s39, 1024
    v_mfma_f32_16x16x32_bf16 v[72:75], v[224:227], v[200:203], v[72:75]
    ds_read_b64_tr_b16 v[178:179], v4 offset:28672
    buffer_load_dwordx4 v34, s[12:15], s37 offen sc1 lds
    v_mfma_f32_16x16x32_bf16 v[72:75], v[240:243], v[216:219], v[72:75]
    ds_read_b128 v[144:147], v2 offset:24576
    v_mfma_f32_16x16x32_bf16 v[76:79], v[224:227], v[204:207], v[76:79]
    ds_read_b128 v[132:135], v2 offset:17408
    s_add_u32 m0, s39, 2048
    v_mfma_f32_16x16x32_bf16 v[76:79], v[240:243], v[220:223], v[76:79]
    ds_read_b128 v[148:151], v2 offset:25600
    buffer_load_dwordx4 v35, s[12:15], s37 offen sc1 lds
    v_mfma_f32_16x16x32_bf16 v[80:83], v[228:231], v[192:195], v[80:83]
    ds_read_b128 v[136:139], v2 offset:18432
    v_mfma_f32_16x16x32_bf16 v[80:83], v[244:247], v[208:211], v[80:83]
    ds_read_b128 v[152:155], v2 offset:26624
    s_add_u32 m0, s39, 3072
    v_mfma_f32_16x16x32_bf16 v[84:87], v[228:231], v[196:199], v[84:87]
    ds_read_b128 v[140:143], v2 offset:19456
    buffer_load_dwordx4 v36, s[12:15], s37 offen sc1 lds
    v_mfma_f32_16x16x32_bf16 v[84:87], v[244:247], v[212:215], v[84:87]
    ds_read_b128 v[156:159], v2 offset:27648
    v_mfma_f32_16x16x32_bf16 v[88:91], v[228:231], v[200:203], v[88:91]
    ds_read_b64_tr_b16 v[164:165], v5 offset:16384
    s_add_u32 m0, s38, 0
    v_mfma_f32_16x16x32_bf16 v[88:91], v[244:247], v[216:219], v[88:91]
    ds_read_b64_tr_b16 v[166:167], v5 offset:20480
    buffer_load_dwordx4 v32, s[8:11], s36 offen offset:0 sc1 lds
    v_mfma_f32_16x16x32_bf16 v[92:95], v[228:231], v[204:207], v[92:95]
    ds_read_b64_tr_b16 v[180:181], v5 offset:24576
    v_mfma_f32_16x16x32_bf16 v[92:95], v[244:247], v[220:223], v[92:95]
    ds_read_b64_tr_b16 v[182:183], v5 offset:28672
    v_mfma_f32_16x16x32_bf16 v[96:99], v[232:235], v[192:195], v[96:99]
    ds_read_b64_tr_b16 v[168:169], v6 offset:16384
    buffer_load_dwordx4 v32, s[8:11], s36 offen offset:1024 sc1 lds
    v_mfma_f32_16x16x32_bf16 v[96:99], v[248:251], v[208:211], v[96:99]
    ds_read_b64_tr_b16 v[170:171], v6 offset:20480
    v_mfma_f32_16x16x32_bf16 v[100:103], v[232:235], v[196:199], v[100:103]
    ds_read_b64_tr_b16 v[184:185], v6 offset:24576
    v_mfma_f32_16x16x32_bf16 v[100:103], v[248:251], v[212:215], v[100:103]
    ds_read_b64_tr_b16 v[186:187], v6 offset:28672
    buffer_load_dwordx4 v32, s[8:11], s36 offen offset:2048 sc1 lds
    v_mfma_f32_16x16x32_bf16 v[104:107], v[232:235], v[200:203], v[104:107]
    ds_read_b64_tr_b16 v[172:173], v7 offset:16384
    v_mfma_f32_16x16x32_bf16 v[104:107], v[248:251], v[216:219], v[104:107]
    ds_read_b64_tr_b16 v[174:175], v7 offset:20480
    v_mfma_f32_16x16x32_bf16 v[108:111], v[232:235], v[204:207], v[108:111]
    ds_read_b64_tr_b16 v[188:189], v7 offset:24576
    buffer_load_dwordx4 v32, s[8:11], s36 offen offset:3072 sc1 lds
    v_mfma_f32_16x16x32_bf16 v[108:111], v[248:251], v[220:223], v[108:111]
    ds_read_b64_tr_b16 v[190:191], v7 offset:28672
    s_add_u32 s53, s53, 1
    v_readlane_b32 s37, v42, s53
    v_mfma_f32_16x16x32_bf16 v[112:115], v[236:239], v[192:195], v[112:115]
    s_nop 0
    s_lshl_b32 s36, s37, 17
    s_cmp_lt_u32 s37, 32
    v_mfma_f32_16x16x32_bf16 v[112:115], v[252:255], v[208:211], v[112:115]
    s_cselect_b32 s12, s92, s68
    s_cselect_b32 s13, s93, s69
    v_mfma_f32_16x16x32_bf16 v[116:119], v[236:239], v[196:199], v[116:119]
    s_cselect_b32 s14, s54, s55
    s_cselect_b32 s60, 0, 32
    v_mfma_f32_16x16x32_bf16 v[116:119], v[252:255], v[212:215], v[116:119]
    s_sub_u32 s37, s37, s60
    s_lshl_b32 s37, s37, 16
    v_mfma_f32_16x16x32_bf16 v[120:123], v[236:239], v[200:203], v[120:123]
    v_mfma_f32_16x16x32_bf16 v[120:123], v[252:255], v[216:219], v[120:123]
    v_mfma_f32_16x16x32_bf16 v[124:127], v[236:239], v[204:207], v[124:127]
    v_mfma_f32_16x16x32_bf16 v[124:127], v[252:255], v[220:223], v[124:127]
    s_waitcnt vmcnt(26) lgkmcnt(0)
    s_barrier
    v_mfma_f32_16x16x32_bf16 v[64:67], v[160:163], v[128:131], v[64:67]
    ds_read_b64_tr_b16 v[224:225], v4 offset:32768
    s_add_u32 m0, s39, 16384
    v_mfma_f32_16x16x32_bf16 v[64:67], v[176:179], v[144:147], v[64:67]
    ds_read_b64_tr_b16 v[226:227], v4 offset:36864
    buffer_load_dwordx4 v33, s[12:15], s37 offen sc1 lds
    v_mfma_f32_16x16x32_bf16 v[68:71], v[160:163], v[132:135], v[68:71]
    ds_read_b128 v[192:195], v2 offset:32768
    v_mfma_f32_16x16x32_bf16 v[68:71], v[176:179], v[148:151], v[68:71]
    ds_read_b64_tr_b16 v[240:241], v4 offset:40960
    s_add_u32 m0, s39, 17408
    v_mfma_f32_16x16x32_bf16 v[72:75], v[160:163], v[136:139], v[72:75]
    ds_read_b64_tr_b16 v[242:243], v4 offset:45056
    buffer_load_dwordx4 v34, s[12:15], s37 offen sc1 lds
    v_mfma_f32_16x16x32_bf16 v[72:75], v[176:179], v[152:155], v[72:75]
    ds_read_b128 v[208:211], v2 offset:40960
    v_mfma_f32_16x16x32_bf16 v[76:79], v[160:163], v[140:143], v[76:79]
    ds_read_b128 v[196:199], v2 offset:33792
    s_add_u32 m0, s39, 18432
    v_mfma_f32_16x16x32_bf16 v[76:79], v[176:179], v[156:159], v[76:79]
    ds_read_b128 v[212:215], v2 offset:41984
    buffer_load_dwordx4 v35, s[12:15], s37 offen sc1 lds
    v_mfma_f32_16x16x32_bf16 v[80:83], v[164:167], v[128:131], v[80:83]
    ds_read_b128 v[200:203], v2 offset:34816
    v_mfma_f32_16x16x32_bf16 v[80:83], v[180:183], v[144:147], v[80:83]
    ds_read_b128 v[216:219], v2 offset:43008
    s_add_u32 m0, s39, 19456
    v_mfma_f32_16x16x32_bf16 v[84:87], v[164:167], v[132:135], v[84:87]
    ds_read_b128 v[204:207], v2 offset:35840
    buffer_load_dwordx4 v36, s[12:15], s37 offen sc1 lds
    v_mfma_f32_16x16x32_bf16 v[84:87], v[180:183], v[148:151], v[84:87]
    ds_read_b128 v[220:223], v2 offset:44032
    v_mfma_f32_16x16x32_bf16 v[88:91], v[164:167], v[136:139], v[88:91]
    ds_read_b64_tr_b16 v[228:229], v5 offset:32768
    s_add_u32 m0, s38, 16384
    v_mfma_f32_16x16x32_bf16 v[88:91], v[180:183], v[152:155], v[88:91]
    ds_read_b64_tr_b16 v[230:231], v5 offset:36864
    buffer_load_dwordx4 v32, s[8:11], s36 offen offset:0 sc1 lds
    v_mfma_f32_16x16x32_bf16 v[92:95], v[164:167], v[140:143], v[92:95]
    ds_read_b64_tr_b16 v[244:245], v5 offset:40960
    v_mfma_f32_16x16x32_bf16 v[92:95], v[180:183], v[156:159], v[92:95]
    ds_read_b64_tr_b16 v[246:247], v5 offset:45056
    v_mfma_f32_16x16x32_bf16 v[96:99], v[168:171], v[128:131], v[96:99]
    ds_read_b64_tr_b16 v[232:233], v6 offset:32768
    buffer_load_dwordx4 v32, s[8:11], s36 offen offset:1024 sc1 lds
    v_mfma_f32_16x16x32_bf16 v[96:99], v[184:187], v[144:147], v[96:99]
    ds_read_b64_tr_b16 v[234:235], v6 offset:36864
    v_mfma_f32_16x16x32_bf16 v[100:103], v[168:171], v[132:135], v[100:103]
    ds_read_b64_tr_b16 v[248:249], v6 offset:40960
    v_mfma_f32_16x16x32_bf16 v[100:103], v[184:187], v[148:151], v[100:103]
    ds_read_b64_tr_b16 v[250:251], v6 offset:45056
    buffer_load_dwordx4 v32, s[8:11], s36 offen offset:2048 sc1 lds
    v_mfma_f32_16x16x32_bf16 v[104:107], v[168:171], v[136:139], v[104:107]
    ds_read_b64_tr_b16 v[236:237], v7 offset:32768
    v_mfma_f32_16x16x32_bf16 v[104:107], v[184:187], v[152:155], v[104:107]
    ds_read_b64_tr_b16 v[238:239], v7 offset:36864
    v_mfma_f32_16x16x32_bf16 v[108:111], v[168:171], v[140:143], v[108:111]
    ds_read_b64_tr_b16 v[252:253], v7 offset:40960
    buffer_load_dwordx4 v32, s[8:11], s36 offen offset:3072 sc1 lds
    v_mfma_f32_16x16x32_bf16 v[108:111], v[184:187], v[156:159], v[108:111]
    ds_read_b64_tr_b16 v[254:255], v7 offset:45056
    s_add_u32 s53, s53, 1
    v_readlane_b32 s37, v42, s53
    v_mfma_f32_16x16x32_bf16 v[112:115], v[172:175], v[128:131], v[112:115]
    s_nop 0
    s_lshl_b32 s36, s37, 17
    s_cmp_lt_u32 s37, 32
    v_mfma_f32_16x16x32_bf16 v[112:115], v[188:191], v[144:147], v[112:115]
    s_cselect_b32 s12, s92, s68
    s_cselect_b32 s13, s93, s69
    v_mfma_f32_16x16x32_bf16 v[116:119], v[172:175], v[132:135], v[116:119]
    s_cselect_b32 s14, s54, s55
    s_cselect_b32 s60, 0, 32
    v_mfma_f32_16x16x32_bf16 v[116:119], v[188:191], v[148:151], v[116:119]
    s_sub_u32 s37, s37, s60
    s_lshl_b32 s37, s37, 16
    v_mfma_f32_16x16x32_bf16 v[120:123], v[172:175], v[136:139], v[120:123]
    v_mfma_f32_16x16x32_bf16 v[120:123], v[188:191], v[152:155], v[120:123]
    v_mfma_f32_16x16x32_bf16 v[124:127], v[172:175], v[140:143], v[124:127]
    v_mfma_f32_16x16x32_bf16 v[124:127], v[188:191], v[156:159], v[124:127]
    s_branch L2_uin
L2_bnat:
    s_and_b32 s3, s51, 1
    s_mul_i32 s3, s3, -24576
    v_add_u32 v33, s3, v33
    s_add_u32 s3, s3, 8192
    v_add_u32 v34, s3, v34
    s_add_u32 s3, s3, 8192
    v_add_u32 v35, s3, v35
    s_add_u32 s3, s3, 8192
    v_add_u32 v36, s3, v36
    s_add_u32 s3, s3, 8192
    s_branch L2_bretnat
L2_bflg:
    s_mov_b64 exec, 1
    buffer_store_dwordx2 v[38:39], v40, s[96:99], 0 offen sc1
    s_mov_b64 exec, -1
    s_branch L2_bretflg
L2_bask:
    buffer_load_dwordx2 v[30:31], v41, s[96:99], 0 offen sc1
    s_branch L2_bretask
L2_bchk:
    s_mov_b32 s3, 0
L2_bspin:
    v_xor_b32 v31, v30, v31
    v_subrev_u32 v30, s100, v30
    v_lshrrev_b32 v30, 17, v30
    v_cmp_eq_u32 vcc, s101, v31
    v_cmp_eq_u32 s[66:67], 0, v30
    s_nop 1
    s_and_b64 vcc, vcc, s[66:67]
    s_cmp_eq_u64 vcc, exec
    s_cbranch_scc1 L2_bretchk
    s_add_u32 s3, s3, 1
    s_cmp_gt_u32 s3, 0x8000
    s_cbranch_scc1 L2_bretchk
    buffer_load_dwordx2 v[30:31], v41, s[96:99], 0 offen sc1
    s_waitcnt vmcnt(0)
    s_branch L2_bspin
L2_loop:
    s_waitcnt vmcnt(24) lgkmcnt(0)
    s_barrier
    v_mfma_f32_16x16x32_bf16 v[64:67], v[160:163], v[128:131], v[64:67]
    ds_read_b64_tr_b16 v[224:225], v4 offset:16384
    s_add_u32 m0, s39, 0
    v_mfma_f32_16x16x32_bf16 v[64:67], v[176:179], v[144:147], v[64:67]
    ds_read_b64_tr_b16 v[226:227], v4 offset:20480
    buffer_load_dwordx4 v33, s[12:15], s37 offen sc1 lds
    v_mfma_f32_16x16x32_bf16 v[68:71], v[160:163], v[132:135], v[68:71]
    ds_read_b128 v[192:195], v2 offset:16384
    v_mfma_f32_16x16x32_bf16 v[68:71], v[176:179], v[148:151], v[68:71]
    ds_read_b64_tr_b16 v[240:241], v4 offset:24576
    s_add_u32 m0, s39, 1024
    v_mfma_f32_16x16x32_bf16 v[72:75], v[160:163], v[136:139], v[72:75]
    ds_read_b64_tr_b16 v[242:243], v4 offset:28672
    buffer_load_dwordx4 v34, s[12:15], s37 offen sc1 lds
    v_mfma_f32_16x16x32_bf16 v[72:75], v[176:179], v[152:155], v[72:75]
    ds_read_b128 v[208:211], v2 offset:24576
    v_mfma_f32_16x16x32_bf16 v[76:79], v[160:163], v[140:143], v[76:79]
    ds_read_b128 v[196:199], v2 offset:17408
    s_add_u32 m0, s39, 2048
    v_mfma_f32_16x16x32_bf16 v[76:79], v[176:179], v[156:159], v[76:79]
    ds_read_b128 v[212:215], v2 offset:25600
    buffer_load_dwordx4 v35, s[12:15], s37 offen sc1 lds
    v_mfma_f32_16x16x32_bf16 v[80:83], v[164:167], v[128:131], v[80:83]
    ds_read_b128 v[200:203], v2 offset:18432
    v_mfma_f32_16x16x32_bf16 v[80:83], v[180:183], v[144:147], v[80:83]
    ds_read_b128 v[216:219], v2 offset:26624
    s_add_u32 m0, s39, 3072
    v_mfma_f32_16x16x32_bf16 v[84:87], v[164:167], v[132:135], v[84:87]
    ds_read_b128 v[204:207], v2 offset:19456
    buffer_load_dwordx4 v36, s[12:15], s37 offen sc1 lds
    v_mfma_f32_16x16x32_bf16 v[84:87], v[180:183], v[148:151], v[84:87]
    ds_read_b128 v[220:223], v2 offset:27648
    v_mfma_f32_16x16x32_bf16 v[88:91], v[164:167], v[136:139], v[88:91]
    ds_read_b64_tr_b16 v[228:229], v5 offset:16384
    s_add_u32 m0, s38, 0
    v_mfma_f32_16x16x32_bf16 v[88:91], v[180:183], v[152:155], v[88:91]
    ds_read_b64_tr_b16 v[230:231], v5 offset:20480
    buffer_load_dwordx4 v32, s[8:11], s36 offen offset:0 sc1 lds
    v_mfma_f32_16x16x32_bf16 v[92:95], v[164:167], v[140:143], v[92:95]
    ds_read_b64_tr_b16 v[244:245], v5 offset:24576
    v_mfma_f32_16x16x32_bf16 v[92:95], v[180:183], v[156:159], v[92:95]
    ds_read_b64_tr_b16 v[246:247], v5 offset:28672
    v_mfma_f32_16x16x32_bf16 v[96:99], v[168:171], v[128:131], v[96:99]
    ds_read_b64_tr_b16 v[232:233], v6 offset:16384
    buffer_load_dwordx4 v32, s[8:11], s36 offen offset:1024 sc1 lds
    v_mfma_f32_16x16x32_bf16 v[96:99], v[184:187], v[144:147], v[96:99]
    ds_read_b64_tr_b16 v[234:235], v6 offset:20480
    v_mfma_f32_16x16x32_bf16 v[100:103], v[168:171], v[132:135], v[100:103]
    ds_read_b64_tr_b16 v[248:249], v6 offset:24576
    v_mfma_f32_16x16x32_bf16 v[100:103], v[184:187], v[148:151], v[100:103]
    ds_read_b64_tr_b16 v[250:251], v6 offset:28672
    buffer_load_dwordx4 v32, s[8:11], s36 offen offset:2048 sc1 lds
    v_mfma_f32_16x16x32_bf16 v[104:107], v[168:171], v[136:139], v[104:107]
    ds_read_b64_tr_b16 v[236:237], v7 offset:16384
    v_mfma_f32_16x16x32_bf16 v[104:107], v[184:187], v[152:155], v[104:107]
    ds_read_b64_tr_b16 v[238:239], v7 offset:20480
    v_mfma_f32_16x16x32_bf16 v[108:111], v[168:171], v[140:143], v[108:111]
    ds_read_b64_tr_b16 v[252:253], v7 offset:24576
    buffer_load_dwordx4 v32, s[8:11], s36 offen offset:3072 sc1 lds
    v_mfma_f32_16x16x32_bf16 v[108:111], v[184:187], v[156:159], v[108:111]
    ds_read_b64_tr_b16 v[254:255], v7 offset:28672
    s_add_u32 s53, s53, 1
    v_readlane_b32 s37, v42, s53
    v_mfma_f32_16x16x32_bf16 v[112:115], v[172:175], v[128:131], v[112:115]
    s_nop 0
    s_lshl_b32 s36, s37, 17
    s_cmp_lt_u32 s37, 32
    v_mfma_f32_16x16x32_bf16 v[112:115], v[188:191], v[144:147], v[112:115]
    s_cselect_b32 s12, s92, s68
    s_cselect_b32 s13, s93, s69
    v_mfma_f32_16x16x32_bf16 v[116:119], v[172:175], v[132:135], v[116:119]
    s_cselect_b32 s14, s54, s55
    s_cselect_b32 s60, 0, 32
    v_mfma_f32_16x16x32_bf16 v[116:119], v[188:191], v[148:151], v[116:119]
    s_sub_u32 s37, s37, s60
    s_lshl_b32 s37, s37, 16
    v_mfma_f32_16x16x32_bf16 v[120:123], v[172:175], v[136:139], v[120:123]
    v_mfma_f32_16x16x32_bf16 v[120:123], v[188:191], v[152:155], v[120:123]
    v_mfma_f32_16x16x32_bf16 v[124:127], v[172:175], v[140:143], v[124:127]
    v_mfma_f32_16x16x32_bf16 v[124:127], v[188:191], v[156:159], v[124:127]
    s_cmp_eq_u32 s40, s65
    s_cbranch_scc1 L2_bnat
L2_bretnat:
    s_waitcnt vmcnt(24) lgkmcnt(0)
    s_barrier
    v_mfma_f32_16x16x32_bf16 v[64:67], v[224:227], v[192:195], v[64:67]
    ds_read_b64_tr_b16 v[160:161], v4 offset:32768
    s_add_u32 m0, s39, 16384
    v_mfma_f32_16x16x32_bf16 v[64:67], v[240:243], v[208:211], v[64:67]
    ds_read_b64_tr_b16 v[162:163], v4 offset:36864
    buffer_load_dwordx4 v33, s[12:15], s37 offen sc1 lds
    v_mfma_f32_16x16x32_bf16 v[68:71], v[224:227], v[196:199], v[68:71]
    ds_read_b128 v[128:131], v2 offset:32768
    v_mfma_f32_16x16x32_bf16 v[68:71], v[240:243], v[212:215], v[68:71]
    ds_read_b64_tr_b16 v[176:177], v4 offset:40960
    s_add_u32 m0, s39, 17408
    v_mfma_f32_16x16x32_bf16 v[72:75], v[224:227], v[200:203], v[72:75]
    ds_read_b64_tr_b16 v[178:179], v4 offset:45056
    buffer_load_dwordx4 v34, s[12:15], s37 offen sc1 lds
    v_mfma_f32_16x16x32_bf16 v[72:75], v[240:243], v[216:219], v[72:75]
    ds_read_b128 v[144:147], v2 offset:40960
    v_mfma_f32_16x16x32_bf16 v[76:79], v[224:227], v[204:207], v[76:79]
    ds_read_b128 v[132:135], v2 offset:33792
    s_add_u32 m0, s39, 18432
    v_mfma_f32_16x16x32_bf16 v[76:79], v[240:243], v[220:223], v[76:79]
    ds_read_b128 v[148:151], v2 offset:41984
    buffer_load_dwordx4 v35, s[12:15], s37 offen sc1 lds
    v_mfma_f32_16x16x32_bf16 v[80:83], v[228:231], v[192:195], v[80:83]
    ds_read_b128 v[136:139], v2 offset:34816
    v_mfma_f32_16x16x32_bf16 v[80:83], v[244:247], v[208:211], v[80:83]
    ds_read_b128 v[152:155], v2 offset:43008
    s_add_u32 m0, s39, 19456
    v_mfma_f32_16x16x32_bf16 v[84:87], v[228:231], v[196:199], v[84:87]
    ds_read_b128 v[140:143], v2 offset:35840
    buffer_load_dwordx4 v36, s[12:15], s37 offen sc1 lds
    v_mfma_f32_16x16x32_bf16 v[84:87], v[244:247], v[212:215], v[84:87]
    ds_read_b128 v[156:159], v2 offset:44032
    v_mfma_f32_16x16x32_bf16 v[88:91], v[228:231], v[200:203], v[88:91]
    ds_read_b64_tr_b16 v[164:165], v5 offset:32768
    s_add_u32 m0, s38, 16384
    v_mfma_f32_16x16x32_bf16 v[88:91], v[244:247], v[216:219], v[88:91]
    ds_read_b64_tr_b16 v[166:167], v5 offset:36864
    buffer_load_dwordx4 v32, s[8:11], s36 offen offset:0 sc1 lds
    v_mfma_f32_16x16x32_bf16 v[92:95], v[228:231], v[204:207], v[92:95]
    ds_read_b64_tr_b16 v[180:181], v5 offset:40960
    v_mfma_f32_16x16x32_bf16 v[92:95], v[244:247], v[220:223], v[92:95]
    ds_read_b64_tr_b16 v[182:183], v5 offset:45056
    v_mfma_f32_16x16x32_bf16 v[96:99], v[232:235], v[192:195], v[96:99]
    ds_read_b64_tr_b16 v[168:169], v6 offset:32768
    buffer_load_dwordx4 v32, s[8:11], s36 offen offset:1024 sc1 lds
    v_mfma_f32_16x16x32_bf16 v[96:99], v[248:251], v[208:211], v[96:99]
    ds_read_b64_tr_b16 v[170:171], v6 offset:36864
    v_mfma_f32_16x16x32_bf16 v[100:103], v[232:235], v[196:199], v[100:103]
    ds_read_b64_tr_b16 v[184:185], v6 offset:40960
    v_mfma_f32_16x16x32_bf16 v[100:103], v[248:251], v[212:215], v[100:103]
    ds_read_b64_tr_b16 v[186:187], v6 offset:45056
    buffer_load_dwordx4 v32, s[8:11], s36 offen offset:2048 sc1 lds
    v_mfma_f32_16x16x32_bf16 v[104:107], v[232:235], v[200:203], v[104:107]
    ds_read_b64_tr_b16 v[172:173], v7 offset:32768
    v_mfma_f32_16x16x32_bf16 v[104:107], v[248:251], v[216:219], v[104:107]
    ds_read_b64_tr_b16 v[174:175], v7 offset:36864
    v_mfma_f32_16x16x32_bf16 v[108:111], v[232:235], v[204:207], v[108:111]
    ds_read_b64_tr_b16 v[188:189], v7 offset:40960
    buffer_load_dwordx4 v32, s[8:11], s36 offen offset:3072 sc1 lds
    v_mfma_f32_16x16x32_bf16 v[108:111], v[248:251], v[220:223], v[108:111]
    ds_read_b64_tr_b16 v[190:191], v7 offset:45056
    s_add_u32 s53, s53, 1
    v_readlane_b32 s37, v42, s53
    v_mfma_f32_16x16x32_bf16 v[112:115], v[236:239], v[192:195], v[112:115]
    s_nop 0
    s_lshl_b32 s36, s37, 17
    s_cmp_lt_u32 s37, 32
    v_mfma_f32_16x16x32_bf16 v[112:115], v[252:255], v[208:211], v[112:115]
    s_cselect_b32 s12, s92, s68
    s_cselect_b32 s13, s93, s69
    v_mfma_f32_16x16x32_bf16 v[116:119], v[236:239], v[196:199], v[116:119]
    s_cselect_b32 s14, s54, s55
    s_cselect_b32 s60, 0, 32
    v_mfma_f32_16x16x32_bf16 v[116:119], v[252:255], v[212:215], v[116:119]
    s_sub_u32 s37, s37, s60
    s_lshl_b32 s37, s37, 16
    v_mfma_f32_16x16x32_bf16 v[120:123], v[236:239], v[200:203], v[120:123]
    v_mfma_f32_16x16x32_bf16 v[120:123], v[252:255], v[216:219], v[120:123]
    v_mfma_f32_16x16x32_bf16 v[124:127], v[236:239], v[204:207], v[124:127]
    v_mfma_f32_16x16x32_bf16 v[124:127], v[252:255], v[220:223], v[124:127]
    s_cmp_eq_u32 s40, 10
    s_cbranch_scc1 L2_bask
L2_bretask:
    s_waitcnt vmcnt(24) lgkmcnt(0)
    s_barrier
    v_mfma_f32_16x16x32_bf16 v[64:67], v[160:163], v[128:131], v[64:67]
    ds_read_b64_tr_b16 v[224:225], v4 offset:49152
    s_add_u32 m0, s39, 32768
    v_mfma_f32_16x16x32_bf16 v[64:67], v[176:179], v[144:147], v[64:67]
    ds_read_b64_tr_b16 v[226:227], v4 offset:53248
    buffer_load_dwordx4 v33, s[12:15], s37 offen sc1 lds
    v_mfma_f32_16x16x32_bf16 v[68:71], v[160:163], v[132:135], v[68:71]
    ds_read_b128 v[192:195], v2 offset:49152
    v_mfma_f32_16x16x32_bf16 v[68:71], v[176:179], v[148:151], v[68:71]
    ds_read_b64_tr_b16 v[240:241], v4 offset:57344
    s_add_u32 m0, s39, 33792
    v_mfma_f32_16x16x32_bf16 v[72:75], v[160:163], v[136:139], v[72:75]
    ds_read_b64_tr_b16 v[242:243], v4 offset:61440
    buffer_load_dwordx4 v34, s[12:15], s37 offen sc1 lds
    v_mfma_f32_16x16x32_bf16 v[72:75], v[176:179], v[152:155], v[72:75]
    ds_read_b128 v[208:211], v2 offset:57344
    v_mfma_f32_16x16x32_bf16 v[76:79], v[160:163], v[140:143], v[76:79]
    ds_read_b128 v[196:199], v2 offset:50176
    s_add_u32 m0, s39, 34816
    v_mfma_f32_16x16x32_bf16 v[76:79], v[176:179], v[156:159], v[76:79]
    ds_read_b128 v[212:215], v2 offset:58368
    buffer_load_dwordx4 v35, s[12:15], s37 offen sc1 lds
    v_mfma_f32_16x16x32_bf16 v[80:83], v[164:167], v[128:131], v[80:83]
    ds_read_b128 v[200:203], v2 offset:51200
    v_mfma_f32_16x16x32_bf16 v[80:83], v[180:183], v[144:147], v[80:83]
    ds_read_b128 v[216:219], v2 offset:59392
    s_add_u32 m0, s39, 35840
    v_mfma_f32_16x16x32_bf16 v[84:87], v[164:167], v[132:135], v[84:87]
    ds_read_b128 v[204:207], v2 offset:52224
    buffer_load_dwordx4 v36, s[12:15], s37 offen sc1 lds
    v_mfma_f32_16x16x32_bf16 v[84:87], v[180:183], v[148:151], v[84:87]
    ds_read_b128 v[220:223], v2 offset:60416
    v_mfma_f32_16x16x32_bf16 v[88:91], v[164:167], v[136:139], v[88:91]
    ds_read_b64_tr_b16 v[228:229], v5 offset:49152
    s_add_u32 m0, s38, 32768
    v_mfma_f32_16x16x32_bf16 v[88:91], v[180:183], v[152:155], v[88:91]
    ds_read_b64_tr_b16 v[230:231], v5 offset:53248
    buffer_load_dwordx4 v32, s[8:11], s36 offen offset:0 sc1 lds
    v_mfma_f32_16x16x32_bf16 v[92:95], v[164:167], v[140:143], v[92:95]
    ds_read_b64_tr_b16 v[244:245], v5 offset:57344
    v_mfma_f32_16x16x32_bf16 v[92:95], v[180:183], v[156:159], v[92:95]
    ds_read_b64_tr_b16 v[246:247], v5 offset:61440
    v_mfma_f32_16x16x32_bf16 v[96:99], v[168:171], v[128:131], v[96:99]
    ds_read_b64_tr_b16 v[232:233], v6 offset:49152
    buffer_load_dwordx4 v32, s[8:11], s36 offen offset:1024 sc1 lds
    v_mfma_f32_16x16x32_bf16 v[96:99], v[184:187], v[144:147], v[96:99]
    ds_read_b64_tr_b16 v[234:235], v6 offset:53248
    v_mfma_f32_16x16x32_bf16 v[100:103], v[168:171], v[132:135], v[100:103]
    ds_read_b64_tr_b16 v[248:249], v6 offset:57344
    v_mfma_f32_16x16x32_bf16 v[100:103], v[184:187], v[148:151], v[100:103]
    ds_read_b64_tr_b16 v[250:251], v6 offset:61440
    buffer_load_dwordx4 v32, s[8:11], s36 offen offset:2048 sc1 lds
    v_mfma_f32_16x16x32_bf16 v[104:107], v[168:171], v[136:139], v[104:107]
    ds_read_b64_tr_b16 v[236:237], v7 offset:49152
    v_mfma_f32_16x16x32_bf16 v[104:107], v[184:187], v[152:155], v[104:107]
    ds_read_b64_tr_b16 v[238:239], v7 offset:53248
    v_mfma_f32_16x16x32_bf16 v[108:111], v[168:171], v[140:143], v[108:111]
    ds_read_b64_tr_b16 v[252:253], v7 offset:57344
    buffer_load_dwordx4 v32, s[8:11], s36 offen offset:3072 sc1 lds
    v_mfma_f32_16x16x32_bf16 v[108:111], v[184:187], v[156:159], v[108:111]
    ds_read_b64_tr_b16 v[254:255], v7 offset:61440
    s_add_u32 s53, s53, 1
    v_readlane_b32 s37, v42, s53
    v_mfma_f32_16x16x32_bf16 v[112:115], v[172:175], v[128:131], v[112:115]
    s_nop 0
    s_lshl_b32 s36, s37, 17
    s_cmp_lt_u32 s37, 32
    v_mfma_f32_16x16x32_bf16 v[112:115], v[188:191], v[144:147], v[112:115]
    s_cselect_b32 s12, s92, s68
    s_cselect_b32 s13, s93, s69
    v_mfma_f32_16x16x32_bf16 v[116:119], v[172:175], v[132:135], v[116:119]
    s_cselect_b32 s14, s54, s55
    s_cselect_b32 s60, 0, 32
    v_mfma_f32_16x16x32_bf16 v[116:119], v[188:191], v[148:151], v[116:119]
    s_sub_u32 s37, s37, s60
    s_lshl_b32 s37, s37, 16
    v_mfma_f32_16x16x32_bf16 v[120:123], v[172:175], v[136:139], v[120:123]
    v_mfma_f32_16x16x32_bf16 v[120:123], v[188:191], v[152:155], v[120:123]
    v_mfma_f32_16x16x32_bf16 v[124:127], v[172:175], v[140:143], v[124:127]
    v_mfma_f32_16x16x32_bf16 v[124:127], v[188:191], v[156:159], v[124:127]
    s_waitcnt vmcnt(24) lgkmcnt(0)
    s_barrier
    v_mfma_f32_16x16x32_bf16 v[64:67], v[224:227], v[192:195], v[64:67]
    ds_read_b64_tr_b16 v[160:161], v8 offset:0
    s_add_u32 m0, s39, 49152
    v_mfma_f32_16x16x32_bf16 v[64:67], v[240:243], v[208:211], v[64:67]
    ds_read_b64_tr_b16 v[162:163], v8 offset:4096
    buffer_load_dwordx4 v33, s[12:15], s37 offen sc1 lds
    v_mfma_f32_16x16x32_bf16 v[68:71], v[224:227], v[196:199], v[68:71]
    ds_read_b128 v[128:131], v3 offset:0
    v_mfma_f32_16x16x32_bf16 v[68:71], v[240:243], v[212:215], v[68:71]
    ds_read_b64_tr_b16 v[176:177], v8 offset:8192
    s_add_u32 m0, s39, 50176
    v_mfma_f32_16x16x32_bf16 v[72:75], v[224:227], v[200:203], v[72:75]
    ds_read_b64_tr_b16 v[178:179], v8 offset:12288
    buffer_load_dwordx4 v34, s[12:15], s37 offen sc1 lds
    v_mfma_f32_16x16x32_bf16 v[72:75], v[240:243], v[216:219], v[72:75]
    ds_read_b128 v[144:147], v3 offset:8192
    v_mfma_f32_16x16x32_bf16 v[76:79], v[224:227], v[204:207], v[76:79]
    ds_read_b128 v[132:135], v3 offset:1024
    s_add_u32 m0, s39, 51200
    v_mfma_f32_16x16x32_bf16 v[76:79], v[240:243], v[220:223], v[76:79]
    ds_read_b128 v[148:151], v3 offset:9216
    buffer_load_dwordx4 v35, s[12:15], s37 offen sc1 lds
    v_mfma_f32_16x16x32_bf16 v[80:83], v[228:231], v[192:195], v[80:83]
    ds_read_b128 v[136:139], v3 offset:2048
    v_mfma_f32_16x16x32_bf16 v[80:83], v[244:247], v[208:211], v[80:83]
    ds_read_b128 v[152:155], v3 offset:10240
    s_add_u32 m0, s39, 52224
    v_mfma_f32_16x16x32_bf16 v[84:87], v[228:231], v[196:199], v[84:87]
    ds_read_b128 v[140:143], v3 offset:3072
    buffer_load_dwordx4 v36, s[12:15], s37 offen sc1 lds
    v_mfma_f32_16x16x32_bf16 v[84:87], v[244:247], v[212:215], v[84:87]
    ds_read_b128 v[156:159], v3 offset:11264
    v_mfma_f32_16x16x32_bf16 v[88:91], v[228:231], v[200:203], v[88:91]
    ds_read_b64_tr_b16 v[164:165], v9 offset:0
    s_add_u32 m0, s38, 49152
    v_mfma_f32_16x16x32_bf16 v[88:91], v[244:247], v[216:219], v[88:91]
    ds_read_b64_tr_b16 v[166:167], v9 offset:4096
    buffer_load_dwordx4 v32, s[8:11], s36 offen offset:0 sc1 lds
    v_mfma_f32_16x16x32_bf16 v[92:95], v[228:231], v[204:207], v[92:95]
    ds_read_b64_tr_b16 v[180:181], v9 offset:8192
    v_mfma_f32_16x16x32_bf16 v[92:95], v[244:247], v[220:223], v[92:95]
    ds_read_b64_tr_b16 v[182:183], v9 offset:12288
    v_mfma_f32_16x16x32_bf16 v[96:99], v[232:235], v[192:195], v[96:99]
    ds_read_b64_tr_b16 v[168:169], v10 offset:0
    buffer_load_dwordx4 v32, s[8:11], s36 offen offset:1024 sc1 lds
    v_mfma_f32_16x16x32_bf16 v[96:99], v[248:251], v[208:211], v[96:99]
    ds_read_b64_tr_b16 v[170:171], v10 offset:4096
    v_mfma_f32_16x16x32_bf16 v[100:103], v[232:235], v[196:199], v[100:103]
    ds_read_b64_tr_b16 v[184:185], v10 offset:8192
    v_mfma_f32_16x16x32_bf16 v[100:103], v[248:251], v[212:215], v[100:103]
    ds_read_b64_tr_b16 v[186:187], v10 offset:12288
    buffer_load_dwordx4 v32, s[8:11], s36 offen offset:2048 sc1 lds
    v_mfma_f32_16x16x32_bf16 v[104:107], v[232:235], v[200:203], v[104:107]
    ds_read_b64_tr_b16 v[172:173], v11 offset:0
    v_mfma_f32_16x16x32_bf16 v[104:107], v[248:251], v[216:219], v[104:107]
    ds_read_b64_tr_b16 v[174:175], v11 offset:4096
    v_mfma_f32_16x16x32_bf16 v[108:111], v[232:235], v[204:207], v[108:111]
    ds_read_b64_tr_b16 v[188:189], v11 offset:8192
    buffer_load_dwordx4 v32, s[8:11], s36 offen offset:3072 sc1 lds
    v_mfma_f32_16x16x32_bf16 v[108:111], v[248:251], v[220:223], v[108:111]
    ds_read_b64_tr_b16 v[190:191], v11 offset:12288
    s_add_u32 s53, s53, 1
    v_readlane_b32 s37, v42, s53
    v_mfma_f32_16x16x32_bf16 v[112:115], v[236:239], v[192:195], v[112:115]
    s_nop 0
    s_lshl_b32 s36, s37, 17
    s_cmp_lt_u32 s37, 32
    v_mfma_f32_16x16x32_bf16 v[112:115], v[252:255], v[208:211], v[112:115]
    s_cselect_b32 s12, s92, s68
    s_cselect_b32 s13, s93, s69
    v_mfma_f32_16x16x32_bf16 v[116:119], v[236:239], v[196:199], v[116:119]
    s_cselect_b32 s14, s54, s55
    s_cselect_b32 s60, 0, 32
    v_mfma_f32_16x16x32_bf16 v[116:119], v[252:255], v[212:215], v[116:119]
    s_sub_u32 s37, s37, s60
    s_lshl_b32 s37, s37, 16
    v_mfma_f32_16x16x32_bf16 v[120:123], v[236:239], v[200:203], v[120:123]
    v_mfma_f32_16x16x32_bf16 v[120:123], v[252:255], v[216:219], v[120:123]
    v_mfma_f32_16x16x32_bf16 v[124:127], v[236:239], v[204:207], v[124:127]
    v_mfma_f32_16x16x32_bf16 v[124:127], v[252:255], v[220:223], v[124:127]
    s_waitcnt vmcnt(24) lgkmcnt(0)
    s_barrier
    v_mfma_f32_16x16x32_bf16 v[64:67], v[160:163], v[128:131], v[64:67]
    ds_read_b64_tr_b16 v[224:225], v4 offset:0
    s_add_u32 m0, s39, 65536
    v_mfma_f32_16x16x32_bf16 v[64:67], v[176:179], v[144:147], v[64:67]
    ds_read_b64_tr_b16 v[226:227], v4 offset:4096
    buffer_load_dwordx4 v33, s[12:15], s37 offen sc1 lds
    v_mfma_f32_16x16x32_bf16 v[68:71], v[160:163], v[132:135], v[68:71]
    ds_read_b128 v[192:195], v2 offset:0
    v_mfma_f32_16x16x32_bf16 v[68:71], v[176:179], v[148:151], v[68:71]
    ds_read_b64_tr_b16 v[240:241], v4 offset:8192
    s_add_u32 m0, s39, 66560
    v_mfma_f32_16x16x32_bf16 v[72:75], v[160:163], v[136:139], v[72:75]
    ds_read_b64_tr_b16 v[242:243], v4 offset:12288
    buffer_load_dwordx4 v34, s[12:15], s37 offen sc1 lds
    v_mfma_f32_16x16x32_bf16 v[72:75], v[176:179], v[152:155], v[72:75]
    ds_read_b128 v[208:211], v2 offset:8192
    v_mfma_f32_16x16x32_bf16 v[76:79], v[160:163], v[140:143], v[76:79]
    ds_read_b128 v[196:199], v2 offset:1024
    s_add_u32 m0, s39, 67584
    v_mfma_f32_16x16x32_bf16 v[76:79], v[176:179], v[156:159], v[76:79]
    ds_read_b128 v[212:215], v2 offset:9216
    buffer_load_dwordx4 v35, s[12:15], s37 offen sc1 lds
    v_mfma_f32_16x16x32_bf16 v[80:83], v[164:167], v[128:131], v[80:83]
    ds_read_b128 v[200:203], v2 offset:2048
    v_mfma_f32_16x16x32_bf16 v[80:83], v[180:183], v[144:147], v[80:83]
    ds_read_b128 v[216:219], v2 offset:10240
    s_add_u32 m0, s39, 68608
    v_mfma_f32_16x16x32_bf16 v[84:87], v[164:167], v[132:135], v[84:87]
    ds_read_b128 v[204:207], v2 offset:3072
    buffer_load_dwordx4 v36, s[12:15], s37 offen sc1 lds
    v_mfma_f32_16x16x32_bf16 v[84:87], v[180:183], v[148:151], v[84:87]
    ds_read_b128 v[220:223], v2 offset:11264
    v_mfma_f32_16x16x32_bf16 v[88:91], v[164:167], v[136:139], v[88:91]
    ds_read_b64_tr_b16 v[228:229], v5 offset:0
    s_add_u32 m0, s38, 65536
    v_mfma_f32_16x16x32_bf16 v[88:91], v[180:183], v[152:155], v[88:91]
    ds_read_b64_tr_b16 v[230:231], v5 offset:4096
    buffer_load_dwordx4 v32, s[8:11], s36 offen offset:0 sc1 lds
    v_mfma_f32_16x16x32_bf16 v[92:95], v[164:167], v[140:143], v[92:95]
    ds_read_b64_tr_b16 v[244:245], v5 offset:8192
    v_mfma_f32_16x16x32_bf16 v[92:95], v[180:183], v[156:159], v[92:95]
    ds_read_b64_tr_b16 v[246:247], v5 offset:12288
    v_mfma_f32_16x16x32_bf16 v[96:99], v[168:171], v[128:131], v[96:99]
    ds_read_b64_tr_b16 v[232:233], v6 offset:0
    buffer_load_dwordx4 v32, s[8:11], s36 offen offset:1024 sc1 lds
    v_mfma_f32_16x16x32_bf16 v[96:99], v[184:187], v[144:147], v[96:99]
    ds_read_b64_tr_b16 v[234:235], v6 offset:4096
    v_mfma_f32_16x16x32_bf16 v[100:103], v[168:171], v[132:135], v[100:103]
    ds_read_b64_tr_b16 v[248:249], v6 offset:8192
    v_mfma_f32_16x16x32_bf16 v[100:103], v[184:187], v[148:151], v[100:103]
    ds_read_b64_tr_b16 v[250:251], v6 offset:12288
    buffer_load_dwordx4 v32, s[8:11], s36 offen offset:2048 sc1 lds
    v_mfma_f32_16x16x32_bf16 v[104:107], v[168:171], v[136:139], v[104:107]
    ds_read_b64_tr_b16 v[236:237], v7 offset:0
    v_mfma_f32_16x16x32_bf16 v[104:107], v[184:187], v[152:155], v[104:107]
    ds_read_b64_tr_b16 v[238:239], v7 offset:4096
    v_mfma_f32_16x16x32_bf16 v[108:111], v[168:171], v[140:143], v[108:111]
    ds_read_b64_tr_b16 v[252:253], v7 offset:8192
    buffer_load_dwordx4 v32, s[8:11], s36 offen offset:3072 sc1 lds
    v_mfma_f32_16x16x32_bf16 v[108:111], v[184:187], v[156:159], v[108:111]
    ds_read_b64_tr_b16 v[254:255], v7 offset:12288
    s_add_u32 s53, s53, 1
    v_readlane_b32 s37, v42, s53
    v_mfma_f32_16x16x32_bf16 v[112:115], v[172:175], v[128:131], v[112:115]
    s_nop 0
    s_lshl_b32 s36, s37, 17
    s_cmp_lt_u32 s37, 32
    v_mfma_f32_16x16x32_bf16 v[112:115], v[188:191], v[144:147], v[112:115]
    s_cselect_b32 s12, s92, s68
    s_cselect_b32 s13, s93, s69
    v_mfma_f32_16x16x32_bf16 v[116:119], v[172:175], v[132:135], v[116:119]
    s_cselect_b32 s14, s54, s55
    s_cselect_b32 s60, 0, 32
    v_mfma_f32_16x16x32_bf16 v[116:119], v[188:191], v[148:151], v[116:119]
    s_sub_u32 s37, s37, s60
    s_lshl_b32 s37, s37, 16
    v_mfma_f32_16x16x32_bf16 v[120:123], v[172:175], v[136:139], v[120:123]
    v_mfma_f32_16x16x32_bf16 v[120:123], v[188:191], v[152:155], v[120:123]
    v_mfma_f32_16x16x32_bf16 v[124:127], v[172:175], v[140:143], v[124:127]
    v_mfma_f32_16x16x32_bf16 v[124:127], v[188:191], v[156:159], v[124:127]
    s_waitcnt vmcnt(24) lgkmcnt(0)
    s_barrier
    v_mfma_f32_16x16x32_bf16 v[64:67], v[224:227], v[192:195], v[64:67]
    ds_read_b64_tr_b16 v[160:161], v4 offset:16384
    s_add_u32 m0, s39, 0
    v_mfma_f32_16x16x32_bf16 v[64:67], v[240:243], v[208:211], v[64:67]
    ds_read_b64_tr_b16 v[162:163], v4 offset:20480
    buffer_load_dwordx4 v33, s[12:15], s37 offen sc1 lds
    v_mfma_f32_16x16x32_bf16 v[68:71], v[224:227], v[196:199], v[68:71]
    ds_read_b128 v[128:131], v2 offset:16384
    v_mfma_f32_16x16x32_bf16 v[68:71], v[240:243], v[212:215], v[68:71]
    ds_read_b64_tr_b16 v[176:177], v4 offset:24576
    s_add_u32 m0, s39, 1024
    v_mfma_f32_16x16x32_bf16 v[72:75], v[224:227], v[200:203], v[72:75]
    ds_read_b64_tr_b16 v[178:179], v4 offset:28672
    buffer_load_dwordx4 v34, s[12:15], s37 offen sc1 lds
    v_mfma_f32_16x16x32_bf16 v[72:75], v[240:243], v[216:219], v[72:75]
    ds_read_b128 v[144:147], v2 offset:24576
    v_mfma_f32_16x16x32_bf16 v[76:79], v[224:227], v[204:207], v[76:79]
    ds_read_b128 v[132:135], v2 offset:17408
    s_add_u32 m0, s39, 2048
    v_mfma_f32_16x16x32_bf16 v[76:79], v[240:243], v[220:223], v[76:79]
    ds_read_b128 v[148:151], v2 offset:25600
    buffer_load_dwordx4 v35, s[12:15], s37 offen sc1 lds
    v_mfma_f32_16x16x32_bf16 v[80:83], v[228:231], v[192:195], v[80:83]
    ds_read_b128 v[136:139], v2 offset:18432
    v_mfma_f32_16x16x32_bf16 v[80:83], v[244:247], v[208:211], v[80:83]
    ds_read_b128 v[152:155], v2 offset:26624
    s_add_u32 m0, s39, 3072
    v_mfma_f32_16x16x32_bf16 v[84:87], v[228:231], v[196:199], v[84:87]
    ds_read_b128 v[140:143], v2 offset:19456
    buffer_load_dwordx4 v36, s[12:15], s37 offen sc1 lds
    v_mfma_f32_16x16x32_bf16 v[84:87], v[244:247], v[212:215], v[84:87]
    ds_read_b128 v[156:159], v2 offset:27648
    v_mfma_f32_16x16x32_bf16 v[88:91], v[228:231], v[200:203], v[88:91]
    ds_read_b64_tr_b16 v[164:165], v5 offset:16384
    s_add_u32 m0, s38, 0
    v_mfma_f32_16x16x32_bf16 v[88:91], v[244:247], v[216:219], v[88:91]
    ds_read_b64_tr_b16 v[166:167], v5 offset:20480
    buffer_load_dwordx4 v32, s[8:11], s36 offen offset:0 sc1 lds
    v_mfma_f32_16x16x32_bf16 v[92:95], v[228:231], v[204:207], v[92:95]
    ds_read_b64_tr_b16 v[180:181], v5 offset:24576
    v_mfma_f32_16x16x32_bf16 v[92:95], v[244:247], v[220:223], v[92:95]
    ds_read_b64_tr_b16 v[182:183], v5 offset:28672
    v_mfma_f32_16x16x32_bf16 v[96:99], v[232:235], v[192:195], v[96:99]
    ds_read_b64_tr_b16 v[168:169], v6 offset:16384
    buffer_load_dwordx4 v32, s[8:11], s36 offen offset:1024 sc1 lds
    v_mfma_f32_16x16x32_bf16 v[96:99], v[248:251], v[208:211], v[96:99]
    ds_read_b64_tr_b16 v[170:171], v6 offset:20480
    v_mfma_f32_16x16x32_bf16 v[100:103], v[232:235], v[196:199], v[100:103]
    ds_read_b64_tr_b16 v[184:185], v6 offset:24576
    v_mfma_f32_16x16x32_bf16 v[100:103], v[248:251], v[212:215], v[100:103]
    ds_read_b64_tr_b16 v[186:187], v6 offset:28672
    buffer_load_dwordx4 v32, s[8:11], s36 offen offset:2048 sc1 lds
    v_mfma_f32_16x16x32_bf16 v[104:107], v[232:235], v[200:203], v[104:107]
    ds_read_b64_tr_b16 v[172:173], v7 offset:16384
    v_mfma_f32_16x16x32_bf16 v[104:107], v[248:251], v[216:219], v[104:107]
    ds_read_b64_tr_b16 v[174:175], v7 offset:20480
    v_mfma_f32_16x16x32_bf16 v[108:111], v[232:235], v[204:207], v[108:111]
    ds_read_b64_tr_b16 v[188:189], v7 offset:24576
    buffer_load_dwordx4 v32, s[8:11], s36 offen offset:3072 sc1 lds
    v_mfma_f32_16x16x32_bf16 v[108:111], v[248:251], v[220:223], v[108:111]
    ds_read_b64_tr_b16 v[190:191], v7 offset:28672
    s_add_u32 s53, s53, 1
    v_readlane_b32 s37, v42, s53
    v_mfma_f32_16x16x32_bf16 v[112:115], v[236:239], v[192:195], v[112:115]
    s_nop 0
    s_lshl_b32 s36, s37, 17
    s_cmp_lt_u32 s37, 32
    v_mfma_f32_16x16x32_bf16 v[112:115], v[252:255], v[208:211], v[112:115]
    s_cselect_b32 s12, s92, s68
    s_cselect_b32 s13, s93, s69
    v_mfma_f32_16x16x32_bf16 v[116:119], v[236:239], v[196:199], v[116:119]
    s_cselect_b32 s14, s54, s55
    s_cselect_b32 s60, 0, 32
    v_mfma_f32_16x16x32_bf16 v[116:119], v[252:255], v[212:215], v[116:119]
    s_sub_u32 s37, s37, s60
    s_lshl_b32 s37, s37, 16
    v_mfma_f32_16x16x32_bf16 v[120:123], v[236:239], v[200:203], v[120:123]
    v_mfma_f32_16x16x32_bf16 v[120:123], v[252:255], v[216:219], v[120:123]
    v_mfma_f32_16x16x32_bf16 v[124:127], v[236:239], v[204:207], v[124:127]
    v_mfma_f32_16x16x32_bf16 v[124:127], v[252:255], v[220:223], v[124:127]
    s_waitcnt vmcnt(24) lgkmcnt(0)
    s_barrier
    v_mfma_f32_16x16x32_bf16 v[64:67], v[160:163], v[128:131], v[64:67]
    ds_read_b64_tr_b16 v[224:225], v4 offset:32768
    s_add_u32 m0, s39, 16384
    v_mfma_f32_16x16x32_bf16 v[64:67], v[176:179], v[144:147], v[64:67]
    ds_read_b64_tr_b16 v[226:227], v4 offset:36864
    buffer_load_dwordx4 v33, s[12:15], s37 offen sc1 lds
    v_mfma_f32_16x16x32_bf16 v[68:71], v[160:163], v[132:135], v[68:71]
    ds_read_b128 v[192:195], v2 offset:32768
    v_mfma_f32_16x16x32_bf16 v[68:71], v[176:179], v[148:151], v[68:71]
    ds_read_b64_tr_b16 v[240:241], v4 offset:40960
    s_add_u32 m0, s39, 17408
    v_mfma_f32_16x16x32_bf16 v[72:75], v[160:163], v[136:139], v[72:75]
    ds_read_b64_tr_b16 v[242:243], v4 offset:45056
    buffer_load_dwordx4 v34, s[12:15], s37 offen sc1 lds
    v_mfma_f32_16x16x32_bf16 v[72:75], v[176:179], v[152:155], v[72:75]
    ds_read_b128 v[208:211], v2 offset:40960
    v_mfma_f32_16x16x32_bf16 v[76:79], v[160:163], v[140:143], v[76:79]
    ds_read_b128 v[196:199], v2 offset:33792
    s_add_u32 m0, s39, 18432
    v_mfma_f32_16x16x32_bf16 v[76:79], v[176:179], v[156:159], v[76:79]
    ds_read_b128 v[212:215], v2 offset:41984
    buffer_load_dwordx4 v35, s[12:15], s37 offen sc1 lds
    v_mfma_f32_16x16x32_bf16 v[80:83], v[164:167], v[128:131], v[80:83]
    ds_read_b128 v[200:203], v2 offset:34816
    v_mfma_f32_16x16x32_bf16 v[80:83], v[180:183], v[144:147], v[80:83]
    ds_read_b128 v[216:219], v2 offset:43008
    s_add_u32 m0, s39, 19456
    v_mfma_f32_16x16x32_bf16 v[84:87], v[164:167], v[132:135], v[84:87]
    ds_read_b128 v[204:207], v2 offset:35840
    buffer_load_dwordx4 v36, s[12:15], s37 offen sc1 lds
    v_mfma_f32_16x16x32_bf16 v[84:87], v[180:183], v[148:151], v[84:87]
    ds_read_b128 v[220:223], v2 offset:44032
    v_mfma_f32_16x16x32_bf16 v[88:91], v[164:167], v[136:139], v[88:91]
    ds_read_b64_tr_b16 v[228:229], v5 offset:32768
    s_add_u32 m0, s38, 16384
    v_mfma_f32_16x16x32_bf16 v[88:91], v[180:183], v[152:155], v[88:91]
    ds_read_b64_tr_b16 v[230:231], v5 offset:36864
    buffer_load_dwordx4 v32, s[8:11], s36 offen offset:0 sc1 lds
    v_mfma_f32_16x16x32_bf16 v[92:95], v[164:167], v[140:143], v[92:95]
    ds_read_b64_tr_b16 v[244:245], v5 offset:40960
    v_mfma_f32_16x16x32_bf16 v[92:95], v[180:183], v[156:159], v[92:95]
    ds_read_b64_tr_b16 v[246:247], v5 offset:45056
    v_mfma_f32_16x16x32_bf16 v[96:99], v[168:171], v[128:131], v[96:99]
    ds_read_b64_tr_b16 v[232:233], v6 offset:32768
    buffer_load_dwordx4 v32, s[8:11], s36 offen offset:1024 sc1 lds
    v_mfma_f32_16x16x32_bf16 v[96:99], v[184:187], v[144:147], v[96:99]
    ds_read_b64_tr_b16 v[234:235], v6 offset:36864
    v_mfma_f32_16x16x32_bf16 v[100:103], v[168:171], v[132:135], v[100:103]
    ds_read_b64_tr_b16 v[248:249], v6 offset:40960
    v_mfma_f32_16x16x32_bf16 v[100:103], v[184:187], v[148:151], v[100:103]
    ds_read_b64_tr_b16 v[250:251], v6 offset:45056
    buffer_load_dwordx4 v32, s[8:11], s36 offen offset:2048 sc1 lds
    v_mfma_f32_16x16x32_bf16 v[104:107], v[168:171], v[136:139], v[104:107]
    ds_read_b64_tr_b16 v[236:237], v7 offset:32768
    v_mfma_f32_16x16x32_bf16 v[104:107], v[184:187], v[152:155], v[104:107]
    ds_read_b64_tr_b16 v[238:239], v7 offset:36864
    v_mfma_f32_16x16x32_bf16 v[108:111], v[168:171], v[140:143], v[108:111]
    ds_read_b64_tr_b16 v[252:253], v7 offset:40960
    buffer_load_dwordx4 v32, s[8:11], s36 offen offset:3072 sc1 lds
    v_mfma_f32_16x16x32_bf16 v[108:111], v[184:187], v[156:159], v[108:111]
    ds_read_b64_tr_b16 v[254:255], v7 offset:45056
    s_add_u32 s53, s53, 1
    v_readlane_b32 s37, v42, s53
    v_mfma_f32_16x16x32_bf16 v[112:115], v[172:175], v[128:131], v[112:115]
    s_nop 0
    s_lshl_b32 s36, s37, 17
    s_cmp_lt_u32 s37, 32
    v_mfma_f32_16x16x32_bf16 v[112:115], v[188:191], v[144:147], v[112:115]
    s_cselect_b32 s12, s92, s68
    s_cselect_b32 s13, s93, s69
    v_mfma_f32_16x16x32_bf16 v[116:119], v[172:175], v[132:135], v[116:119]
    s_cselect_b32 s14, s54, s55
    s_cselect_b32 s60, 0, 32
    v_mfma_f32_16x16x32_bf16 v[116:119], v[188:191], v[148:151], v[116:119]
    s_sub_u32 s37, s37, s60
    s_lshl_b32 s37, s37, 16
    v_mfma_f32_16x16x32_bf16 v[120:123], v[172:175], v[136:139], v[120:123]
    v_mfma_f32_16x16x32_bf16 v[120:123], v[188:191], v[152:155], v[120:123]
    v_mfma_f32_16x16x32_bf16 v[124:127], v[172:175], v[140:143], v[124:127]
    v_mfma_f32_16x16x32_bf16 v[124:127], v[188:191], v[156:159], v[124:127]
    s_cmp_eq_u32 s40, 10
    s_cbranch_scc1 L2_bchk
L2_bretchk:
L2_uin:
    s_waitcnt vmcnt(24) lgkmcnt(0)
    s_barrier
    v_mfma_f32_16x16x32_bf16 v[64:67], v[224:227], v[192:195], v[64:67]
    ds_read_b64_tr_b16 v[160:161], v4 offset:49152
    s_add_u32 m0, s39, 32768
    v_mfma_f32_16x16x32_bf16 v[64:67], v[240:243], v[208:211], v[64:67]
    ds_read_b64_tr_b16 v[162:163], v4 offset:53248
    buffer_load_dwordx4 v33, s[12:15], s37 offen sc1 lds
    v_mfma_f32_16x16x32_bf16 v[68:71], v[224:227], v[196:199], v[68:71]
    ds_read_b128 v[128:131], v2 offset:49152
    v_mfma_f32_16x16x32_bf16 v[68:71], v[240:243], v[212:215], v[68:71]
    ds_read_b64_tr_b16 v[176:177], v4 offset:57344
    s_add_u32 m0, s39, 33792
    v_mfma_f32_16x16x32_bf16 v[72:75], v[224:227], v[200:203], v[72:75]
    ds_read_b64_tr_b16 v[178:179], v4 offset:61440
    buffer_load_dwordx4 v34, s[12:15], s37 offen sc1 lds
    v_mfma_f32_16x16x32_bf16 v[72:75], v[240:243], v[216:219], v[72:75]
    ds_read_b128 v[144:147], v2 offset:57344
    v_mfma_f32_16x16x32_bf16 v[76:79], v[224:227], v[204:207], v[76:79]
    ds_read_b128 v[132:135], v2 offset:50176
    s_add_u32 m0, s39, 34816
    v_mfma_f32_16x16x32_bf16 v[76:79], v[240:243], v[220:223], v[76:79]
    ds_read_b128 v[148:151], v2 offset:58368
    buffer_load_dwordx4 v35, s[12:15], s37 offen sc1 lds
    v_mfma_f32_16x16x32_bf16 v[80:83], v[228:231], v[192:195], v[80:83]
    ds_read_b128 v[136:139], v2 offset:51200
    v_mfma_f32_16x16x32_bf16 v[80:83], v[244:247], v[208:211], v[80:83]
    ds_read_b128 v[152:155], v2 offset:59392
    s_add_u32 m0, s39, 35840
    v_mfma_f32_16x16x32_bf16 v[84:87], v[228:231], v[196:199], v[84:87]
    ds_read_b128 v[140:143], v2 offset:52224
    buffer_load_dwordx4 v36, s[12:15], s37 offen sc1 lds
    v_mfma_f32_16x16x32_bf16 v[84:87], v[244:247], v[212:215], v[84:87]
    ds_read_b128 v[156:159], v2 offset:60416
    v_mfma_f32_16x16x32_bf16 v[88:91], v[228:231], v[200:203], v[88:91]
    ds_read_b64_tr_b16 v[164:165], v5 offset:49152
    s_add_u32 m0, s38, 32768
    v_mfma_f32_16x16x32_bf16 v[88:91], v[244:247], v[216:219], v[88:91]
    ds_read_b64_tr_b16 v[166:167], v5 offset:53248
    buffer_load_dwordx4 v32, s[8:11], s36 offen offset:0 sc1 lds
    v_mfma_f32_16x16x32_bf16 v[92:95], v[228:231], v[204:207], v[92:95]
    ds_read_b64_tr_b16 v[180:181], v5 offset:57344
    v_mfma_f32_16x16x32_bf16 v[92:95], v[244:247], v[220:223], v[92:95]
    ds_read_b64_tr_b16 v[182:183], v5 offset:61440
    v_mfma_f32_16x16x32_bf16 v[96:99], v[232:235], v[192:195], v[96:99]
    ds_read_b64_tr_b16 v[168:169], v6 offset:49152
    buffer_load_dwordx4 v32, s[8:11], s36 offen offset:1024 sc1 lds
    v_mfma_f32_16x16x32_bf16 v[96:99], v[248:251], v[208:211], v[96:99]
    ds_read_b64_tr_b16 v[170:171], v6 offset:53248
    v_mfma_f32_16x16x32_bf16 v[100:103], v[232:235], v[196:199], v[100:103]
    ds_read_b64_tr_b16 v[184:185], v6 offset:57344
    v_mfma_f32_16x16x32_bf16 v[100:103], v[248:251], v[212:215], v[100:103]
    ds_read_b64_tr_b16 v[186:187], v6 offset:61440
    buffer_load_dwordx4 v32, s[8:11], s36 offen offset:2048 sc1 lds
    v_mfma_f32_16x16x32_bf16 v[104:107], v[232:235], v[200:203], v[104:107]
    ds_read_b64_tr_b16 v[172:173], v7 offset:49152
    v_mfma_f32_16x16x32_bf16 v[104:107], v[248:251], v[216:219], v[104:107]
    ds_read_b64_tr_b16 v[174:175], v7 offset:53248
    v_mfma_f32_16x16x32_bf16 v[108:111], v[232:235], v[204:207], v[108:111]
    ds_read_b64_tr_b16 v[188:189], v7 offset:57344
    buffer_load_dwordx4 v32, s[8:11], s36 offen offset:3072 sc1 lds
    v_mfma_f32_16x16x32_bf16 v[108:111], v[248:251], v[220:223], v[108:111]
    ds_read_b64_tr_b16 v[190:191], v7 offset:61440
    s_add_u32 s53, s53, 1
    v_readlane_b32 s37, v42, s53
    v_mfma_f32_16x16x32_bf16 v[112:115], v[236:239], v[192:195], v[112:115]
    s_nop 0
    s_lshl_b32 s36, s37, 17
    s_cmp_lt_u32 s37, 32
    v_mfma_f32_16x16x32_bf16 v[112:115], v[252:255], v[208:211], v[112:115]
    s_cselect_b32 s12, s92, s68
    s_cselect_b32 s13, s93, s69
    v_mfma_f32_16x16x32_bf16 v[116:119], v[236:239], v[196:199], v[116:119]
    s_cselect_b32 s14, s54, s55
    s_cselect_b32 s60, 0, 32
    v_mfma_f32_16x16x32_bf16 v[116:119], v[252:255], v[212:215], v[116:119]
    s_sub_u32 s37, s37, s60
    s_lshl_b32 s37, s37, 16
    v_mfma_f32_16x16x32_bf16 v[120:123], v[236:239], v[200:203], v[120:123]
    v_mfma_f32_16x16x32_bf16 v[120:123], v[252:255], v[216:219], v[120:123]
    v_mfma_f32_16x16x32_bf16 v[124:127], v[236:239], v[204:207], v[124:127]
    v_mfma_f32_16x16x32_bf16 v[124:127], v[252:255], v[220:223], v[124:127]
    s_cmp_eq_u32 s40, 0
    s_cbranch_scc1 L2_bflg
L2_bretflg:
    s_waitcnt vmcnt(24) lgkmcnt(0)
    s_barrier
    v_mfma_f32_16x16x32_bf16 v[64:67], v[160:163], v[128:131], v[64:67]
    ds_read_b64_tr_b16 v[224:225], v8 offset:0
    s_add_u32 m0, s39, 49152
    v_mfma_f32_16x16x32_bf16 v[64:67], v[176:179], v[144:147], v[64:67]
    ds_read_b64_tr_b16 v[226:227], v8 offset:4096
    buffer_load_dwordx4 v33, s[12:15], s37 offen sc1 lds
    v_mfma_f32_16x16x32_bf16 v[68:71], v[160:163], v[132:135], v[68:71]
    ds_read_b128 v[192:195], v3 offset:0
    v_mfma_f32_16x16x32_bf16 v[68:71], v[176:179], v[148:151], v[68:71]
    ds_read_b64_tr_b16 v[240:241], v8 offset:8192
    s_add_u32 m0, s39, 50176
    v_mfma_f32_16x16x32_bf16 v[72:75], v[160:163], v[136:139], v[72:75]
    ds_read_b64_tr_b16 v[242:243], v8 offset:12288
    buffer_load_dwordx4 v34, s[12:15], s37 offen sc1 lds
    v_mfma_f32_16x16x32_bf16 v[72:75], v[176:179], v[152:155], v[72:75]
    ds_read_b128 v[208:211], v3 offset:8192
    v_mfma_f32_16x16x32_bf16 v[76:79], v[160:163], v[140:143], v[76:79]
    ds_read_b128 v[196:199], v3 offset:1024
    s_add_u32 m0, s39, 51200
    v_mfma_f32_16x16x32_bf16 v[76:79], v[176:179], v[156:159], v[76:79]
    ds_read_b128 v[212:215], v3 offset:9216
    buffer_load_dwordx4 v35, s[12:15], s37 offen sc1 lds
    v_mfma_f32_16x16x32_bf16 v[80:83], v[164:167], v[128:131], v[80:83]
    ds_read_b128 v[200:203], v3 offset:2048
    v_mfma_f32_16x16x32_bf16 v[80:83], v[180:183], v[144:147], v[80:83]
    ds_read_b128 v[216:219], v3 offset:10240
    s_add_u32 m0, s39, 52224
    v_mfma_f32_16x16x32_bf16 v[84:87], v[164:167], v[132:135], v[84:87]
    ds_read_b128 v[204:207], v3 offset:3072
    buffer_load_dwordx4 v36, s[12:15], s37 offen sc1 lds
    v_mfma_f32_16x16x32_bf16 v[84:87], v[180:183], v[148:151], v[84:87]
    ds_read_b128 v[220:223], v3 offset:11264
    v_mfma_f32_16x16x32_bf16 v[88:91], v[164:167], v[136:139], v[88:91]
    ds_read_b64_tr_b16 v[228:229], v9 offset:0
    s_add_u32 m0, s38, 49152
    v_mfma_f32_16x16x32_bf16 v[88:91], v[180:183], v[152:155], v[88:91]
    ds_read_b64_tr_b16 v[230:231], v9 offset:4096
    buffer_load_dwordx4 v32, s[8:11], s36 offen offset:0 sc1 lds
    v_mfma_f32_16x16x32_bf16 v[92:95], v[164:167], v[140:143], v[92:95]
    ds_read_b64_tr_b16 v[244:245], v9 offset:8192
    v_mfma_f32_16x16x32_bf16 v[92:95], v[180:183], v[156:159], v[92:95]
    ds_read_b64_tr_b16 v[246:247], v9 offset:12288
    v_mfma_f32_16x16x32_bf16 v[96:99], v[168:171], v[128:131], v[96:99]
    ds_read_b64_tr_b16 v[232:233], v10 offset:0
    buffer_load_dwordx4 v32, s[8:11], s36 offen offset:1024 sc1 lds
    v_mfma_f32_16x16x32_bf16 v[96:99], v[184:187], v[144:147], v[96:99]
    ds_read_b64_tr_b16 v[234:235], v10 offset:4096
    v_mfma_f32_16x16x32_bf16 v[100:103], v[168:171], v[132:135], v[100:103]
    ds_read_b64_tr_b16 v[248:249], v10 offset:8192
    v_mfma_f32_16x16x32_bf16 v[100:103], v[184:187], v[148:151], v[100:103]
    ds_read_b64_tr_b16 v[250:251], v10 offset:12288
    buffer_load_dwordx4 v32, s[8:11], s36 offen offset:2048 sc1 lds
    v_mfma_f32_16x16x32_bf16 v[104:107], v[168:171], v[136:139], v[104:107]
    ds_read_b64_tr_b16 v[236:237], v11 offset:0
    v_mfma_f32_16x16x32_bf16 v[104:107], v[184:187], v[152:155], v[104:107]
    ds_read_b64_tr_b16 v[238:239], v11 offset:4096
    v_mfma_f32_16x16x32_bf16 v[108:111], v[168:171], v[140:143], v[108:111]
    ds_read_b64_tr_b16 v[252:253], v11 offset:8192
    buffer_load_dwordx4 v32, s[8:11], s36 offen offset:3072 sc1 lds
    v_mfma_f32_16x16x32_bf16 v[108:111], v[184:187], v[156:159], v[108:111]
    ds_read_b64_tr_b16 v[254:255], v11 offset:12288
    s_add_u32 s53, s53, 1
    v_readlane_b32 s37, v42, s53
    v_mfma_f32_16x16x32_bf16 v[112:115], v[172:175], v[128:131], v[112:115]
    s_nop 0
    s_lshl_b32 s36, s37, 17
    s_cmp_lt_u32 s37, 32
    v_mfma_f32_16x16x32_bf16 v[112:115], v[188:191], v[144:147], v[112:115]
    s_cselect_b32 s12, s92, s68
    s_cselect_b32 s13, s93, s69
    v_mfma_f32_16x16x32_bf16 v[116:119], v[172:175], v[132:135], v[116:119]
    s_cselect_b32 s14, s54, s55
    s_cselect_b32 s60, 0, 32
    v_mfma_f32_16x16x32_bf16 v[116:119], v[188:191], v[148:151], v[116:119]
    s_sub_u32 s37, s37, s60
    s_lshl_b32 s37, s37, 16
    v_mfma_f32_16x16x32_bf16 v[120:123], v[172:175], v[136:139], v[120:123]
    v_mfma_f32_16x16x32_bf16 v[120:123], v[188:191], v[152:155], v[120:123]
    v_mfma_f32_16x16x32_bf16 v[124:127], v[172:175], v[140:143], v[124:127]
    v_mfma_f32_16x16x32_bf16 v[124:127], v[188:191], v[156:159], v[124:127]
    s_add_u32 s40, s40, 10
    s_cmp_ge_u32 s40, 29
    s_cbranch_scc1 L2_half
    s_waitcnt vmcnt(24) lgkmcnt(0)
    s_barrier
    v_mfma_f32_16x16x32_bf16 v[64:67], v[224:227], v[192:195], v[64:67]
    ds_read_b64_tr_b16 v[160:161], v4 offset:0
    s_add_u32 m0, s39, 65536
    v_mfma_f32_16x16x32_bf16 v[64:67], v[240:243], v[208:211], v[64:67]
    ds_read_b64_tr_b16 v[162:163], v4 offset:4096
    buffer_load_dwordx4 v33, s[12:15], s37 offen sc1 lds
    v_mfma_f32_16x16x32_bf16 v[68:71], v[224:227], v[196:199], v[68:71]
    ds_read_b128 v[128:131], v2 offset:0
    v_mfma_f32_16x16x32_bf16 v[68:71], v[240:243], v[212:215], v[68:71]
    ds_read_b64_tr_b16 v[176:177], v4 offset:8192
    s_add_u32 m0, s39, 66560
    v_mfma_f32_16x16x32_bf16 v[72:75], v[224:227], v[200:203], v[72:75]
    ds_read_b64_tr_b16 v[178:179], v4 offset:12288
    buffer_load_dwordx4 v34, s[12:15], s37 offen sc1 lds
    v_mfma_f32_16x16x32_bf16 v[72:75], v[240:243], v[216:219], v[72:75]
    ds_read_b128 v[144:147], v2 offset:8192
    v_mfma_f32_16x16x32_bf16 v[76:79], v[224:227], v[204:207], v[76:79]
    ds_read_b128 v[132:135], v2 offset:1024
    s_add_u32 m0, s39, 67584
    v_mfma_f32_16x16x32_bf16 v[76:79], v[240:243], v[220:223], v[76:79]
    ds_read_b128 v[148:151], v2 offset:9216
    buffer_load_dwordx4 v35, s[12:15], s37 offen sc1 lds
    v_mfma_f32_16x16x32_bf16 v[80:83], v[228:231], v[192:195], v[80:83]
    ds_read_b128 v[136:139], v2 offset:2048
    v_mfma_f32_16x16x32_bf16 v[80:83], v[244:247], v[208:211], v[80:83]
    ds_read_b128 v[152:155], v2 offset:10240
    s_add_u32 m0, s39, 68608
    v_mfma_f32_16x16x32_bf16 v[84:87], v[228:231], v[196:199], v[84:87]
    ds_read_b128 v[140:143], v2 offset:3072
    buffer_load_dwordx4 v36, s[12:15], s37 offen sc1 lds
    v_mfma_f32_16x16x32_bf16 v[84:87], v[244:247], v[212:215], v[84:87]
    ds_read_b128 v[156:159], v2 offset:11264
    v_mfma_f32_16x16x32_bf16 v[88:91], v[228:231], v[200:203], v[88:91]
    ds_read_b64_tr_b16 v[164:165], v5 offset:0
    s_add_u32 m0, s38, 65536
    v_mfma_f32_16x16x32_bf16 v[88:91], v[244:247], v[216:219], v[88:91]
    ds_read_b64_tr_b16 v[166:167], v5 offset:4096
    buffer_load_dwordx4 v32, s[8:11], s36 offen offset:0 sc1 lds
    v_mfma_f32_16x16x32_bf16 v[92:95], v[228:231], v[204:207], v[92:95]
    ds_read_b64_tr_b16 v[180:181], v5 offset:8192
    v_mfma_f32_16x16x32_bf16 v[92:95], v[244:247], v[220:223], v[92:95]
    ds_read_b64_tr_b16 v[182:183], v5 offset:12288
    v_mfma_f32_16x16x32_bf16 v[96:99], v[232:235], v[192:195], v[96:99]
    ds_read_b64_tr_b16 v[168:169], v6 offset:0
    buffer_load_dwordx4 v32, s[8:11], s36 offen offset:1024 sc1 lds
    v_mfma_f32_16x16x32_bf16 v[96:99], v[248:251], v[208:211], v[96:99]
    ds_read_b64_tr_b16 v[170:171], v6 offset:4096
    v_mfma_f32_16x16x32_bf16 v[100:103], v[232:235], v[196:199], v[100:103]
    ds_read_b64_tr_b16 v[184:185], v6 offset:8192
    v_mfma_f32_16x16x32_bf16 v[100:103], v[248:251], v[212:215], v[100:103]
    ds_read_b64_tr_b16 v[186:187], v6 offset:12288
    buffer_load_dwordx4 v32, s[8:11], s36 offen offset:2048 sc1 lds
    v_mfma_f32_16x16x32_bf16 v[104:107], v[232:235], v[200:203], v[104:107]
    ds_read_b64_tr_b16 v[172:173], v7 offset:0
    v_mfma_f32_16x16x32_bf16 v[104:107], v[248:251], v[216:219], v[104:107]
    ds_read_b64_tr_b16 v[174:175], v7 offset:4096
    v_mfma_f32_16x16x32_bf16 v[108:111], v[232:235], v[204:207], v[108:111]
    ds_read_b64_tr_b16 v[188:189], v7 offset:8192
    buffer_load_dwordx4 v32, s[8:11], s36 offen offset:3072 sc1 lds
    v_mfma_f32_16x16x32_bf16 v[108:111], v[248:251], v[220:223], v[108:111]
    ds_read_b64_tr_b16 v[190:191], v7 offset:12288
    s_add_u32 s53, s53, 1
    v_readlane_b32 s37, v42, s53
    v_mfma_f32_16x16x32_bf16 v[112:115], v[236:239], v[192:195], v[112:115]
    s_nop 0
    s_lshl_b32 s36, s37, 17
    s_cmp_lt_u32 s37, 32
    v_mfma_f32_16x16x32_bf16 v[112:115], v[252:255], v[208:211], v[112:115]
    s_cselect_b32 s12, s92, s68
    s_cselect_b32 s13, s93, s69
    v_mfma_f32_16x16x32_bf16 v[116:119], v[236:239], v[196:199], v[116:119]
    s_cselect_b32 s14, s54, s55
    s_cselect_b32 s60, 0, 32
    v_mfma_f32_16x16x32_bf16 v[116:119], v[252:255], v[212:215], v[116:119]
    s_sub_u32 s37, s37, s60
    s_lshl_b32 s37, s37, 16
    v_mfma_f32_16x16x32_bf16 v[120:123], v[236:239], v[200:203], v[120:123]
    v_mfma_f32_16x16x32_bf16 v[120:123], v[252:255], v[216:219], v[120:123]
    v_mfma_f32_16x16x32_bf16 v[124:127], v[236:239], v[204:207], v[124:127]
    v_mfma_f32_16x16x32_bf16 v[124:127], v[252:255], v[220:223], v[124:127]
    s_branch L2_loop
L2_half:
    s_waitcnt vmcnt(24) lgkmcnt(0)
    s_barrier
    v_mfma_f32_16x16x32_bf16 v[64:67], v[224:227], v[192:195], v[64:67]
    ds_read_b64_tr_b16 v[160:161], v4 offset:0
    s_add_u32 m0, s44, 65536
    v_mfma_f32_16x16x32_bf16 v[64:67], v[240:243], v[208:211], v[64:67]
    ds_read_b64_tr_b16 v[162:163], v4 offset:4096
    buffer_load_dwordx4 v18, s[12:15], s37 offen sc1 lds
    v_mfma_f32_16x16x32_bf16 v[68:71], v[224:227], v[196:199], v[68:71]
    ds_read_b128 v[128:131], v2 offset:0
    v_mfma_f32_16x16x32_bf16 v[68:71], v[240:243], v[212:215], v[68:71]
    ds_read_b64_tr_b16 v[176:177], v4 offset:8192
    s_add_u32 m0, s44, 66560
    v_mfma_f32_16x16x32_bf16 v[72:75], v[224:227], v[200:203], v[72:75]
    ds_read_b64_tr_b16 v[178:179], v4 offset:12288
    v_mfma_f32_16x16x32_bf16 v[72:75], v[240:243], v[216:219], v[72:75]
    ds_read_b128 v[144:147], v2 offset:8192
    buffer_load_dwordx4 v19, s[12:15], s37 offen sc1 lds
    v_mfma_f32_16x16x32_bf16 v[76:79], v[224:227], v[204:207], v[76:79]
    ds_read_b128 v[132:135], v2 offset:1024
    s_add_u32 m0, s38, 65536
    v_mfma_f32_16x16x32_bf16 v[76:79], v[240:243], v[220:223], v[76:79]
    ds_read_b128 v[148:151], v2 offset:9216
    v_mfma_f32_16x16x32_bf16 v[80:83], v[228:231], v[192:195], v[80:83]
    ds_read_b128 v[136:139], v2 offset:2048
    buffer_load_dwordx4 v32, s[8:11], s36 offen offset:0 sc1 lds
    v_mfma_f32_16x16x32_bf16 v[80:83], v[244:247], v[208:211], v[80:83]
    ds_read_b128 v[152:155], v2 offset:10240
    v_mfma_f32_16x16x32_bf16 v[84:87], v[228:231], v[196:199], v[84:87]
    ds_read_b128 v[140:143], v2 offset:3072
    buffer_load_dwordx4 v32, s[8:11], s36 offen offset:1024 sc1 lds
    v_mfma_f32_16x16x32_bf16 v[84:87], v[244:247], v[212:215], v[84:87]
    ds_read_b128 v[156:159], v2 offset:11264
    buffer_load_dwordx4 v32, s[8:11], s36 offen offset:2048 sc1 lds
    v_mfma_f32_16x16x32_bf16 v[88:91], v[228:231], v[200:203], v[88:91]
    ds_read_b64_tr_b16 v[164:165], v5 offset:0
    v_mfma_f32_16x16x32_bf16 v[88:91], v[244:247], v[216:219], v[88:91]
    ds_read_b64_tr_b16 v[166:167], v5 offset:4096
    buffer_load_dwordx4 v32, s[8:11], s36 offen offset:3072 sc1 lds
    v_mfma_f32_16x16x32_bf16 v[92:95], v[228:231], v[204:207], v[92:95]
    ds_read_b64_tr_b16 v[180:181], v5 offset:8192
    v_mfma_f32_16x16x32_bf16 v[92:95], v[244:247], v[220:223], v[92:95]
    ds_read_b64_tr_b16 v[182:183], v5 offset:12288
    s_add_u32 s53, s53, 1
    v_mfma_f32_16x16x32_bf16 v[96:99], v[232:235], v[192:195], v[96:99]
    ds_read_b64_tr_b16 v[168:169], v6 offset:0
    v_readlane_b32 s37, v42, s53
    v_mfma_f32_16x16x32_bf16 v[96:99], v[248:251], v[208:211], v[96:99]
    ds_read_b64_tr_b16 v[170:171], v6 offset:4096
    v_mfma_f32_16x16x32_bf16 v[100:103], v[232:235], v[196:199], v[100:103]
    ds_read_b64_tr_b16 v[184:185], v6 offset:8192
    s_lshl_b32 s36, s37, 17
    v_mfma_f32_16x16x32_bf16 v[100:103], v[248:251], v[212:215], v[100:103]
    ds_read_b64_tr_b16 v[186:187], v6 offset:12288
    v_mfma_f32_16x16x32_bf16 v[104:107], v[232:235], v[200:203], v[104:107]
    ds_read_b64_tr_b16 v[172:173], v7 offset:0
    s_cmp_lt_u32 s37, 32
    v_mfma_f32_16x16x32_bf16 v[104:107], v[248:251], v[216:219], v[104:107]
    ds_read_b64_tr_b16 v[174:175], v7 offset:4096
    s_cselect_b32 s12, s92, s68
    v_mfma_f32_16x16x32_bf16 v[108:111], v[232:235], v[204:207], v[108:111]
    ds_read_b64_tr_b16 v[188:189], v7 offset:8192
    v_mfma_f32_16x16x32_bf16 v[108:111], v[248:251], v[220:223], v[108:111]
    ds_read_b64_tr_b16 v[190:191], v7 offset:12288
    s_cselect_b32 s13, s93, s69
    v_mfma_f32_16x16x32_bf16 v[112:115], v[236:239], v[192:195], v[112:115]
    v_mfma_f32_16x16x32_bf16 v[112:115], v[252:255], v[208:211], v[112:115]
    s_cselect_b32 s14, s54, s55
    v_mfma_f32_16x16x32_bf16 v[116:119], v[236:239], v[196:199], v[116:119]
    s_cselect_b32 s60, 0, 32
    v_mfma_f32_16x16x32_bf16 v[116:119], v[252:255], v[212:215], v[116:119]
    v_mfma_f32_16x16x32_bf16 v[120:123], v[236:239], v[200:203], v[120:123]
    s_sub_u32 s37, s37, s60
    v_mfma_f32_16x16x32_bf16 v[120:123], v[252:255], v[216:219], v[120:123]
    v_mfma_f32_16x16x32_bf16 v[124:127], v[236:239], v[204:207], v[124:127]
    s_lshl_b32 s37, s37, 16
    v_mfma_f32_16x16x32_bf16 v[124:127], v[252:255], v[220:223], v[124:127]
    s_waitcnt vmcnt(22) lgkmcnt(0)
    s_barrier
    v_mfma_f32_16x16x32_bf16 v[64:67], v[160:163], v[128:131], v[64:67]
    ds_read_b64_tr_b16 v[224:225], v4 offset:16384
    s_add_u32 m0, s44, 0
    v_mfma_f32_16x16x32_bf16 v[64:67], v[176:179], v[144:147], v[64:67]
    ds_read_b64_tr_b16 v[226:227], v4 offset:20480
    buffer_load_dwordx4 v18, s[12:15], s37 offen sc1 lds
    v_mfma_f32_16x16x32_bf16 v[68:71], v[160:163], v[132:135], v[68:71]
    ds_read_b128 v[192:195], v2 offset:16384
    v_mfma_f32_16x16x32_bf16 v[68:71], v[176:179], v[148:151], v[68:71]
    ds_read_b64_tr_b16 v[240:241], v4 offset:24576
    s_add_u32 m0, s44, 1024
    v_mfma_f32_16x16x32_bf16 v[72:75], v[160:163], v[136:139], v[72:75]
    ds_read_b64_tr_b16 v[242:243], v4 offset:28672
    v_mfma_f32_16x16x32_bf16 v[72:75], v[176:179], v[152:155], v[72:75]
    ds_read_b128 v[208:211], v2 offset:24576
    buffer_load_dwordx4 v19, s[12:15], s37 offen sc1 lds
    v_mfma_f32_16x16x32_bf16 v[76:79], v[160:163], v[140:143], v[76:79]
    ds_read_b128 v[196:199], v2 offset:17408
    s_add_u32 m0, s38, 0
    v_mfma_f32_16x16x32_bf16 v[76:79], v[176:179], v[156:159], v[76:79]
    ds_read_b128 v[212:215], v2 offset:25600
    v_mfma_f32_16x16x32_bf16 v[80:83], v[164:167], v[128:131], v[80:83]
    ds_read_b128 v[200:203], v2 offset:18432
    buffer_load_dwordx4 v32, s[8:11], s36 offen offset:0 sc1 lds
    v_mfma_f32_16x16x32_bf16 v[80:83], v[180:183], v[144:147], v[80:83]
    ds_read_b128 v[216:219], v2 offset:26624
    v_mfma_f32_16x16x32_bf16 v[84:87], v[164:167], v[132:135], v[84:87]
    ds_read_b128 v[204:207], v2 offset:19456
    buffer_load_dwordx4 v32, s[8:11], s36 offen offset:1024 sc1 lds
    v_mfma_f32_16x16x32_bf16 v[84:87], v[180:183], v[148:151], v[84:87]
    ds_read_b128 v[220:223], v2 offset:27648
    buffer_load_dwordx4 v32, s[8:11], s36 offen offset:2048 sc1 lds
    v_mfma_f32_16x16x32_bf16 v[88:91], v[164:167], v[136:139], v[88:91]
    ds_read_b64_tr_b16 v[228:229], v5 offset:16384
    v_mfma_f32_16x16x32_bf16 v[88:91], v[180:183], v[152:155], v[88:91]
    ds_read_b64_tr_b16 v[230:231], v5 offset:20480
    buffer_load_dwordx4 v32, s[8:11], s36 offen offset:3072 sc1 lds
    v_mfma_f32_16x16x32_bf16 v[92:95], v[164:167], v[140:143], v[92:95]
    ds_read_b64_tr_b16 v[244:245], v5 offset:24576
    v_mfma_f32_16x16x32_bf16 v[92:95], v[180:183], v[156:159], v[92:95]
    ds_read_b64_tr_b16 v[246:247], v5 offset:28672
    s_add_u32 s53, s53, 1
    v_mfma_f32_16x16x32_bf16 v[96:99], v[168:171], v[128:131], v[96:99]
    ds_read_b64_tr_b16 v[232:233], v6 offset:16384
    v_readlane_b32 s37, v42, s53
    v_mfma_f32_16x16x32_bf16 v[96:99], v[184:187], v[144:147], v[96:99]
    ds_read_b64_tr_b16 v[234:235], v6 offset:20480
    v_mfma_f32_16x16x32_bf16 v[100:103], v[168:171], v[132:135], v[100:103]
    ds_read_b64_tr_b16 v[248:249], v6 offset:24576
    s_lshl_b32 s36, s37, 17
    v_mfma_f32_16x16x32_bf16 v[100:103], v[184:187], v[148:151], v[100:103]
    ds_read_b64_tr_b16 v[250:251], v6 offset:28672
    v_mfma_f32_16x16x32_bf16 v[104:107], v[168:171], v[136:139], v[104:107]
    ds_read_b64_tr_b16 v[236:237], v7 offset:16384
    s_cmp_lt_u32 s37, 32
    v_mfma_f32_16x16x32_bf16 v[104:107], v[184:187], v[152:155], v[104:107]
    ds_read_b64_tr_b16 v[238:239], v7 offset:20480
    s_cselect_b32 s12, s92, s68
    v_mfma_f32_16x16x32_bf16 v[108:111], v[168:171], v[140:143], v[108:111]
    ds_read_b64_tr_b16 v[252:253], v7 offset:24576
    v_mfma_f32_16x16x32_bf16 v[108:111], v[184:187], v[156:159], v[108:111]
    ds_read_b64_tr_b16 v[254:255], v7 offset:28672
    s_cselect_b32 s13, s93, s69
    v_mfma_f32_16x16x32_bf16 v[112:115], v[172:175], v[128:131], v[112:115]
    v_mfma_f32_16x16x32_bf16 v[112:115], v[188:191], v[144:147], v[112:115]
    s_cselect_b32 s14, s54, s55
    v_mfma_f32_16x16x32_bf16 v[116:119], v[172:175], v[132:135], v[116:119]
    s_cselect_b32 s60, 0, 32
    v_mfma_f32_16x16x32_bf16 v[116:119], v[188:191], v[148:151], v[116:119]
    v_mfma_f32_16x16x32_bf16 v[120:123], v[172:175], v[136:139], v[120:123]
    s_sub_u32 s37, s37, s60
    v_mfma_f32_16x16x32_bf16 v[120:123], v[188:191], v[152:155], v[120:123]
    v_mfma_f32_16x16x32_bf16 v[124:127], v[172:175], v[140:143], v[124:127]
    s_lshl_b32 s37, s37, 16
    v_mfma_f32_16x16x32_bf16 v[124:127], v[188:191], v[156:159], v[124:127]
    s_waitcnt vmcnt(20) lgkmcnt(0)
    s_barrier
    v_mfma_f32_16x16x32_bf16 v[64:67], v[224:227], v[192:195], v[64:67]
    ds_read_b64_tr_b16 v[160:161], v4 offset:32768
    s_add_u32 m0, s44, 16384
    v_mfma_f32_16x16x32_bf16 v[64:67], v[240:243], v[208:211], v[64:67]
    ds_read_b64_tr_b16 v[162:163], v4 offset:36864
    buffer_load_dwordx4 v18, s[12:15], s37 offen sc1 lds
    v_mfma_f32_16x16x32_bf16 v[68:71], v[224:227], v[196:199], v[68:71]
    ds_read_b128 v[128:131], v2 offset:32768
    v_mfma_f32_16x16x32_bf16 v[68:71], v[240:243], v[212:215], v[68:71]
    ds_read_b64_tr_b16 v[176:177], v4 offset:40960
    s_add_u32 m0, s44, 17408
    v_mfma_f32_16x16x32_bf16 v[72:75], v[224:227], v[200:203], v[72:75]
    ds_read_b64_tr_b16 v[178:179], v4 offset:45056
    v_mfma_f32_16x16x32_bf16 v[72:75], v[240:243], v[216:219], v[72:75]
    ds_read_b128 v[144:147], v2 offset:40960
    buffer_load_dwordx4 v19, s[12:15], s37 offen sc1 lds
    v_mfma_f32_16x16x32_bf16 v[76:79], v[224:227], v[204:207], v[76:79]
    ds_read_b128 v[132:135], v2 offset:33792
    s_add_u32 m0, s38, 16384
    v_mfma_f32_16x16x32_bf16 v[76:79], v[240:243], v[220:223], v[76:79]
    ds_read_b128 v[148:151], v2 offset:41984
    v_mfma_f32_16x16x32_bf16 v[80:83], v[228:231], v[192:195], v[80:83]
    ds_read_b128 v[136:139], v2 offset:34816
    buffer_load_dwordx4 v32, s[8:11], s36 offen offset:0 sc1 lds
    v_mfma_f32_16x16x32_bf16 v[80:83], v[244:247], v[208:211], v[80:83]
    ds_read_b128 v[152:155], v2 offset:43008
    v_mfma_f32_16x16x32_bf16 v[84:87], v[228:231], v[196:199], v[84:87]
    ds_read_b128 v[140:143], v2 offset:35840
    buffer_load_dwordx4 v32, s[8:11], s36 offen offset:1024 sc1 lds
    v_mfma_f32_16x16x32_bf16 v[84:87], v[244:247], v[212:215], v[84:87]
    ds_read_b128 v[156:159], v2 offset:44032
    buffer_load_dwordx4 v32, s[8:11], s36 offen offset:2048 sc1 lds
    v_mfma_f32_16x16x32_bf16 v[88:91], v[228:231], v[200:203], v[88:91]
    ds_read_b64_tr_b16 v[164:165], v5 offset:32768
    v_mfma_f32_16x16x32_bf16 v[88:91], v[244:247], v[216:219], v[88:91]
    ds_read_b64_tr_b16 v[166:167], v5 offset:36864
    buffer_load_dwordx4 v32, s[8:11], s36 offen offset:3072 sc1 lds
    v_mfma_f32_16x16x32_bf16 v[92:95], v[228:231], v[204:207], v[92:95]
    ds_read_b64_tr_b16 v[180:181], v5 offset:40960
    v_mfma_f32_16x16x32_bf16 v[92:95], v[244:247], v[220:223], v[92:95]
    ds_read_b64_tr_b16 v[182:183], v5 offset:45056
    s_add_u32 s53, s53, 1
    v_mfma_f32_16x16x32_bf16 v[96:99], v[232:235], v[192:195], v[96:99]
    ds_read_b64_tr_b16 v[168:169], v6 offset:32768
    v_readlane_b32 s37, v42, s53
    v_mfma_f32_16x16x32_bf16 v[96:99], v[248:251], v[208:211], v[96:99]
    ds_read_b64_tr_b16 v[170:171], v6 offset:36864
    v_mfma_f32_16x16x32_bf16 v[100:103], v[232:235], v[196:199], v[100:103]
    ds_read_b64_tr_b16 v[184:185], v6 offset:40960
    s_lshl_b32 s36, s37, 17
    v_mfma_f32_16x16x32_bf16 v[100:103], v[248:251], v[212:215], v[100:103]
    ds_read_b64_tr_b16 v[186:187], v6 offset:45056
    v_mfma_f32_16x16x32_bf16 v[104:107], v[232:235], v[200:203], v[104:107]
    ds_read_b64_tr_b16 v[172:173], v7 offset:32768
    s_cmp_lt_u32 s37, 32
    v_mfma_f32_16x16x32_bf16 v[104:107], v[248:251], v[216:219], v[104:107]
    ds_read_b64_tr_b16 v[174:175], v7 offset:36864
    s_cselect_b32 s12, s92, s68
    v_mfma_f32_16x16x32_bf16 v[108:111], v[232:235], v[204:207], v[108:111]
    ds_read_b64_tr_b16 v[188:189], v7 offset:40960
    v_mfma_f32_16x16x32_bf16 v[108:111], v[248:251], v[220:223], v[108:111]
    ds_read_b64_tr_b16 v[190:191], v7 offset:45056
    s_cselect_b32 s13, s93, s69
    v_mfma_f32_16x16x32_bf16 v[112:115], v[236:239], v[192:195], v[112:115]
    v_mfma_f32_16x16x32_bf16 v[112:115], v[252:255], v[208:211], v[112:115]
    s_cselect_b32 s14, s54, s55
    v_mfma_f32_16x16x32_bf16 v[116:119], v[236:239], v[196:199], v[116:119]
    s_cselect_b32 s60, 0, 32
    v_mfma_f32_16x16x32_bf16 v[116:119], v[252:255], v[212:215], v[116:119]
    v_mfma_f32_16x16x32_bf16 v[120:123], v[236:239], v[200:203], v[120:123]
    s_sub_u32 s37, s37, s60
    v_mfma_f32_16x16x32_bf16 v[120:123], v[252:255], v[216:219], v[120:123]
    v_mfma_f32_16x16x32_bf16 v[124:127], v[236:239], v[204:207], v[124:127]
    s_lshl_b32 s37, s37, 16
    v_mfma_f32_16x16x32_bf16 v[124:127], v[252:255], v[220:223], v[124:127]
    s_waitcnt vmcnt(18) lgkmcnt(0)
    s_barrier
    v_mfma_f32_16x16x32_bf16 v[64:67], v[160:163], v[128:131], v[64:67]
    ds_read_b64_tr_b16 v[224:225], v4 offset:49152
    s_add_u32 m0, s44, 32768
    v_mfma_f32_16x16x32_bf16 v[64:67], v[176:179], v[144:147], v[64:67]
    ds_read_b64_tr_b16 v[226:227], v4 offset:53248
    v_mfma_f32_16x16x32_bf16 v[68:71], v[160:163], v[132:135], v[68:71]
    ds_read_b128 v[192:195], v2 offset:49152
    v_mfma_f32_16x16x32_bf16 v[68:71], v[176:179], v[148:151], v[68:71]
    ds_read_b64_tr_b16 v[240:241], v4 offset:57344
    buffer_load_dwordx4 v18, s[12:15], s37 offen sc1 lds
    v_mfma_f32_16x16x32_bf16 v[72:75], v[160:163], v[136:139], v[72:75]
    ds_read_b64_tr_b16 v[242:243], v4 offset:61440
    v_mfma_f32_16x16x32_bf16 v[72:75], v[176:179], v[152:155], v[72:75]
    ds_read_b128 v[208:211], v2 offset:57344
    v_mfma_f32_16x16x32_bf16 v[76:79], v[160:163], v[140:143], v[76:79]
    ds_read_b128 v[196:199], v2 offset:50176
    v_mfma_f32_16x16x32_bf16 v[76:79], v[176:179], v[156:159], v[76:79]
    ds_read_b128 v[212:215], v2 offset:58368
    s_add_u32 m0, s44, 33792
    v_mfma_f32_16x16x32_bf16 v[80:83], v[164:167], v[128:131], v[80:83]
    ds_read_b128 v[200:203], v2 offset:51200
    v_mfma_f32_16x16x32_bf16 v[80:83], v[180:183], v[144:147], v[80:83]
    ds_read_b128 v[216:219], v2 offset:59392
    v_mfma_f32_16x16x32_bf16 v[84:87], v[164:167], v[132:135], v[84:87]
    ds_read_b128 v[204:207], v2 offset:52224
    buffer_load_dwordx4 v19, s[12:15], s37 offen sc1 lds
    v_mfma_f32_16x16x32_bf16 v[84:87], v[180:183], v[148:151], v[84:87]
    ds_read_b128 v[220:223], v2 offset:60416
    v_mfma_f32_16x16x32_bf16 v[88:91], v[164:167], v[136:139], v[88:91]
    ds_read_b64_tr_b16 v[228:229], v5 offset:49152
    v_mfma_f32_16x16x32_bf16 v[88:91], v[180:183], v[152:155], v[88:91]
    ds_read_b64_tr_b16 v[230:231], v5 offset:53248
    v_mfma_f32_16x16x32_bf16 v[92:95], v[164:167], v[140:143], v[92:95]
    ds_read_b64_tr_b16 v[244:245], v5 offset:57344
    s_add_u32 m0, s38, 32768
    v_mfma_f32_16x16x32_bf16 v[92:95], v[180:183], v[156:159], v[92:95]
    ds_read_b64_tr_b16 v[246:247], v5 offset:61440
    v_mfma_f32_16x16x32_bf16 v[96:99], v[168:171], v[128:131], v[96:99]
    ds_read_b64_tr_b16 v[232:233], v6 offset:49152
    v_mfma_f32_16x16x32_bf16 v[96:99], v[184:187], v[144:147], v[96:99]
    ds_read_b64_tr_b16 v[234:235], v6 offset:53248
    buffer_load_dwordx4 v32, s[8:11], s36 offen offset:0 sc1 lds
    v_mfma_f32_16x16x32_bf16 v[100:103], v[168:171], v[132:135], v[100:103]
    ds_read_b64_tr_b16 v[248:249], v6 offset:57344
    v_mfma_f32_16x16x32_bf16 v[100:103], v[184:187], v[148:151], v[100:103]
    ds_read_b64_tr_b16 v[250:251], v6 offset:61440
    v_mfma_f32_16x16x32_bf16 v[104:107], v[168:171], v[136:139], v[104:107]
    ds_read_b64_tr_b16 v[236:237], v7 offset:49152
    v_mfma_f32_16x16x32_bf16 v[104:107], v[184:187], v[152:155], v[104:107]
    ds_read_b64_tr_b16 v[238:239], v7 offset:53248
    buffer_load_dwordx4 v32, s[8:11], s36 offen offset:1024 sc1 lds
    v_mfma_f32_16x16x32_bf16 v[108:111], v[168:171], v[140:143], v[108:111]
    ds_read_b64_tr_b16 v[252:253], v7 offset:57344
    v_mfma_f32_16x16x32_bf16 v[108:111], v[184:187], v[156:159], v[108:111]
    ds_read_b64_tr_b16 v[254:255], v7 offset:61440
    v_mfma_f32_16x16x32_bf16 v[112:115], v[172:175], v[128:131], v[112:115]
    buffer_load_dwordx4 v32, s[8:11], s36 offen offset:2048 sc1 lds
    v_mfma_f32_16x16x32_bf16 v[112:115], v[188:191], v[144:147], v[112:115]
    v_mfma_f32_16x16x32_bf16 v[116:119], v[172:175], v[132:135], v[116:119]
    v_mfma_f32_16x16x32_bf16 v[116:119], v[188:191], v[148:151], v[116:119]
    v_mfma_f32_16x16x32_bf16 v[120:123], v[172:175], v[136:139], v[120:123]
    buffer_load_dwordx4 v32, s[8:11], s36 offen offset:3072 sc1 lds
    v_mfma_f32_16x16x32_bf16 v[120:123], v[188:191], v[152:155], v[120:123]
    v_mfma_f32_16x16x32_bf16 v[124:127], v[172:175], v[140:143], v[124:127]
    v_mfma_f32_16x16x32_bf16 v[124:127], v[188:191], v[156:159], v[124:127]
    s_waitcnt vmcnt(18) lgkmcnt(0)
    s_barrier
    v_mfma_f32_16x16x32_bf16 v[96:99], v[232:235], v[192:195], v[96:99]
    ds_read_b64_tr_b16 v[160:161], v22 offset:0
    v_mfma_f32_16x16x32_bf16 v[96:99], v[248:251], v[208:211], v[96:99]
    ds_read_b64_tr_b16 v[162:163], v22 offset:2048
    v_mfma_f32_16x16x32_bf16 v[100:103], v[232:235], v[196:199], v[100:103]
    ds_read_b128 v[128:131], v3 offset:0
    v_mfma_f32_16x16x32_bf16 v[100:103], v[248:251], v[212:215], v[100:103]
    ds_read_b64_tr_b16 v[176:177], v22 offset:4096
    v_mfma_f32_16x16x32_bf16 v[104:107], v[232:235], v[200:203], v[104:107]
    ds_read_b64_tr_b16 v[178:179], v22 offset:6144
    v_mfma_f32_16x16x32_bf16 v[104:107], v[248:251], v[216:219], v[104:107]
    ds_read_b128 v[144:147], v3 offset:8192
    v_mfma_f32_16x16x32_bf16 v[108:111], v[232:235], v[204:207], v[108:111]
    ds_read_b128 v[132:135], v3 offset:1024
    v_mfma_f32_16x16x32_bf16 v[108:111], v[248:251], v[220:223], v[108:111]
    ds_read_b128 v[148:151], v3 offset:9216
    v_mfma_f32_16x16x32_bf16 v[112:115], v[236:239], v[192:195], v[112:115]
    ds_read_b128 v[136:139], v3 offset:2048
    v_mfma_f32_16x16x32_bf16 v[112:115], v[252:255], v[208:211], v[112:115]
    ds_read_b128 v[152:155], v3 offset:10240
    v_mfma_f32_16x16x32_bf16 v[116:119], v[236:239], v[196:199], v[116:119]
    ds_read_b128 v[140:143], v3 offset:3072
    v_mfma_f32_16x16x32_bf16 v[116:119], v[252:255], v[212:215], v[116:119]
    ds_read_b128 v[156:159], v3 offset:11264
    v_mfma_f32_16x16x32_bf16 v[120:123], v[236:239], v[200:203], v[120:123]
    ds_read_b64_tr_b16 v[164:165], v23 offset:0
    v_mfma_f32_16x16x32_bf16 v[120:123], v[252:255], v[216:219], v[120:123]
    ds_read_b64_tr_b16 v[166:167], v23 offset:2048
    v_mfma_f32_16x16x32_bf16 v[124:127], v[236:239], v[204:207], v[124:127]
    ds_read_b64_tr_b16 v[180:181], v23 offset:4096
    v_mfma_f32_16x16x32_bf16 v[124:127], v[252:255], v[220:223], v[124:127]
    ds_read_b64_tr_b16 v[182:183], v23 offset:6144
    v_mfma_f32_16x16x32_bf16 v[64:67], v[224:227], v[192:195], v[64:67]
    v_mfma_f32_16x16x32_bf16 v[64:67], v[240:243], v[208:211], v[64:67]
    v_mfma_f32_16x16x32_bf16 v[68:71], v[224:227], v[196:199], v[68:71]
    v_mfma_f32_16x16x32_bf16 v[68:71], v[240:243], v[212:215], v[68:71]
    v_mfma_f32_16x16x32_bf16 v[72:75], v[224:227], v[200:203], v[72:75]
    v_cvt_pk_bf16_f32 v96, v96, v97
    v_cvt_pk_bf16_f32 v97, v98, v99
    v_mfma_f32_16x16x32_bf16 v[72:75], v[240:243], v[216:219], v[72:75]
    v_cvt_pk_bf16_f32 v98, v112, v113
    v_cvt_pk_bf16_f32 v99, v114, v115
    v_mfma_f32_16x16x32_bf16 v[76:79], v[224:227], v[204:207], v[76:79]
    buffer_store_dwordx4 v[96:99], v14, s[16:19], 0 offen offset:0 sc1
    v_mfma_f32_16x16x32_bf16 v[76:79], v[240:243], v[220:223], v[76:79]
    v_cvt_pk_bf16_f32 v100, v100, v101
    v_cvt_pk_bf16_f32 v101, v102, v103
    v_mfma_f32_16x16x32_bf16 v[80:83], v[228:231], v[192:195], v[80:83]
    v_cvt_pk_bf16_f32 v102, v116, v117
    v_cvt_pk_bf16_f32 v103, v118, v119
    v_mfma_f32_16x16x32_bf16 v[80:83], v[244:247], v[208:211], v[80:83]
    buffer_store_dwordx4 v[100:103], v14, s[16:19], 0 offen offset:1024 sc1
    v_mfma_f32_16x16x32_bf16 v[84:87], v[228:231], v[196:199], v[84:87]
    v_cvt_pk_bf16_f32 v104, v104, v105
    v_cvt_pk_bf16_f32 v105, v106, v107
    v_mfma_f32_16x16x32_bf16 v[84:87], v[244:247], v[212:215], v[84:87]
    v_cvt_pk_bf16_f32 v106, v120, v121
    v_cvt_pk_bf16_f32 v107, v122, v123
    v_mfma_f32_16x16x32_bf16 v[88:91], v[228:231], v[200:203], v[88:91]
    buffer_store_dwordx4 v[104:107], v14, s[16:19], 0 offen offset:2048 sc1
    v_mfma_f32_16x16x32_bf16 v[88:91], v[244:247], v[216:219], v[88:91]
    v_cvt_pk_bf16_f32 v108, v108, v109
    v_cvt_pk_bf16_f32 v109, v110, v111
    v_mfma_f32_16x16x32_bf16 v[92:95], v[228:231], v[204:207], v[92:95]
    v_cvt_pk_bf16_f32 v110, v124, v125
    v_cvt_pk_bf16_f32 v111, v126, v127
    v_mfma_f32_16x16x32_bf16 v[92:95], v[244:247], v[220:223], v[92:95]
    buffer_store_dwordx4 v[108:111], v14, s[16:19], 0 offen offset:3072 sc1
    s_waitcnt vmcnt(16) lgkmcnt(0)
    s_barrier
    v_mfma_f32_16x16x32_bf16 v[64:67], v[160:163], v[128:131], v[64:67]
    ds_read_b64_tr_b16 v[224:225], v20 offset:0
    v_mfma_f32_16x16x32_bf16 v[64:67], v[176:179], v[144:147], v[64:67]
    ds_read_b64_tr_b16 v[226:227], v20 offset:2048
    v_mfma_f32_16x16x32_bf16 v[68:71], v[160:163], v[132:135], v[68:71]
    ds_read_b128 v[192:195], v2 offset:0
    v_mfma_f32_16x16x32_bf16 v[68:71], v[176:179], v[148:151], v[68:71]
    ds_read_b64_tr_b16 v[240:241], v20 offset:4096
    v_mfma_f32_16x16x32_bf16 v[72:75], v[160:163], v[136:139], v[72:75]
    ds_read_b64_tr_b16 v[242:243], v20 offset:6144
    v_mfma_f32_16x16x32_bf16 v[72:75], v[176:179], v[152:155], v[72:75]
    ds_read_b128 v[208:211], v2 offset:8192
    v_mfma_f32_16x16x32_bf16 v[76:79], v[160:163], v[140:143], v[76:79]
    ds_read_b128 v[196:199], v2 offset:1024
    v_mfma_f32_16x16x32_bf16 v[76:79], v[176:179], v[156:159], v[76:79]
    ds_read_b128 v[212:215], v2 offset:9216
    v_mfma_f32_16x16x32_bf16 v[80:83], v[164:167], v[128:131], v[80:83]
    ds_read_b128 v[200:203], v2 offset:2048
    v_mfma_f32_16x16x32_bf16 v[80:83], v[180:183], v[144:147], v[80:83]
    ds_read_b128 v[216:219], v2 offset:10240
    v_mfma_f32_16x16x32_bf16 v[84:87], v[164:167], v[132:135], v[84:87]
    ds_read_b128 v[204:207], v2 offset:3072
    v_mfma_f32_16x16x32_bf16 v[84:87], v[180:183], v[148:151], v[84:87]
    ds_read_b128 v[220:223], v2 offset:11264
    v_mfma_f32_16x16x32_bf16 v[88:91], v[164:167], v[136:139], v[88:91]
    ds_read_b64_tr_b16 v[228:229], v21 offset:0
    v_mfma_f32_16x16x32_bf16 v[88:91], v[180:183], v[152:155], v[88:91]
    ds_read_b64_tr_b16 v[230:231], v21 offset:2048
    v_mfma_f32_16x16x32_bf16 v[92:95], v[164:167], v[140:143], v[92:95]
    ds_read_b64_tr_b16 v[244:245], v21 offset:4096
    v_mfma_f32_16x16x32_bf16 v[92:95], v[180:183], v[156:159], v[92:95]
    ds_read_b64_tr_b16 v[246:247], v21 offset:6144
    s_waitcnt vmcnt(10) lgkmcnt(0)
    s_barrier
    v_mfma_f32_16x16x32_bf16 v[64:67], v[224:227], v[192:195], v[64:67]
    ds_read_b64_tr_b16 v[160:161], v20 offset:16384
    buffer_load_dwordx4 v[48:51], v12, s[20:23], 0 offen
    v_mfma_f32_16x16x32_bf16 v[64:67], v[240:243], v[208:211], v[64:67]
    ds_read_b64_tr_b16 v[162:163], v20 offset:18432
    v_mfma_f32_16x16x32_bf16 v[68:71], v[224:227], v[196:199], v[68:71]
    ds_read_b128 v[128:131], v2 offset:16384
    v_mfma_f32_16x16x32_bf16 v[68:71], v[240:243], v[212:215], v[68:71]
    ds_read_b64_tr_b16 v[176:177], v20 offset:20480
    v_mfma_f32_16x16x32_bf16 v[72:75], v[224:227], v[200:203], v[72:75]
    ds_read_b64_tr_b16 v[178:179], v20 offset:22528
    buffer_load_dwordx4 v[52:55], v12, s[20:23], s61 offen
    v_mfma_f32_16x16x32_bf16 v[72:75], v[240:243], v[216:219], v[72:75]
    ds_read_b128 v[144:147], v2 offset:24576
    v_mfma_f32_16x16x32_bf16 v[76:79], v[224:227], v[204:207], v[76:79]
    ds_read_b128 v[132:135], v2 offset:17408
    v_mfma_f32_16x16x32_bf16 v[76:79], v[240:243], v[220:223], v[76:79]
    ds_read_b128 v[148:151], v2 offset:25600
    v_mfma_f32_16x16x32_bf16 v[80:83], v[228:231], v[192:195], v[80:83]
    ds_read_b128 v[136:139], v2 offset:18432
    buffer_load_dwordx4 v[56:59], v12, s[20:23], s62 offen
    v_mfma_f32_16x16x32_bf16 v[80:83], v[244:247], v[208:211], v[80:83]
    ds_read_b128 v[152:155], v2 offset:26624
    v_mfma_f32_16x16x32_bf16 v[84:87], v[228:231], v[196:199], v[84:87]
    ds_read_b128 v[140:143], v2 offset:19456
    v_mfma_f32_16x16x32_bf16 v[84:87], v[244:247], v[212:215], v[84:87]
    ds_read_b128 v[156:159], v2 offset:27648
    v_mfma_f32_16x16x32_bf16 v[88:91], v[228:231], v[200:203], v[88:91]
    ds_read_b64_tr_b16 v[164:165], v21 offset:16384
    buffer_load_dwordx4 v[60:63], v12, s[20:23], s63 offen
    v_mfma_f32_16x16x32_bf16 v[88:91], v[244:247], v[216:219], v[88:91]
    ds_read_b64_tr_b16 v[166:167], v21 offset:18432
    v_mfma_f32_16x16x32_bf16 v[92:95], v[228:231], v[204:207], v[92:95]
    ds_read_b64_tr_b16 v[180:181], v21 offset:20480
    v_mfma_f32_16x16x32_bf16 v[92:95], v[244:247], v[220:223], v[92:95]
    ds_read_b64_tr_b16 v[182:183], v21 offset:22528
    s_waitcnt vmcnt(8) lgkmcnt(0)
    s_barrier
    v_mfma_f32_16x16x32_bf16 v[64:67], v[160:163], v[128:131], v[64:67]
    ds_read_b64_tr_b16 v[224:225], v20 offset:32768
    v_mfma_f32_16x16x32_bf16 v[64:67], v[176:179], v[144:147], v[64:67]
    ds_read_b64_tr_b16 v[226:227], v20 offset:34816
    v_mfma_f32_16x16x32_bf16 v[68:71], v[160:163], v[132:135], v[68:71]
    ds_read_b128 v[192:195], v2 offset:32768
    v_mfma_f32_16x16x32_bf16 v[68:71], v[176:179], v[148:151], v[68:71]
    ds_read_b64_tr_b16 v[240:241], v20 offset:36864
    v_mfma_f32_16x16x32_bf16 v[72:75], v[160:163], v[136:139], v[72:75]
    ds_read_b64_tr_b16 v[242:243], v20 offset:38912
    v_mfma_f32_16x16x32_bf16 v[72:75], v[176:179], v[152:155], v[72:75]
    ds_read_b128 v[208:211], v2 offset:40960
    v_mfma_f32_16x16x32_bf16 v[76:79], v[160:163], v[140:143], v[76:79]
    ds_read_b128 v[196:199], v2 offset:33792
    v_mfma_f32_16x16x32_bf16 v[76:79], v[176:179], v[156:159], v[76:79]
    ds_read_b128 v[212:215], v2 offset:41984
    v_mfma_f32_16x16x32_bf16 v[80:83], v[164:167], v[128:131], v[80:83]
    ds_read_b128 v[200:203], v2 offset:34816
    v_mfma_f32_16x16x32_bf16 v[80:83], v[180:183], v[144:147], v[80:83]
    ds_read_b128 v[216:219], v2 offset:43008
    v_mfma_f32_16x16x32_bf16 v[84:87], v[164:167], v[132:135], v[84:87]
    ds_read_b128 v[204:207], v2 offset:35840
    v_mfma_f32_16x16x32_bf16 v[84:87], v[180:183], v[148:151], v[84:87]
    ds_read_b128 v[220:223], v2 offset:44032
    v_mfma_f32_16x16x32_bf16 v[88:91], v[164:167], v[136:139], v[88:91]
    ds_read_b64_tr_b16 v[228:229], v21 offset:32768
    v_mfma_f32_16x16x32_bf16 v[88:91], v[180:183], v[152:155], v[88:91]
    ds_read_b64_tr_b16 v[230:231], v21 offset:34816
    v_mfma_f32_16x16x32_bf16 v[92:95], v[164:167], v[140:143], v[92:95]
    ds_read_b64_tr_b16 v[244:245], v21 offset:36864
    v_mfma_f32_16x16x32_bf16 v[92:95], v[180:183], v[156:159], v[92:95]
    ds_read_b64_tr_b16 v[246:247], v21 offset:38912
    s_waitcnt vmcnt(4)
    s_mov_b64 exec, 1
    buffer_store_dwordx2 v[38:39], v16, s[96:99], 0 offen sc1
    s_mov_b64 exec, -1
    buffer_load_dwordx2 v[30:31], v17, s[96:99], 0 offen sc1
    s_waitcnt lgkmcnt(0)
    v_mfma_f32_16x16x32_bf16 v[64:67], v[224:227], v[192:195], v[64:67]
    v_mfma_f32_16x16x32_bf16 v[64:67], v[240:243], v[208:211], v[64:67]
    v_mfma_f32_16x16x32_bf16 v[68:71], v[224:227], v[196:199], v[68:71]
    v_mfma_f32_16x16x32_bf16 v[68:71], v[240:243], v[212:215], v[68:71]
    v_mfma_f32_16x16x32_bf16 v[72:75], v[224:227], v[200:203], v[72:75]
    v_mfma_f32_16x16x32_bf16 v[72:75], v[240:243], v[216:219], v[72:75]
    v_mfma_f32_16x16x32_bf16 v[76:79], v[224:227], v[204:207], v[76:79]
    v_mfma_f32_16x16x32_bf16 v[76:79], v[240:243], v[220:223], v[76:79]
    v_mfma_f32_16x16x32_bf16 v[80:83], v[228:231], v[192:195], v[80:83]
    v_mfma_f32_16x16x32_bf16 v[80:83], v[244:247], v[208:211], v[80:83]
    v_mfma_f32_16x16x32_bf16 v[84:87], v[228:231], v[196:199], v[84:87]
    v_mfma_f32_16x16x32_bf16 v[84:87], v[244:247], v[212:215], v[84:87]
    v_mfma_f32_16x16x32_bf16 v[88:91], v[228:231], v[200:203], v[88:91]
    v_mfma_f32_16x16x32_bf16 v[88:91], v[244:247], v[216:219], v[88:91]
    v_mfma_f32_16x16x32_bf16 v[92:95], v[228:231], v[204:207], v[92:95]
    v_mfma_f32_16x16x32_bf16 v[92:95], v[244:247], v[220:223], v[92:95]
    s_waitcnt vmcnt(0)
    s_mov_b32 s3, 0
L2_chk:
    v_xor_b32 v31, v30, v31
    v_subrev_u32 v30, s100, v30
    v_lshrrev_b32 v30, 17, v30
    v_cmp_eq_u32 vcc, s101, v31
    v_cmp_eq_u32 s[66:67], 0, v30
    s_nop 1
    s_and_b64 vcc, vcc, s[66:67]
    s_cmp_eq_u64 vcc, exec
    s_cbranch_scc1 L2_have
    s_add_u32 s3, s3, 1
    s_cmp_gt_u32 s3, 0x40000
    s_cbranch_scc1 L2_have
    buffer_load_dwordx2 v[30:31], v17, s[96:99], 0 offen sc1
    s_waitcnt vmcnt(0)
    s_branch L2_chk
L2_have:
    buffer_load_dwordx4 v[96:99], v15, s[16:19], 0 offen offset:0 sc1
    buffer_load_dwordx4 v[100:103], v15, s[16:19], 0 offen offset:1024 sc1
    buffer_load_dwordx4 v[104:107], v15, s[16:19], 0 offen offset:2048 sc1
    buffer_load_dwordx4 v[108:111], v15, s[16:19], 0 offen offset:3072 sc1
    v_lshlrev_b32 v128, 16, v48
    v_and_b32 v129, s64, v48
    v_lshlrev_b32 v130, 16, v49
    v_and_b32 v131, s64, v49
    v_lshlrev_b32 v132, 16, v50
    v_and_b32 v133, s64, v50
    v_lshlrev_b32 v134, 16, v51
    v_and_b32 v135, s64, v51
    v_lshlrev_b32 v136, 16, v52
    v_and_b32 v137, s64, v52
    v_lshlrev_b32 v138, 16, v53
    v_and_b32 v139, s64, v53
    v_lshlrev_b32 v140, 16, v54
    v_and_b32 v141, s64, v54
    v_lshlrev_b32 v142, 16, v55
    v_and_b32 v143, s64, v55
    v_lshlrev_b32 v144, 16, v56
    v_and_b32 v145, s64, v56
    v_lshlrev_b32 v146, 16, v57
    v_and_b32 v147, s64, v57
    v_lshlrev_b32 v148, 16, v58
    v_and_b32 v149, s64, v58
    v_lshlrev_b32 v150, 16, v59
    v_and_b32 v151, s64, v59
    v_lshlrev_b32 v152, 16, v60
    v_and_b32 v153, s64, v60
    v_lshlrev_b32 v154, 16, v61
    v_and_b32 v155, s64, v61
    v_lshlrev_b32 v156, 16, v62
    v_and_b32 v157, s64, v62
    v_lshlrev_b32 v158, 16, v63
    v_and_b32 v159, s64, v63
    s_waitcnt vmcnt(3)
    v_lshlrev_b32 v160, 16, v96
    v_and_b32 v161, s64, v96
    v_lshlrev_b32 v162, 16, v97
    v_and_b32 v163, s64, v97
    v_lshlrev_b32 v164, 16, v98
    v_and_b32 v165, s64, v98
    v_lshlrev_b32 v166, 16, v99
    v_and_b32 v167, s64, v99
    v_pk_add_f32 v[64:65], v[64:65], v[160:161]
    v_pk_add_f32 v[66:67], v[66:67], v[162:163]
    v_pk_add_f32 v[80:81], v[80:81], v[164:165]
    v_pk_add_f32 v[82:83], v[82:83], v[166:167]
    s_nop 0
    v_permlane16_swap_b32 v64, v80
    v_permlane16_swap_b32 v65, v81
    v_permlane16_swap_b32 v66, v82
    v_permlane16_swap_b32 v67, v83
    v_pk_add_f32 v[64:65], v[64:65], v[128:129]
    v_pk_add_f32 v[66:67], v[66:67], v[130:131]
    v_pk_add_f32 v[80:81], v[80:81], v[132:133]
    v_pk_add_f32 v[82:83], v[82:83], v[134:135]
    v_cvt_pk_bf16_f32 v48, v64, v65
    v_cvt_pk_bf16_f32 v49, v66, v67
    v_cvt_pk_bf16_f32 v50, v80, v81
    v_cvt_pk_bf16_f32 v51, v82, v83
    buffer_store_dwordx4 v[48:51], v12, s[24:27], 0 offen
    s_waitcnt vmcnt(3)
    v_lshlrev_b32 v168, 16, v100
    v_and_b32 v169, s64, v100
    v_lshlrev_b32 v170, 16, v101
    v_and_b32 v171, s64, v101
    v_lshlrev_b32 v172, 16, v102
    v_and_b32 v173, s64, v102
    v_lshlrev_b32 v174, 16, v103
    v_and_b32 v175, s64, v103
    v_pk_add_f32 v[68:69], v[68:69], v[168:169]
    v_pk_add_f32 v[70:71], v[70:71], v[170:171]
    v_pk_add_f32 v[84:85], v[84:85], v[172:173]
    v_pk_add_f32 v[86:87], v[86:87], v[174:175]
    s_nop 0
    v_permlane16_swap_b32 v68, v84
    v_permlane16_swap_b32 v69, v85
    v_permlane16_swap_b32 v70, v86
    v_permlane16_swap_b32 v71, v87
    v_pk_add_f32 v[68:69], v[68:69], v[136:137]
    v_pk_add_f32 v[70:71], v[70:71], v[138:139]
    v_pk_add_f32 v[84:85], v[84:85], v[140:141]
    v_pk_add_f32 v[86:87], v[86:87], v[142:143]
    v_cvt_pk_bf16_f32 v52, v68, v69
    v_cvt_pk_bf16_f32 v53, v70, v71
    v_cvt_pk_bf16_f32 v54, v84, v85
    v_cvt_pk_bf16_f32 v55, v86, v87
    buffer_store_dwordx4 v[52:55], v12, s[24:27], s61 offen
    s_waitcnt vmcnt(3)
    v_lshlrev_b32 v176, 16, v104
    v_and_b32 v177, s64, v104
    v_lshlrev_b32 v178, 16, v105
    v_and_b32 v179, s64, v105
    v_lshlrev_b32 v180, 16, v106
    v_and_b32 v181, s64, v106
    v_lshlrev_b32 v182, 16, v107
    v_and_b32 v183, s64, v107
    v_pk_add_f32 v[72:73], v[72:73], v[176:177]
    v_pk_add_f32 v[74:75], v[74:75], v[178:179]
    v_pk_add_f32 v[88:89], v[88:89], v[180:181]
    v_pk_add_f32 v[90:91], v[90:91], v[182:183]
    s_nop 0
    v_permlane16_swap_b32 v72, v88
    v_permlane16_swap_b32 v73, v89
    v_permlane16_swap_b32 v74, v90
    v_permlane16_swap_b32 v75, v91
    v_pk_add_f32 v[72:73], v[72:73], v[144:145]
    v_pk_add_f32 v[74:75], v[74:75], v[146:147]
    v_pk_add_f32 v[88:89], v[88:89], v[148:149]
    v_pk_add_f32 v[90:91], v[90:91], v[150:151]
    v_cvt_pk_bf16_f32 v56, v72, v73
    v_cvt_pk_bf16_f32 v57, v74, v75
    v_cvt_pk_bf16_f32 v58, v88, v89
    v_cvt_pk_bf16_f32 v59, v90, v91
    buffer_store_dwordx4 v[56:59], v12, s[24:27], s62 offen
    s_waitcnt vmcnt(3)
    v_lshlrev_b32 v184, 16, v108
    v_and_b32 v185, s64, v108
    v_lshlrev_b32 v186, 16, v109
    v_and_b32 v187, s64, v109
    v_lshlrev_b32 v188, 16, v110
    v_and_b32 v189, s64, v110
    v_lshlrev_b32 v190, 16, v111
    v_and_b32 v191, s64, v111
    v_pk_add_f32 v[76:77], v[76:77], v[184:185]
    v_pk_add_f32 v[78:79], v[78:79], v[186:187]
    v_pk_add_f32 v[92:93], v[92:93], v[188:189]
    v_pk_add_f32 v[94:95], v[94:95], v[190:191]
    s_nop 0
    v_permlane16_swap_b32 v76, v92
    v_permlane16_swap_b32 v77, v93
    v_permlane16_swap_b32 v78, v94
    v_permlane16_swap_b32 v79, v95
    v_pk_add_f32 v[76:77], v[76:77], v[152:153]
    v_pk_add_f32 v[78:79], v[78:79], v[154:155]
    v_pk_add_f32 v[92:93], v[92:93], v[156:157]
    v_pk_add_f32 v[94:95], v[94:95], v[158:159]
    v_cvt_pk_bf16_f32 v60, v76, v77
    v_cvt_pk_bf16_f32 v61, v78, v79
    v_cvt_pk_bf16_f32 v62, v92, v93
    v_cvt_pk_bf16_f32 v63, v94, v95
    buffer_store_dwordx4 v[60:63], v12, s[24:27], s63 offen
L_end:
    s_endpgm
.section .rodata,"a"
.p2align 6
.amdhsa_kernel parallel_sum__sliding_local_dilated__glu_gated_bilinear__prompt_kernel
  .amdhsa_next_free_vgpr 512
  .amdhsa_next_free_sgpr 102
  .amdhsa_accum_offset 256
  .amdhsa_group_segment_fixed_size 0
  .amdhsa_kernarg_size 80
  .amdhsa_user_sgpr_count 2
  .amdhsa_user_sgpr_kernarg_segment_ptr 1
  .amdhsa_system_sgpr_workgroup_id_x 1
.end_amdhsa_kernel
```
